```python
import torch

def _softmax(x, axis=-1):
    return torch.softmax(x, dim=axis)
def _gelu(x):
    return torch.nn.functional.gelu(x, approximate="tanh")
def _silu(x):
    return torch.nn.functional.silu(x)
def _sigmoid(x):
    return torch.sigmoid(x)
def _layernorm(x, axis=-1, eps=1e-5):
    m = x.mean(dim=axis, keepdim=True)
    v = x.var(dim=axis, keepdim=True, unbiased=False)
    return (x - m) / torch.sqrt(v + eps)
def _scatter_add(tgt, idx, src, axis=0):
    return tgt.clone().index_add_(axis, idx, src)
def _segment_sum(src, seg, n):
    out = torch.zeros((n,) + src.shape[1:], dtype=src.dtype)
    return out.index_add_(0, seg, src)
def _pad(x, pw):
    flat = tuple(v for pair in reversed(pw) for v in pair)
    return torch.nn.functional.pad(x, flat)

kernel_name = 'concat_heads__mha_block_cached__gqa_block_cached__near_ridge'

def setup_inputs():

    _w = (lambda a: (lambda t: t.to(torch.bfloat16) if t.is_floating_point() else t)(torch.as_tensor(a)))
    def _A_setup():
        B, Sq, D = 16, 160, 512
        H, Sk, Dh = 32, 512, 128
        return {
            "x": _w((lambda *s: torch.randn(*s, dtype=torch.bfloat16) * 0.8)(B, Sq, D)),
            "k_cache": _w((lambda *s: torch.randn(*s, dtype=torch.bfloat16) * 0.8)(B, H, Sk, Dh)),
            "v_cache": _w((lambda *s: torch.randn(*s, dtype=torch.bfloat16) * 0.05)(B, H, Sk, Dh)),
            "wq": _w((lambda *s: torch.randn(*s, dtype=torch.bfloat16) * 0.8)(D, H * Dh) * (D ** -0.5)),
            "wo": _w((lambda *s: torch.randn(*s, dtype=torch.bfloat16) * 0.05)(H * Dh, D) * ((H * Dh) ** -0.5)),
        }
    _A_in = _A_setup()

    def _B_setup():
        B, Sq, D = 16, 160, 512
        Hq, Hkv, Sk, Dh = 32, 32, 512, 128
        assert Hq % Hkv == 0, (Hq, Hkv)
        return {
            "x": _w((lambda *s: torch.randn(*s, dtype=torch.bfloat16) * 0.8)(B, Sq, D)),
            "k_cache": _w((lambda *s: torch.randn(*s, dtype=torch.bfloat16) * 0.8)(B, Hkv, Sk, Dh)),
            "v_cache": _w((lambda *s: torch.randn(*s, dtype=torch.bfloat16) * 0.05)(B, Hkv, Sk, Dh)),
            "wq": _w((lambda *s: torch.randn(*s, dtype=torch.bfloat16) * 0.8)(D, Hq * Dh) * (D ** -0.5)),
            "wo": _w((lambda *s: torch.randn(*s, dtype=torch.bfloat16) * 0.05)(Hq * Dh, D) * ((Hq * Dh) ** -0.5)),
        }
    _B_in = _B_setup()

    return {
        "A_x": _A_in["x"],
        "A_k_cache": _A_in["k_cache"],
        "A_v_cache": _A_in["v_cache"],
        "A_wq": _A_in["wq"],
        "A_wo": _A_in["wo"],
        "B_x": _B_in["x"],
        "B_k_cache": _B_in["k_cache"],
        "B_v_cache": _B_in["v_cache"],
        "B_wq": _B_in["wq"],
        "B_wo": _B_in["wo"],
    }

def reference(A_x, A_k_cache, A_v_cache, A_wq, A_wo, B_x, B_k_cache, B_v_cache, B_wq, B_wo):
    def _A_ref(x, k_cache, v_cache, wq, wo):
        B, Sq, D = x.shape
        H, Dh = 32, 128
        q = (lambda x, *d: x.permute(*d))((x @ wq).reshape(B, Sq, H, Dh), 0, 2, 1, 3)
        scores = torch.einsum("bhqd,bhkd->bhqk", q, k_cache) * (Dh ** -0.5)
        p = _softmax(scores, axis=-1)
        o = torch.einsum("bhqk,bhkd->bhqd", p, v_cache)
        return (lambda x, *d: x.permute(*d))(o, 0, 2, 1, 3).reshape(B, Sq, H * Dh) @ wo

    def _B_ref(x, k_cache, v_cache, wq, wo):
        B, Sq, D = x.shape
        Hq, Dh = 32, 128
        Hkv = k_cache.shape[1]
        rep = Hq // Hkv
        q = (lambda x, *d: x.permute(*d))((x @ wq).reshape(B, Sq, Hq, Dh), 0, 2, 1, 3)
        k = (lambda x, n, axis: torch.repeat_interleave(x, n, dim=axis))(k_cache, rep, axis=1)
        v = (lambda x, n, axis: torch.repeat_interleave(x, n, dim=axis))(v_cache, rep, axis=1)
        scores = torch.einsum("bhqd,bhkd->bhqk", q, k) * (Dh ** -0.5)
        p = _softmax(scores, axis=-1)
        o = torch.einsum("bhqk,bhkd->bhqd", p, v)
        return (lambda x, *d: x.permute(*d))(o, 0, 2, 1, 3).reshape(B, Sq, Hq * Dh) @ wo

    a = _A_ref(A_x, A_k_cache, A_v_cache, A_wq, A_wo)
    b = _B_ref(B_x, B_k_cache, B_v_cache, B_wq, B_wo)
    return torch.concatenate([a, b], axis=-1)
```

```asm
; @launch grid=(256,1,1) block=(256,1,1) lds=163840
.amdgcn_target "amdgcn-amd-amdhsa--gfx950"
.text
.globl concat_heads__mha_block_cached__gqa_block_cached__near_ridge_kernel
.p2align 8
.type concat_heads__mha_block_cached__gqa_block_cached__near_ridge_kernel,@function
concat_heads__mha_block_cached__gqa_block_cached__near_ridge_kernel:
  s_cmp_ge_u32 s2, 256
  s_cbranch_scc1 L_end
  s_bfe_u32 s44, s2, 0x10002
  s_mul_i32 s45, s44, 40
  s_add_u32 s46, s0, s45
  s_addc_u32 s47, s1, 0
  s_load_dwordx8 s[72:79], s[46:47], 0
  s_load_dwordx2 s[26:27], s[46:47], 32
  s_load_dwordx4 s[80:83], s[0:1], 88
  v_lshrrev_b32 v28, 6, v0
  v_and_b32 v0, 63, v0
  v_readfirstlane_b32 s30, v28
  s_and_b32 s45, s2, 3
  s_lshl_b32 s45, s45, 1
  s_bfe_u32 s46, s2, 0x10003
  s_add_u32 s33, s45, s46
  s_lshr_b32 s43, s2, 4
  v_lshrrev_b32 v24, 4, v0
  v_and_b32 v25, 15, v0
  v_bfe_u32 v26, v0, 2, 2
  v_and_b32 v27, 3, v0
  s_lshl_b32 s31, s30, 12
  s_mul_i32 s32, s30, 5120
  s_lshr_b32 s46, s30, 1
  s_and_b32 s47, s30, 1
  s_mov_b32 s7, 0x20000
  s_mov_b32 s15, 0x20000
  s_mov_b32 s11, 0x20000
  s_mov_b32 s10, 393216
  s_lshl_b32 s48, s43, 5
  s_lshl_b32 s49, s33, 2
  s_add_u32 s48, s48, s49
  s_add_u32 s48, s48, s46
  s_lshl_b32 s42, s48, 17
  s_mul_i32 s48, s2, 79
  s_lshr_b32 s48, s48, 10
  s_mul_i32 s48, s48, 13
  s_sub_u32 s45, s2, s48
  s_mul_i32 s48, s46, 6
  s_add_u32 s48, s48, s45
  s_cmp_ge_u32 s48, 13
  s_cselect_b32 s49, 13, 0
  s_sub_u32 s48, s48, s49
  s_lshl_b32 s71, s48, 13
  s_lshl_b32 s45, s45, 13
  s_and_b32 s71, s71, 0x1ffff
  s_and_b32 s45, s45, 0x1ffff
  s_lshl_b32 s48, s47, 12
  v_lshl_add_u32 v29, v24, 8, s48
  v_xor_b32 v28, v24, v25
  v_xor_b32 v13, 0, v28
  v_lshl_add_u32 v13, v13, 4, v29
  v_xor_b32 v14, 4, v28
  v_lshl_add_u32 v14, v14, 4, v29
  v_xor_b32 v15, 8, v28
  v_lshl_add_u32 v15, v15, 4, v29
  v_xor_b32 v16, 12, v28
  v_lshl_add_u32 v16, v16, 4, v29
  v_lshlrev_b32 v28, 1, v24
  v_xor_b32 v28, v28, v25
  v_lshl_add_u32 v21, v28, 4, v29
  v_and_b32 v28, 7, v0
  v_bfe_u32 v29, v0, 3, 1
  v_lshlrev_b32 v30, 7, v28
  v_lshl_add_u32 v30, v29, 13, v30
  v_lshl_add_u32 v30, v24, 18, v30
  s_lshl_b32 s49, s43, 14
  v_add_u32 v30, s49, v30
  v_max_u32 v28, 2, v28
  v_lshlrev_b32 v28, 7, v28
  v_lshrrev_b32 v29, 3, v0
  v_lshl_add_u32 v32, v29, 10, v28
  s_mov_b64 vcc, 0
  s_waitcnt lgkmcnt(0)
  s_add_u32 s8, s74, s42
  s_addc_u32 s9, s75, 0
  s_add_u32 s24, s76, s42
  s_addc_u32 s25, s77, 0
  s_cmp_eq_u32 s47, 0
  s_cbranch_scc0 L_role_odd
  s_lshl_b32 s48, s33, 10
  s_lshl_b32 s49, s46, 8
  s_add_u32 s48, s48, s49
  s_add_u32 s4, s78, s48
  s_addc_u32 s5, s79, 0
  s_sub_u32 s6, 0x400000, s48
  v_lshlrev_b32 v28, 2, v24
  v_xor_b32 v28, v28, v25
  v_lshlrev_b32 v28, 4, v28
  v_lshl_add_u32 v36, v24, 13, v28
  v_add_u32 v37, 31744, v36
  v_add_u32 v38, 63480, v36
  v_add_u32 v39, 95224, v36
  v_add_u32 v40, 131072, v36
  v_add_u32 v41, 162816, v36
  v_add_u32 v42, 194552, v36
  v_add_u32 v43, 226296, v36
  s_mul_i32 s53, s46, 8224
  s_mov_b32 s48, 0
  s_add_u32 m0, s53, 0
  s_nop 0
  buffer_load_dwordx4 v36, s[4:7], s48 offen lds
  buffer_load_dwordx4 v37, s[4:7], s48 offen offset:1024 lds
  buffer_load_dwordx4 v38, s[4:7], s48 offen offset:2056 lds
  buffer_load_dwordx4 v39, s[4:7], s48 offen offset:3080 lds
  s_add_u32 m0, s53, 4112
  s_nop 0
  buffer_load_dwordx4 v40, s[4:7], s48 offen lds
  buffer_load_dwordx4 v41, s[4:7], s48 offen offset:1024 lds
  buffer_load_dwordx4 v42, s[4:7], s48 offen offset:2056 lds
  buffer_load_dwordx4 v43, s[4:7], s48 offen offset:3080 lds
  s_mov_b32 s48, 512
  s_add_u32 m0, s53, 16448
  s_nop 0
  buffer_load_dwordx4 v36, s[4:7], s48 offen lds
  buffer_load_dwordx4 v37, s[4:7], s48 offen offset:1024 lds
  buffer_load_dwordx4 v38, s[4:7], s48 offen offset:2056 lds
  buffer_load_dwordx4 v39, s[4:7], s48 offen offset:3080 lds
  s_add_u32 m0, s53, 20560
  s_nop 0
  buffer_load_dwordx4 v40, s[4:7], s48 offen lds
  buffer_load_dwordx4 v41, s[4:7], s48 offen offset:1024 lds
  buffer_load_dwordx4 v42, s[4:7], s48 offen offset:2056 lds
  buffer_load_dwordx4 v43, s[4:7], s48 offen offset:3080 lds
  s_mov_b32 s52, 524288
  s_mov_b32 s97, 0
  s_branch L_role_done
L_role_odd:
  s_cmp_eq_u32 s30, 1
  s_cbranch_scc0 L_role_t
  s_mul_i32 s48, s43, 163840
  s_add_u32 s4, s72, s48
  s_addc_u32 s5, s73, 0
  s_mov_b32 s6, 163840
  v_and_b32 v28, 7, v0
  v_xor_b32 v28, v28, v24
  v_lshrrev_b32 v29, 3, v0
  v_lshlrev_b32 v29, 10, v29
  v_lshl_add_u32 v28, v28, 4, v29
  v_xor_b32 v29, 64, v28
  v_add_u32 v36, 0, v29
  v_add_u32 v37, 7168, v28
  v_add_u32 v38, 14336, v29
  v_add_u32 v39, 21504, v28
  v_add_u32 v40, 32768, v29
  v_add_u32 v44, 0, v28
  v_add_u32 v45, 7168, v29
  v_add_u32 v46, 14336, v28
  v_add_u32 v47, 21504, v29
  v_add_u32 v48, 32768, v28
  s_mov_b32 s48, 0
  s_mov_b32 m0, 135424
  s_nop 0
  buffer_load_dwordx4 v44, s[4:7], s48 offen lds
  buffer_load_dwordx4 v45, s[4:7], s48 offen offset:1024 lds
  buffer_load_dwordx4 v46, s[4:7], s48 offen offset:2048 lds
  buffer_load_dwordx4 v47, s[4:7], s48 offen offset:3072 lds
  s_mov_b32 m0, 139520
  s_nop 0
  buffer_load_dwordx4 v48, s[4:7], s48 offen lds
  s_mov_b32 s48, 40960
  s_mov_b32 m0, 140544
  s_nop 0
  buffer_load_dwordx4 v36, s[4:7], s48 offen lds
  buffer_load_dwordx4 v37, s[4:7], s48 offen offset:1024 lds
  buffer_load_dwordx4 v38, s[4:7], s48 offen offset:2048 lds
  buffer_load_dwordx4 v39, s[4:7], s48 offen offset:3072 lds
  s_mov_b32 m0, 144640
  s_nop 0
  buffer_load_dwordx4 v40, s[4:7], s48 offen lds
  s_mov_b32 s48, 81920
  s_mov_b32 m0, 145664
  s_nop 0
  buffer_load_dwordx4 v44, s[4:7], s48 offen lds
  buffer_load_dwordx4 v45, s[4:7], s48 offen offset:1024 lds
  buffer_load_dwordx4 v46, s[4:7], s48 offen offset:2048 lds
  buffer_load_dwordx4 v47, s[4:7], s48 offen offset:3072 lds
  s_mov_b32 m0, 149760
  s_nop 0
  buffer_load_dwordx4 v48, s[4:7], s48 offen lds
  s_mov_b32 s48, 122880
  s_mov_b32 m0, 150784
  s_nop 0
  buffer_load_dwordx4 v36, s[4:7], s48 offen lds
  buffer_load_dwordx4 v37, s[4:7], s48 offen offset:1024 lds
  buffer_load_dwordx4 v38, s[4:7], s48 offen offset:2048 lds
  buffer_load_dwordx4 v39, s[4:7], s48 offen offset:3072 lds
  s_mov_b32 m0, 154880
  s_nop 0
  buffer_load_dwordx4 v40, s[4:7], s48 offen lds
  s_mov_b32 s52, 128
  s_mov_b32 s53, 114944
  s_mov_b32 s97, 1
  s_branch L_role_done

L_qside:
L_role2_odd:
  s_cmp_eq_u32 s97, 1
  s_cbranch_scc0 L_role2_t
  s_mov_b32 s48, 128
  s_mov_b32 m0, 114944
  s_nop 0
  buffer_load_dwordx4 v44, s[4:7], s48 offen lds
  buffer_load_dwordx4 v45, s[4:7], s48 offen offset:1024 lds
  buffer_load_dwordx4 v46, s[4:7], s48 offen offset:2048 lds
  buffer_load_dwordx4 v47, s[4:7], s48 offen offset:3072 lds
  s_mov_b32 m0, 119040
  s_nop 0
  buffer_load_dwordx4 v48, s[4:7], s48 offen lds
  s_mov_b32 s48, 41088
  s_mov_b32 m0, 120064
  s_nop 0
  buffer_load_dwordx4 v36, s[4:7], s48 offen lds
  buffer_load_dwordx4 v37, s[4:7], s48 offen offset:1024 lds
  buffer_load_dwordx4 v38, s[4:7], s48 offen offset:2048 lds
  buffer_load_dwordx4 v39, s[4:7], s48 offen offset:3072 lds
  s_mov_b32 m0, 124160
  s_nop 0
  buffer_load_dwordx4 v40, s[4:7], s48 offen lds
  s_mov_b32 s48, 82048
  s_mov_b32 m0, 125184
  s_nop 0
  buffer_load_dwordx4 v44, s[4:7], s48 offen lds
  buffer_load_dwordx4 v45, s[4:7], s48 offen offset:1024 lds
  buffer_load_dwordx4 v46, s[4:7], s48 offen offset:2048 lds
  buffer_load_dwordx4 v47, s[4:7], s48 offen offset:3072 lds
  s_mov_b32 m0, 129280
  s_nop 0
  buffer_load_dwordx4 v48, s[4:7], s48 offen lds
  s_waitcnt vmcnt(15)
  s_branch L_role2_done
L_role2_t:
  s_lshl_b32 s48, s33, 10
  s_add_u32 s80, s78, s48
  s_addc_u32 s81, s79, 0
  s_sub_u32 s82, 0x400000, s48
  s_mov_b32 s83, 0x20000
  s_branch L_role2_done
L_pick:
  s_mov_b32 s48, 0
L_pick_l:
  s_add_u32 s48, s48, 1
  v_cmp_eq_u32 vcc, s48, v60
  s_nop 3
  s_cbranch_vccnz L_pick_l
  v_cmp_eq_u32 vcc, s48, v61
  s_nop 3
  s_cbranch_vccnz L_pick_l
  v_cmp_eq_u32 vcc, s48, v62
  s_nop 3
  s_cbranch_vccnz L_pick_l
  v_cmp_eq_u32 vcc, s48, v63
  s_nop 3
  s_cbranch_vccnz L_pick_l
  v_mov_b32 v60, s48
  v_mov_b32 v61, 0
  s_mov_b64 exec, 1
  global_store_dword v61, v60, s[28:29] sc1
  s_mov_b64 exec, -1
  s_nop 1
  s_branch L_picked
L_vswitch:
  s_cmp_eq_u32 s39, 1
  s_cbranch_scc0 L_vswitch2
  s_mov_b32 s6, 266240
  s_mov_b32 s52, s88
  s_mov_b32 s53, 65792
  s_mov_b32 s96, 4
  s_mov_b32 s58, 4096
  s_branch L_vswitched
L_vswitch2:
  s_sub_u32 s4, s24, 0x21000
  s_subb_u32 s5, s25, 0
  s_mov_b32 s6, 528384
  s_mov_b32 s58, 0
  s_mov_b32 s52, 24576
  s_mov_b32 s53, 155904
  v_lshlrev_b32 v24, 4, v0
  s_mov_b32 s54, 28672
  s_mov_b32 s55, 28672
  s_mov_b32 s56, 28672
  s_mov_b32 s57, 28672
  v_add_u32 v40, 4096, v24
  v_add_u32 v41, 10240, v24
  v_add_u32 v42, 16384, v24
  v_add_u32 v43, 22528, v24
  s_branch L_vswitched
L_qloopX:
  v_mfma_f32_16x16x32_bf16 v[96:99], a[160:163], a[192:195], v[96:99]
  s_barrier
  v_mfma_f32_16x16x32_bf16 v[104:107], a[160:163], a[196:199], v[104:107]
  ds_read_b64_tr_b16 a[248:249], v55 offset:16456
  v_mfma_f32_16x16x32_bf16 v[112:115], a[160:163], a[200:203], v[112:115]
  ds_read_b64_tr_b16 a[250:251], v55 offset:17480
  v_mfma_f32_16x16x32_bf16 v[120:123], a[160:163], a[204:207], v[120:123]
  s_add_u32 s48, s52, 122880
  s_add_u32 m0, s53, 15360
  ds_read_b128 a[212:215], v57 offset:0
  v_mfma_f32_16x16x32_bf16 v[128:131], a[160:163], a[208:211], v[128:131]
  buffer_load_dwordx4 v36, s[4:7], s48 offen lds
  v_mfma_f32_16x16x32_bf16 v[100:103], a[164:167], a[192:195], v[100:103]
  ds_read_b64_tr_b16 a[160:161], v52 offset:16448
  v_mfma_f32_16x16x32_bf16 v[108:111], a[164:167], a[196:199], v[108:111]
  ds_read_b64_tr_b16 a[162:163], v52 offset:17472
  v_mfma_f32_16x16x32_bf16 v[116:119], a[164:167], a[200:203], v[116:119]
  ds_read_b128 a[216:219], v57 offset:2048
  v_mfma_f32_16x16x32_bf16 v[124:127], a[164:167], a[204:207], v[124:127]
  ds_read_b128 a[220:223], v57 offset:4096
  v_mfma_f32_16x16x32_bf16 v[132:135], a[164:167], a[208:211], v[132:135]
  ds_read_b64_tr_b16 a[164:165], v52 offset:16456
  v_mfma_f32_16x16x32_bf16 v[136:139], a[168:171], a[192:195], v[136:139]
  ds_read_b64_tr_b16 a[166:167], v52 offset:17480
  v_mfma_f32_16x16x32_bf16 v[144:147], a[168:171], a[196:199], v[144:147]
  buffer_load_dwordx4 v37, s[4:7], s48 offen offset:1024 lds
  v_mfma_f32_16x16x32_bf16 v[152:155], a[168:171], a[200:203], v[152:155]
  ds_read_b128 a[224:227], v57 offset:6144
  v_mfma_f32_16x16x32_bf16 v[160:163], a[168:171], a[204:207], v[160:163]
  ds_read_b128 a[228:231], v57 offset:8192
  v_mfma_f32_16x16x32_bf16 v[168:171], a[168:171], a[208:211], v[168:171]
  ds_read_b64_tr_b16 a[168:169], v53 offset:16448
  v_mfma_f32_16x16x32_bf16 v[140:143], a[172:175], a[192:195], v[140:143]
  ds_read_b64_tr_b16 a[170:171], v53 offset:17472
  v_mfma_f32_16x16x32_bf16 v[148:151], a[172:175], a[196:199], v[148:151]
  ds_read_b64_tr_b16 a[252:253], v55 offset:16448
  v_mfma_f32_16x16x32_bf16 v[156:159], a[172:175], a[200:203], v[156:159]
  ds_read_b64_tr_b16 a[254:255], v55 offset:17472
  v_mfma_f32_16x16x32_bf16 v[164:167], a[172:175], a[204:207], v[164:167]
  buffer_load_dwordx4 v38, s[4:7], s48 offen offset:2048 lds
  v_mfma_f32_16x16x32_bf16 v[172:175], a[172:175], a[208:211], v[172:175]
  ds_read_b64_tr_b16 a[172:173], v53 offset:16456
  v_mfma_f32_16x16x32_bf16 v[176:179], a[176:179], a[192:195], v[176:179]
  ds_read_b64_tr_b16 a[174:175], v53 offset:17480
  v_mfma_f32_16x16x32_bf16 v[184:187], a[176:179], a[196:199], v[184:187]
  v_mfma_f32_16x16x32_bf16 v[192:195], a[176:179], a[200:203], v[192:195]
  v_mfma_f32_16x16x32_bf16 v[200:203], a[176:179], a[204:207], v[200:203]
  v_mfma_f32_16x16x32_bf16 v[208:211], a[176:179], a[208:211], v[208:211]
  ds_read_b64_tr_b16 a[176:177], v54 offset:16448
  v_mfma_f32_16x16x32_bf16 v[180:183], a[180:183], a[192:195], v[180:183]
  buffer_load_dwordx4 v39, s[4:7], s48 offen offset:3072 lds
  v_mfma_f32_16x16x32_bf16 v[188:191], a[180:183], a[196:199], v[188:191]
  ds_read_b64_tr_b16 a[178:179], v54 offset:17472
  v_mfma_f32_16x16x32_bf16 v[196:199], a[180:183], a[200:203], v[196:199]
  v_mfma_f32_16x16x32_bf16 v[204:207], a[180:183], a[204:207], v[204:207]
  v_mfma_f32_16x16x32_bf16 v[212:215], a[180:183], a[208:211], v[212:215]
  ds_read_b64_tr_b16 a[180:181], v54 offset:16456
  v_mfma_f32_16x16x32_bf16 v[216:219], a[184:187], a[192:195], v[216:219]
  ds_read_b64_tr_b16 a[182:183], v54 offset:17480
  v_mfma_f32_16x16x32_bf16 v[224:227], a[184:187], a[196:199], v[224:227]
  s_add_u32 m0, s53, 19456
  v_mfma_f32_16x16x32_bf16 v[232:235], a[184:187], a[200:203], v[232:235]
  buffer_load_dwordx4 v40, s[4:7], s48 offen lds
  v_mfma_f32_16x16x32_bf16 v[240:243], a[184:187], a[204:207], v[240:243]
  s_xor_b32 s53, s53, 249856
  s_add_u32 s52, s52, 128
  v_mfma_f32_16x16x32_bf16 v[248:251], a[184:187], a[208:211], v[248:251]
  v_mfma_f32_16x16x32_bf16 v[220:223], a[188:191], a[192:195], v[220:223]
  v_mfma_f32_16x16x32_bf16 v[228:231], a[188:191], a[196:199], v[228:231]
  s_cmp_eq_u32 s39, 6
  s_cselect_b32 s6, 0, s6
  v_mfma_f32_16x16x32_bf16 v[236:239], a[188:191], a[200:203], v[236:239]
  v_mfma_f32_16x16x32_bf16 v[244:247], a[188:191], a[204:207], v[244:247]
  s_waitcnt lgkmcnt(0)
  v_mfma_f32_16x16x32_bf16 v[252:255], a[188:191], a[208:211], v[252:255]
  v_mfma_f32_16x16x32_bf16 a[0:3], a[160:163], a[192:195], a[0:3]
  s_barrier
  v_mfma_f32_16x16x32_bf16 a[8:11], a[160:163], a[196:199], a[8:11]
  ds_read_b64_tr_b16 a[188:189], v55 offset:32904
  v_mfma_f32_16x16x32_bf16 a[16:19], a[160:163], a[200:203], a[16:19]
  ds_read_b64_tr_b16 a[190:191], v55 offset:33928
  v_mfma_f32_16x16x32_bf16 a[24:27], a[160:163], a[204:207], a[24:27]
  s_add_u32 s48, s52, 0
  s_add_u32 m0, s53, 0
  ds_read_b64_tr_b16 a[184:185], v55 offset:32896
  v_mfma_f32_16x16x32_bf16 a[32:35], a[160:163], a[208:211], a[32:35]
  buffer_load_dwordx4 v44, s[4:7], s48 offen lds
  v_mfma_f32_16x16x32_bf16 a[4:7], a[164:167], a[192:195], a[4:7]
  ds_read_b64_tr_b16 a[160:161], v52 offset:32896
  v_mfma_f32_16x16x32_bf16 a[12:15], a[164:167], a[196:199], a[12:15]
  ds_read_b64_tr_b16 a[162:163], v52 offset:33920
  v_mfma_f32_16x16x32_bf16 a[20:23], a[164:167], a[200:203], a[20:23]
  ds_read_b64_tr_b16 a[186:187], v55 offset:33920
  v_mfma_f32_16x16x32_bf16 a[28:31], a[164:167], a[204:207], a[28:31]
  v_mfma_f32_16x16x32_bf16 a[36:39], a[164:167], a[208:211], a[36:39]
  ds_read_b64_tr_b16 a[164:165], v52 offset:32904
  v_mfma_f32_16x16x32_bf16 a[40:43], a[168:171], a[192:195], a[40:43]
  ds_read_b64_tr_b16 a[166:167], v52 offset:33928
  v_mfma_f32_16x16x32_bf16 a[48:51], a[168:171], a[196:199], a[48:51]
  buffer_load_dwordx4 v45, s[4:7], s48 offen offset:1024 lds
  v_mfma_f32_16x16x32_bf16 a[56:59], a[168:171], a[200:203], a[56:59]
  v_mfma_f32_16x16x32_bf16 a[64:67], a[168:171], a[204:207], a[64:67]
  v_mfma_f32_16x16x32_bf16 a[72:75], a[168:171], a[208:211], a[72:75]
  ds_read_b64_tr_b16 a[168:169], v53 offset:32896
  v_mfma_f32_16x16x32_bf16 a[44:47], a[172:175], a[192:195], a[44:47]
  ds_read_b64_tr_b16 a[170:171], v53 offset:33920
  v_mfma_f32_16x16x32_bf16 a[52:55], a[172:175], a[196:199], a[52:55]
  v_mfma_f32_16x16x32_bf16 a[60:63], a[172:175], a[200:203], a[60:63]
  v_mfma_f32_16x16x32_bf16 a[68:71], a[172:175], a[204:207], a[68:71]
  buffer_load_dwordx4 v46, s[4:7], s48 offen offset:2048 lds
  v_mfma_f32_16x16x32_bf16 a[76:79], a[172:175], a[208:211], a[76:79]
  ds_read_b64_tr_b16 a[172:173], v53 offset:32904
  v_mfma_f32_16x16x32_bf16 a[80:83], a[176:179], a[192:195], a[80:83]
  ds_read_b64_tr_b16 a[174:175], v53 offset:33928
  v_mfma_f32_16x16x32_bf16 a[88:91], a[176:179], a[196:199], a[88:91]
  v_mfma_f32_16x16x32_bf16 a[96:99], a[176:179], a[200:203], a[96:99]
  v_mfma_f32_16x16x32_bf16 a[104:107], a[176:179], a[204:207], a[104:107]
  v_mfma_f32_16x16x32_bf16 a[112:115], a[176:179], a[208:211], a[112:115]
  ds_read_b64_tr_b16 a[176:177], v54 offset:32896
  v_mfma_f32_16x16x32_bf16 a[84:87], a[180:183], a[192:195], a[84:87]
  buffer_load_dwordx4 v47, s[4:7], s48 offen offset:3072 lds
  v_mfma_f32_16x16x32_bf16 a[92:95], a[180:183], a[196:199], a[92:95]
  ds_read_b64_tr_b16 a[178:179], v54 offset:33920
  v_mfma_f32_16x16x32_bf16 a[100:103], a[180:183], a[200:203], a[100:103]
  v_mfma_f32_16x16x32_bf16 a[108:111], a[180:183], a[204:207], a[108:111]
  v_mfma_f32_16x16x32_bf16 a[116:119], a[180:183], a[208:211], a[116:119]
  ds_read_b64_tr_b16 a[180:181], v54 offset:32904
  v_mfma_f32_16x16x32_bf16 a[120:123], a[252:255], a[192:195], a[120:123]
  ds_read_b64_tr_b16 a[182:183], v54 offset:33928
  v_mfma_f32_16x16x32_bf16 a[128:131], a[252:255], a[196:199], a[128:131]
  s_add_u32 m0, s53, 4096
  v_mfma_f32_16x16x32_bf16 a[136:139], a[252:255], a[200:203], a[136:139]
  buffer_load_dwordx4 v48, s[4:7], s48 offen lds
  v_mfma_f32_16x16x32_bf16 a[144:147], a[252:255], a[204:207], a[144:147]
  v_mfma_f32_16x16x32_bf16 a[152:155], a[252:255], a[208:211], a[152:155]
  v_add_u32 v56, s92, v56
  v_mfma_f32_16x16x32_bf16 a[124:127], a[248:251], a[192:195], a[124:127]
  v_add_u32 v57, s92, v57
  v_mfma_f32_16x16x32_bf16 a[132:135], a[248:251], a[196:199], a[132:135]
  s_sub_u32 s92, 0, s92
  v_mfma_f32_16x16x32_bf16 a[140:143], a[248:251], a[200:203], a[140:143]
  v_mfma_f32_16x16x32_bf16 a[148:151], a[248:251], a[204:207], a[148:151]
  s_waitcnt lgkmcnt(0)
  v_mfma_f32_16x16x32_bf16 a[156:159], a[248:251], a[208:211], a[156:159]
  v_mfma_f32_16x16x32_bf16 v[96:99], a[160:163], a[212:215], v[96:99]
  s_barrier
  v_mfma_f32_16x16x32_bf16 v[104:107], a[160:163], a[216:219], v[104:107]
  ds_read_b64_tr_b16 a[248:249], v55 offset:49352
  v_mfma_f32_16x16x32_bf16 v[112:115], a[160:163], a[220:223], v[112:115]
  ds_read_b64_tr_b16 a[250:251], v55 offset:50376
  v_mfma_f32_16x16x32_bf16 v[120:123], a[160:163], a[224:227], v[120:123]
  s_add_u32 s48, s52, 40960
  s_add_u32 m0, s53, 5120
  ds_read_b64_tr_b16 a[252:253], v55 offset:49344
  v_mfma_f32_16x16x32_bf16 v[128:131], a[160:163], a[228:231], v[128:131]
  buffer_load_dwordx4 v36, s[4:7], s48 offen lds
  v_mfma_f32_16x16x32_bf16 v[100:103], a[164:167], a[212:215], v[100:103]
  ds_read_b64_tr_b16 a[160:161], v52 offset:49344
  v_mfma_f32_16x16x32_bf16 v[108:111], a[164:167], a[216:219], v[108:111]
  ds_read_b64_tr_b16 a[162:163], v52 offset:50368
  v_mfma_f32_16x16x32_bf16 v[116:119], a[164:167], a[220:223], v[116:119]
  ds_read_b64_tr_b16 a[254:255], v55 offset:50368
  v_mfma_f32_16x16x32_bf16 v[124:127], a[164:167], a[224:227], v[124:127]
  v_mfma_f32_16x16x32_bf16 v[132:135], a[164:167], a[228:231], v[132:135]
  ds_read_b64_tr_b16 a[164:165], v52 offset:49352
  v_mfma_f32_16x16x32_bf16 v[136:139], a[168:171], a[212:215], v[136:139]
  ds_read_b64_tr_b16 a[166:167], v52 offset:50376
  v_mfma_f32_16x16x32_bf16 v[144:147], a[168:171], a[216:219], v[144:147]
  buffer_load_dwordx4 v37, s[4:7], s48 offen offset:1024 lds
  v_mfma_f32_16x16x32_bf16 v[152:155], a[168:171], a[220:223], v[152:155]
  v_mfma_f32_16x16x32_bf16 v[160:163], a[168:171], a[224:227], v[160:163]
  v_mfma_f32_16x16x32_bf16 v[168:171], a[168:171], a[228:231], v[168:171]
  ds_read_b64_tr_b16 a[168:169], v53 offset:49344
  v_mfma_f32_16x16x32_bf16 v[140:143], a[172:175], a[212:215], v[140:143]
  ds_read_b64_tr_b16 a[170:171], v53 offset:50368
  v_mfma_f32_16x16x32_bf16 v[148:151], a[172:175], a[216:219], v[148:151]
  v_mfma_f32_16x16x32_bf16 v[156:159], a[172:175], a[220:223], v[156:159]
  v_mfma_f32_16x16x32_bf16 v[164:167], a[172:175], a[224:227], v[164:167]
  buffer_load_dwordx4 v38, s[4:7], s48 offen offset:2048 lds
  v_mfma_f32_16x16x32_bf16 v[172:175], a[172:175], a[228:231], v[172:175]
  ds_read_b64_tr_b16 a[172:173], v53 offset:49352
  v_mfma_f32_16x16x32_bf16 v[176:179], a[176:179], a[212:215], v[176:179]
  ds_read_b64_tr_b16 a[174:175], v53 offset:50376
  v_mfma_f32_16x16x32_bf16 v[184:187], a[176:179], a[216:219], v[184:187]
  v_mfma_f32_16x16x32_bf16 v[192:195], a[176:179], a[220:223], v[192:195]
  v_mfma_f32_16x16x32_bf16 v[200:203], a[176:179], a[224:227], v[200:203]
  v_mfma_f32_16x16x32_bf16 v[208:211], a[176:179], a[228:231], v[208:211]
  ds_read_b64_tr_b16 a[176:177], v54 offset:49344
  v_mfma_f32_16x16x32_bf16 v[180:183], a[180:183], a[212:215], v[180:183]
  buffer_load_dwordx4 v39, s[4:7], s48 offen offset:3072 lds
  v_mfma_f32_16x16x32_bf16 v[188:191], a[180:183], a[216:219], v[188:191]
  ds_read_b64_tr_b16 a[178:179], v54 offset:50368
  v_mfma_f32_16x16x32_bf16 v[196:199], a[180:183], a[220:223], v[196:199]
  v_mfma_f32_16x16x32_bf16 v[204:207], a[180:183], a[224:227], v[204:207]
  v_mfma_f32_16x16x32_bf16 v[212:215], a[180:183], a[228:231], v[212:215]
  ds_read_b64_tr_b16 a[180:181], v54 offset:49352
  v_mfma_f32_16x16x32_bf16 v[216:219], a[184:187], a[212:215], v[216:219]
  ds_read_b64_tr_b16 a[182:183], v54 offset:50376
  v_mfma_f32_16x16x32_bf16 v[224:227], a[184:187], a[216:219], v[224:227]
  s_add_u32 m0, s53, 9216
  v_mfma_f32_16x16x32_bf16 v[232:235], a[184:187], a[220:223], v[232:235]
  buffer_load_dwordx4 v40, s[4:7], s48 offen lds
  v_mfma_f32_16x16x32_bf16 v[240:243], a[184:187], a[224:227], v[240:243]
  v_mfma_f32_16x16x32_bf16 v[248:251], a[184:187], a[228:231], v[248:251]
  v_mfma_f32_16x16x32_bf16 v[220:223], a[188:191], a[212:215], v[220:223]
  v_mfma_f32_16x16x32_bf16 v[228:231], a[188:191], a[216:219], v[228:231]
  v_mfma_f32_16x16x32_bf16 v[236:239], a[188:191], a[220:223], v[236:239]
  v_mfma_f32_16x16x32_bf16 v[244:247], a[188:191], a[224:227], v[244:247]
  s_waitcnt lgkmcnt(0)
  v_mfma_f32_16x16x32_bf16 v[252:255], a[188:191], a[228:231], v[252:255]
  v_mfma_f32_16x16x32_bf16 a[0:3], a[160:163], a[212:215], a[0:3]
  s_waitcnt vmcnt(10)
  s_barrier
  v_mfma_f32_16x16x32_bf16 a[8:11], a[160:163], a[216:219], a[8:11]
  ds_read_b64_tr_b16 a[188:189], v55 offset:8
  v_mfma_f32_16x16x32_bf16 a[16:19], a[160:163], a[220:223], a[16:19]
  ds_read_b64_tr_b16 a[190:191], v55 offset:1032
  v_mfma_f32_16x16x32_bf16 a[24:27], a[160:163], a[224:227], a[24:27]
  s_add_u32 s48, s52, 81920
  s_add_u32 m0, s53, 10240
  ds_read_b128 a[192:195], v56 offset:0
  v_mfma_f32_16x16x32_bf16 a[32:35], a[160:163], a[228:231], a[32:35]
  buffer_load_dwordx4 v44, s[4:7], s48 offen lds
  v_mfma_f32_16x16x32_bf16 a[4:7], a[164:167], a[212:215], a[4:7]
  ds_read_b64_tr_b16 a[160:161], v52 offset:0
  v_mfma_f32_16x16x32_bf16 a[12:15], a[164:167], a[216:219], a[12:15]
  ds_read_b64_tr_b16 a[162:163], v52 offset:1024
  v_mfma_f32_16x16x32_bf16 a[20:23], a[164:167], a[220:223], a[20:23]
  ds_read_b128 a[196:199], v56 offset:2048
  v_mfma_f32_16x16x32_bf16 a[28:31], a[164:167], a[224:227], a[28:31]
  ds_read_b128 a[200:203], v56 offset:4096
  v_mfma_f32_16x16x32_bf16 a[36:39], a[164:167], a[228:231], a[36:39]
  ds_read_b64_tr_b16 a[164:165], v52 offset:8
  v_mfma_f32_16x16x32_bf16 a[40:43], a[168:171], a[212:215], a[40:43]
  ds_read_b64_tr_b16 a[166:167], v52 offset:1032
  v_mfma_f32_16x16x32_bf16 a[48:51], a[168:171], a[216:219], a[48:51]
  buffer_load_dwordx4 v45, s[4:7], s48 offen offset:1024 lds
  v_mfma_f32_16x16x32_bf16 a[56:59], a[168:171], a[220:223], a[56:59]
  ds_read_b128 a[204:207], v56 offset:6144
  v_mfma_f32_16x16x32_bf16 a[64:67], a[168:171], a[224:227], a[64:67]
  ds_read_b128 a[208:211], v56 offset:8192
  v_mfma_f32_16x16x32_bf16 a[72:75], a[168:171], a[228:231], a[72:75]
  ds_read_b64_tr_b16 a[168:169], v53 offset:0
  v_mfma_f32_16x16x32_bf16 a[44:47], a[172:175], a[212:215], a[44:47]
  ds_read_b64_tr_b16 a[170:171], v53 offset:1024
  v_mfma_f32_16x16x32_bf16 a[52:55], a[172:175], a[216:219], a[52:55]
  ds_read_b64_tr_b16 a[184:185], v55 offset:0
  v_mfma_f32_16x16x32_bf16 a[60:63], a[172:175], a[220:223], a[60:63]
  ds_read_b64_tr_b16 a[186:187], v55 offset:1024
  v_mfma_f32_16x16x32_bf16 a[68:71], a[172:175], a[224:227], a[68:71]
  buffer_load_dwordx4 v46, s[4:7], s48 offen offset:2048 lds
  v_mfma_f32_16x16x32_bf16 a[76:79], a[172:175], a[228:231], a[76:79]
  ds_read_b64_tr_b16 a[172:173], v53 offset:8
  v_mfma_f32_16x16x32_bf16 a[80:83], a[176:179], a[212:215], a[80:83]
  ds_read_b64_tr_b16 a[174:175], v53 offset:1032
  v_mfma_f32_16x16x32_bf16 a[88:91], a[176:179], a[216:219], a[88:91]
  v_mfma_f32_16x16x32_bf16 a[96:99], a[176:179], a[220:223], a[96:99]
  v_mfma_f32_16x16x32_bf16 a[104:107], a[176:179], a[224:227], a[104:107]
  v_mfma_f32_16x16x32_bf16 a[112:115], a[176:179], a[228:231], a[112:115]
  ds_read_b64_tr_b16 a[176:177], v54 offset:0
  v_mfma_f32_16x16x32_bf16 a[84:87], a[180:183], a[212:215], a[84:87]
  buffer_load_dwordx4 v47, s[4:7], s48 offen offset:3072 lds
  v_mfma_f32_16x16x32_bf16 a[92:95], a[180:183], a[216:219], a[92:95]
  ds_read_b64_tr_b16 a[178:179], v54 offset:1024
  v_mfma_f32_16x16x32_bf16 a[100:103], a[180:183], a[220:223], a[100:103]
  v_mfma_f32_16x16x32_bf16 a[108:111], a[180:183], a[224:227], a[108:111]
  v_mfma_f32_16x16x32_bf16 a[116:119], a[180:183], a[228:231], a[116:119]
  ds_read_b64_tr_b16 a[180:181], v54 offset:8
  v_mfma_f32_16x16x32_bf16 a[120:123], a[252:255], a[212:215], a[120:123]
  ds_read_b64_tr_b16 a[182:183], v54 offset:1032
  v_mfma_f32_16x16x32_bf16 a[128:131], a[252:255], a[216:219], a[128:131]
  s_add_u32 m0, s53, 14336
  v_mfma_f32_16x16x32_bf16 a[136:139], a[252:255], a[220:223], a[136:139]
  buffer_load_dwordx4 v48, s[4:7], s48 offen lds
  v_mfma_f32_16x16x32_bf16 a[144:147], a[252:255], a[224:227], a[144:147]
  v_mfma_f32_16x16x32_bf16 a[152:155], a[252:255], a[228:231], a[152:155]
  v_mfma_f32_16x16x32_bf16 a[124:127], a[248:251], a[212:215], a[124:127]
  s_add_u32 s39, s39, 1
  v_mfma_f32_16x16x32_bf16 a[132:135], a[248:251], a[216:219], a[132:135]
  v_mfma_f32_16x16x32_bf16 a[140:143], a[248:251], a[220:223], a[140:143]
  s_cmp_lt_u32 s39, 7
  v_mfma_f32_16x16x32_bf16 a[148:151], a[248:251], a[224:227], a[148:151]
  s_waitcnt lgkmcnt(0)
  v_mfma_f32_16x16x32_bf16 a[156:159], a[248:251], a[228:231], a[156:159]
  s_cbranch_scc1 L_qloopX
  s_branch L_qswap
L_qloopT:
  v_mfma_f32_16x16x32_bf16 v[96:99], a[160:163], a[192:195], v[96:99]
  s_waitcnt vmcnt(45)
  s_barrier
  v_mfma_f32_16x16x32_bf16 v[104:107], a[160:163], a[196:199], v[104:107]
  ds_read_b64_tr_b16 a[248:249], v55 offset:16456
  v_mfma_f32_16x16x32_bf16 v[112:115], a[160:163], a[200:203], v[112:115]
  s_mov_b32 m0, 155904
  ds_read_b64_tr_b16 a[250:251], v55 offset:17480
  v_mfma_f32_16x16x32_bf16 v[120:123], a[160:163], a[204:207], v[120:123]
  buffer_load_dwordx4 v36, s[12:15], s35 offen lds
  v_mfma_f32_16x16x32_bf16 v[128:131], a[160:163], a[208:211], v[128:131]
  ds_read_b64_tr_b16 a[160:161], v52 offset:16448
  v_mfma_f32_16x16x32_bf16 v[100:103], a[164:167], a[192:195], v[100:103]
  ds_read_b64_tr_b16 a[162:163], v52 offset:17472
  v_mfma_f32_16x16x32_bf16 v[108:111], a[164:167], a[196:199], v[108:111]
  ds_read_b128 a[212:215], v57 offset:0
  v_mfma_f32_16x16x32_bf16 v[116:119], a[164:167], a[200:203], v[116:119]
  ds_read_b128 a[216:219], v57 offset:2048
  v_mfma_f32_16x16x32_bf16 v[124:127], a[164:167], a[204:207], v[124:127]
  ds_read_b128 a[220:223], v57 offset:4096
  v_mfma_f32_16x16x32_bf16 v[132:135], a[164:167], a[208:211], v[132:135]
  s_add_u32 s35, s35, 512
  s_mov_b32 m0, s53
  ds_read_b64_tr_b16 a[164:165], v52 offset:16456
  v_mfma_f32_16x16x32_bf16 v[136:139], a[168:171], a[192:195], v[136:139]
  buffer_load_dwordx4 v40, s[4:7], s52 offen lds
  v_mfma_f32_16x16x32_bf16 v[144:147], a[168:171], a[196:199], v[144:147]
  ds_read_b64_tr_b16 a[166:167], v52 offset:17480
  v_mfma_f32_16x16x32_bf16 v[152:155], a[168:171], a[200:203], v[152:155]
  ds_read_b128 a[224:227], v57 offset:6144
  v_mfma_f32_16x16x32_bf16 v[160:163], a[168:171], a[204:207], v[160:163]
  ds_read_b128 a[228:231], v57 offset:8192
  v_mfma_f32_16x16x32_bf16 v[168:171], a[168:171], a[208:211], v[168:171]
  ds_read_b64_tr_b16 a[168:169], v53 offset:16448
  v_mfma_f32_16x16x32_bf16 v[140:143], a[172:175], a[192:195], v[140:143]
  ds_read_b64_tr_b16 a[170:171], v53 offset:17472
  v_mfma_f32_16x16x32_bf16 v[148:151], a[172:175], a[196:199], v[148:151]
  ds_read_b64_tr_b16 a[252:253], v55 offset:16448
  v_mfma_f32_16x16x32_bf16 v[156:159], a[172:175], a[200:203], v[156:159]
  buffer_load_dwordx4 v41, s[4:7], s52 offen offset:1024 lds
  v_mfma_f32_16x16x32_bf16 v[164:167], a[172:175], a[204:207], v[164:167]
  ds_read_b64_tr_b16 a[254:255], v55 offset:17472
  v_mfma_f32_16x16x32_bf16 v[172:175], a[172:175], a[208:211], v[172:175]
  ds_read_b64_tr_b16 a[172:173], v53 offset:16456
  v_mfma_f32_16x16x32_bf16 v[176:179], a[176:179], a[192:195], v[176:179]
  ds_read_b64_tr_b16 a[174:175], v53 offset:17480
  v_mfma_f32_16x16x32_bf16 v[184:187], a[176:179], a[196:199], v[184:187]
  v_mfma_f32_16x16x32_bf16 v[192:195], a[176:179], a[200:203], v[192:195]
  v_mfma_f32_16x16x32_bf16 v[200:203], a[176:179], a[204:207], v[200:203]
  v_mfma_f32_16x16x32_bf16 v[208:211], a[176:179], a[208:211], v[208:211]
  buffer_load_dwordx4 v42, s[4:7], s52 offen offset:2048 lds
  v_mfma_f32_16x16x32_bf16 v[180:183], a[180:183], a[192:195], v[180:183]
  ds_read_b64_tr_b16 a[176:177], v54 offset:16448
  v_mfma_f32_16x16x32_bf16 v[188:191], a[180:183], a[196:199], v[188:191]
  ds_read_b64_tr_b16 a[178:179], v54 offset:17472
  v_mfma_f32_16x16x32_bf16 v[196:199], a[180:183], a[200:203], v[196:199]
  v_mfma_f32_16x16x32_bf16 v[204:207], a[180:183], a[204:207], v[204:207]
  v_mfma_f32_16x16x32_bf16 v[212:215], a[180:183], a[208:211], v[212:215]
  ds_read_b64_tr_b16 a[180:181], v54 offset:16456
  v_mfma_f32_16x16x32_bf16 v[216:219], a[184:187], a[192:195], v[216:219]
  ds_read_b64_tr_b16 a[182:183], v54 offset:17480
  v_mfma_f32_16x16x32_bf16 v[224:227], a[184:187], a[196:199], v[224:227]
  buffer_load_dwordx4 v43, s[4:7], s52 offen offset:3072 lds
  v_mfma_f32_16x16x32_bf16 v[232:235], a[184:187], a[200:203], v[232:235]
  s_add_u32 s52, s52, s54
  s_add_u32 s53, s53, s58
  v_mfma_f32_16x16x32_bf16 v[240:243], a[184:187], a[204:207], v[240:243]
  v_mfma_f32_16x16x32_bf16 v[248:251], a[184:187], a[208:211], v[248:251]
  v_mfma_f32_16x16x32_bf16 v[220:223], a[188:191], a[192:195], v[220:223]
  v_mfma_f32_16x16x32_bf16 v[228:231], a[188:191], a[196:199], v[228:231]
  v_mfma_f32_16x16x32_bf16 v[236:239], a[188:191], a[200:203], v[236:239]
  v_mfma_f32_16x16x32_bf16 v[244:247], a[188:191], a[204:207], v[244:247]
  s_waitcnt lgkmcnt(0)
  v_mfma_f32_16x16x32_bf16 v[252:255], a[188:191], a[208:211], v[252:255]
  v_mfma_f32_16x16x32_bf16 a[0:3], a[160:163], a[192:195], a[0:3]
  s_waitcnt vmcnt(45)
  s_barrier
  v_mfma_f32_16x16x32_bf16 a[8:11], a[160:163], a[196:199], a[8:11]
  ds_read_b64_tr_b16 a[188:189], v55 offset:32904
  v_mfma_f32_16x16x32_bf16 a[16:19], a[160:163], a[200:203], a[16:19]
  s_mov_b32 m0, 155904
  ds_read_b64_tr_b16 a[190:191], v55 offset:33928
  v_mfma_f32_16x16x32_bf16 a[24:27], a[160:163], a[204:207], a[24:27]
  buffer_load_dwordx4 v36, s[12:15], s35 offen lds
  v_mfma_f32_16x16x32_bf16 a[32:35], a[160:163], a[208:211], a[32:35]
  ds_read_b64_tr_b16 a[160:161], v52 offset:32896
  v_mfma_f32_16x16x32_bf16 a[4:7], a[164:167], a[192:195], a[4:7]
  ds_read_b64_tr_b16 a[162:163], v52 offset:33920
  v_mfma_f32_16x16x32_bf16 a[12:15], a[164:167], a[196:199], a[12:15]
  ds_read_b64_tr_b16 a[184:185], v55 offset:32896
  v_mfma_f32_16x16x32_bf16 a[20:23], a[164:167], a[200:203], a[20:23]
  ds_read_b64_tr_b16 a[186:187], v55 offset:33920
  v_mfma_f32_16x16x32_bf16 a[28:31], a[164:167], a[204:207], a[28:31]
  v_mfma_f32_16x16x32_bf16 a[36:39], a[164:167], a[208:211], a[36:39]
  s_add_u32 s35, s35, 261632
  s_mov_b32 m0, s53
  ds_read_b64_tr_b16 a[164:165], v52 offset:32904
  v_mfma_f32_16x16x32_bf16 a[40:43], a[168:171], a[192:195], a[40:43]
  buffer_load_dwordx4 v40, s[4:7], s52 offen lds
  v_mfma_f32_16x16x32_bf16 a[48:51], a[168:171], a[196:199], a[48:51]
  ds_read_b64_tr_b16 a[166:167], v52 offset:33928
  v_mfma_f32_16x16x32_bf16 a[56:59], a[168:171], a[200:203], a[56:59]
  v_mfma_f32_16x16x32_bf16 a[64:67], a[168:171], a[204:207], a[64:67]
  v_mfma_f32_16x16x32_bf16 a[72:75], a[168:171], a[208:211], a[72:75]
  ds_read_b64_tr_b16 a[168:169], v53 offset:32896
  v_mfma_f32_16x16x32_bf16 a[44:47], a[172:175], a[192:195], a[44:47]
  ds_read_b64_tr_b16 a[170:171], v53 offset:33920
  v_mfma_f32_16x16x32_bf16 a[52:55], a[172:175], a[196:199], a[52:55]
  v_mfma_f32_16x16x32_bf16 a[60:63], a[172:175], a[200:203], a[60:63]
  buffer_load_dwordx4 v41, s[4:7], s52 offen offset:1024 lds
  v_mfma_f32_16x16x32_bf16 a[68:71], a[172:175], a[204:207], a[68:71]
  v_mfma_f32_16x16x32_bf16 a[76:79], a[172:175], a[208:211], a[76:79]
  ds_read_b64_tr_b16 a[172:173], v53 offset:32904
  v_mfma_f32_16x16x32_bf16 a[80:83], a[176:179], a[192:195], a[80:83]
  ds_read_b64_tr_b16 a[174:175], v53 offset:33928
  v_mfma_f32_16x16x32_bf16 a[88:91], a[176:179], a[196:199], a[88:91]
  v_mfma_f32_16x16x32_bf16 a[96:99], a[176:179], a[200:203], a[96:99]
  v_mfma_f32_16x16x32_bf16 a[104:107], a[176:179], a[204:207], a[104:107]
  v_mfma_f32_16x16x32_bf16 a[112:115], a[176:179], a[208:211], a[112:115]
  buffer_load_dwordx4 v42, s[4:7], s52 offen offset:2048 lds
  v_mfma_f32_16x16x32_bf16 a[84:87], a[180:183], a[192:195], a[84:87]
  ds_read_b64_tr_b16 a[176:177], v54 offset:32896
  v_mfma_f32_16x16x32_bf16 a[92:95], a[180:183], a[196:199], a[92:95]
  ds_read_b64_tr_b16 a[178:179], v54 offset:33920
  v_mfma_f32_16x16x32_bf16 a[100:103], a[180:183], a[200:203], a[100:103]
  v_mfma_f32_16x16x32_bf16 a[108:111], a[180:183], a[204:207], a[108:111]
  v_mfma_f32_16x16x32_bf16 a[116:119], a[180:183], a[208:211], a[116:119]
  ds_read_b64_tr_b16 a[180:181], v54 offset:32904
  v_mfma_f32_16x16x32_bf16 a[120:123], a[252:255], a[192:195], a[120:123]
  ds_read_b64_tr_b16 a[182:183], v54 offset:33928
  v_mfma_f32_16x16x32_bf16 a[128:131], a[252:255], a[196:199], a[128:131]
  buffer_load_dwordx4 v43, s[4:7], s52 offen offset:3072 lds
  v_mfma_f32_16x16x32_bf16 a[136:139], a[252:255], a[200:203], a[136:139]
  s_add_u32 s52, s52, s55
  s_add_u32 s53, s53, s58
  v_mfma_f32_16x16x32_bf16 a[144:147], a[252:255], a[204:207], a[144:147]
  v_mfma_f32_16x16x32_bf16 a[152:155], a[252:255], a[208:211], a[152:155]
  v_add_u32 v56, s92, v56
  v_mfma_f32_16x16x32_bf16 a[124:127], a[248:251], a[192:195], a[124:127]
  v_add_u32 v57, s92, v57
  v_mfma_f32_16x16x32_bf16 a[132:135], a[248:251], a[196:199], a[132:135]
  s_sub_u32 s92, 0, s92
  v_mfma_f32_16x16x32_bf16 a[140:143], a[248:251], a[200:203], a[140:143]
  v_mfma_f32_16x16x32_bf16 a[148:151], a[248:251], a[204:207], a[148:151]
  s_waitcnt lgkmcnt(0)
  v_mfma_f32_16x16x32_bf16 a[156:159], a[248:251], a[208:211], a[156:159]
  v_mfma_f32_16x16x32_bf16 v[96:99], a[160:163], a[212:215], v[96:99]
  s_waitcnt vmcnt(45)
  s_barrier
  v_mfma_f32_16x16x32_bf16 v[104:107], a[160:163], a[216:219], v[104:107]
  ds_read_b64_tr_b16 a[248:249], v55 offset:49352
  v_mfma_f32_16x16x32_bf16 v[112:115], a[160:163], a[220:223], v[112:115]
  s_mov_b32 m0, 155904
  ds_read_b64_tr_b16 a[250:251], v55 offset:50376
  v_mfma_f32_16x16x32_bf16 v[120:123], a[160:163], a[224:227], v[120:123]
  buffer_load_dwordx4 v36, s[12:15], s35 offen lds
  v_mfma_f32_16x16x32_bf16 v[128:131], a[160:163], a[228:231], v[128:131]
  ds_read_b64_tr_b16 a[160:161], v52 offset:49344
  v_mfma_f32_16x16x32_bf16 v[100:103], a[164:167], a[212:215], v[100:103]
  ds_read_b64_tr_b16 a[162:163], v52 offset:50368
  v_mfma_f32_16x16x32_bf16 v[108:111], a[164:167], a[216:219], v[108:111]
  ds_read_b64_tr_b16 a[252:253], v55 offset:49344
  v_mfma_f32_16x16x32_bf16 v[116:119], a[164:167], a[220:223], v[116:119]
  ds_read_b64_tr_b16 a[254:255], v55 offset:50368
  v_mfma_f32_16x16x32_bf16 v[124:127], a[164:167], a[224:227], v[124:127]
  v_mfma_f32_16x16x32_bf16 v[132:135], a[164:167], a[228:231], v[132:135]
  s_add_u32 s35, s35, 512
  s_mov_b32 m0, s53
  ds_read_b64_tr_b16 a[164:165], v52 offset:49352
  v_mfma_f32_16x16x32_bf16 v[136:139], a[168:171], a[212:215], v[136:139]
  buffer_load_dwordx4 v40, s[4:7], s52 offen lds
  v_mfma_f32_16x16x32_bf16 v[144:147], a[168:171], a[216:219], v[144:147]
  ds_read_b64_tr_b16 a[166:167], v52 offset:50376
  v_mfma_f32_16x16x32_bf16 v[152:155], a[168:171], a[220:223], v[152:155]
  v_mfma_f32_16x16x32_bf16 v[160:163], a[168:171], a[224:227], v[160:163]
  v_mfma_f32_16x16x32_bf16 v[168:171], a[168:171], a[228:231], v[168:171]
  ds_read_b64_tr_b16 a[168:169], v53 offset:49344
  v_mfma_f32_16x16x32_bf16 v[140:143], a[172:175], a[212:215], v[140:143]
  ds_read_b64_tr_b16 a[170:171], v53 offset:50368
  v_mfma_f32_16x16x32_bf16 v[148:151], a[172:175], a[216:219], v[148:151]
  v_mfma_f32_16x16x32_bf16 v[156:159], a[172:175], a[220:223], v[156:159]
  buffer_load_dwordx4 v41, s[4:7], s52 offen offset:1024 lds
  v_mfma_f32_16x16x32_bf16 v[164:167], a[172:175], a[224:227], v[164:167]
  v_mfma_f32_16x16x32_bf16 v[172:175], a[172:175], a[228:231], v[172:175]
  ds_read_b64_tr_b16 a[172:173], v53 offset:49352
  v_mfma_f32_16x16x32_bf16 v[176:179], a[176:179], a[212:215], v[176:179]
  ds_read_b64_tr_b16 a[174:175], v53 offset:50376
  v_mfma_f32_16x16x32_bf16 v[184:187], a[176:179], a[216:219], v[184:187]
  v_mfma_f32_16x16x32_bf16 v[192:195], a[176:179], a[220:223], v[192:195]
  v_mfma_f32_16x16x32_bf16 v[200:203], a[176:179], a[224:227], v[200:203]
  v_mfma_f32_16x16x32_bf16 v[208:211], a[176:179], a[228:231], v[208:211]
  buffer_load_dwordx4 v42, s[4:7], s52 offen offset:2048 lds
  v_mfma_f32_16x16x32_bf16 v[180:183], a[180:183], a[212:215], v[180:183]
  ds_read_b64_tr_b16 a[176:177], v54 offset:49344
  v_mfma_f32_16x16x32_bf16 v[188:191], a[180:183], a[216:219], v[188:191]
  ds_read_b64_tr_b16 a[178:179], v54 offset:50368
  v_mfma_f32_16x16x32_bf16 v[196:199], a[180:183], a[220:223], v[196:199]
  v_mfma_f32_16x16x32_bf16 v[204:207], a[180:183], a[224:227], v[204:207]
  v_mfma_f32_16x16x32_bf16 v[212:215], a[180:183], a[228:231], v[212:215]
  ds_read_b64_tr_b16 a[180:181], v54 offset:49352
  v_mfma_f32_16x16x32_bf16 v[216:219], a[184:187], a[212:215], v[216:219]
  ds_read_b64_tr_b16 a[182:183], v54 offset:50376
  v_mfma_f32_16x16x32_bf16 v[224:227], a[184:187], a[216:219], v[224:227]
  buffer_load_dwordx4 v43, s[4:7], s52 offen offset:3072 lds
  v_mfma_f32_16x16x32_bf16 v[232:235], a[184:187], a[220:223], v[232:235]
  s_add_u32 s52, s52, s56
  s_add_u32 s53, s53, s58
  v_mfma_f32_16x16x32_bf16 v[240:243], a[184:187], a[224:227], v[240:243]
  v_mfma_f32_16x16x32_bf16 v[248:251], a[184:187], a[228:231], v[248:251]
  v_mfma_f32_16x16x32_bf16 v[220:223], a[188:191], a[212:215], v[220:223]
  v_mfma_f32_16x16x32_bf16 v[228:231], a[188:191], a[216:219], v[228:231]
  v_mfma_f32_16x16x32_bf16 v[236:239], a[188:191], a[220:223], v[236:239]
  v_mfma_f32_16x16x32_bf16 v[244:247], a[188:191], a[224:227], v[244:247]
  s_waitcnt lgkmcnt(0)
  v_mfma_f32_16x16x32_bf16 v[252:255], a[188:191], a[228:231], v[252:255]
  v_mfma_f32_16x16x32_bf16 a[0:3], a[160:163], a[212:215], a[0:3]
  s_waitcnt vmcnt(45)
  s_barrier
  v_mfma_f32_16x16x32_bf16 a[8:11], a[160:163], a[216:219], a[8:11]
  ds_read_b64_tr_b16 a[188:189], v55 offset:8
  v_mfma_f32_16x16x32_bf16 a[16:19], a[160:163], a[220:223], a[16:19]
  s_mov_b32 m0, 155904
  ds_read_b64_tr_b16 a[190:191], v55 offset:1032
  v_mfma_f32_16x16x32_bf16 a[24:27], a[160:163], a[224:227], a[24:27]
  buffer_load_dwordx4 v36, s[12:15], s35 offen lds
  v_mfma_f32_16x16x32_bf16 a[32:35], a[160:163], a[228:231], a[32:35]
  ds_read_b64_tr_b16 a[160:161], v52 offset:0
  v_mfma_f32_16x16x32_bf16 a[4:7], a[164:167], a[212:215], a[4:7]
  ds_read_b64_tr_b16 a[162:163], v52 offset:1024
  v_mfma_f32_16x16x32_bf16 a[12:15], a[164:167], a[216:219], a[12:15]
  ds_read_b128 a[192:195], v56 offset:0
  v_mfma_f32_16x16x32_bf16 a[20:23], a[164:167], a[220:223], a[20:23]
  ds_read_b128 a[196:199], v56 offset:2048
  v_mfma_f32_16x16x32_bf16 a[28:31], a[164:167], a[224:227], a[28:31]
  ds_read_b128 a[200:203], v56 offset:4096
  v_mfma_f32_16x16x32_bf16 a[36:39], a[164:167], a[228:231], a[36:39]
  s_add_u32 s35, s35, 261632
  s_mov_b32 m0, s53
  ds_read_b64_tr_b16 a[164:165], v52 offset:8
  v_mfma_f32_16x16x32_bf16 a[40:43], a[168:171], a[212:215], a[40:43]
  buffer_load_dwordx4 v40, s[4:7], s52 offen lds
  v_mfma_f32_16x16x32_bf16 a[48:51], a[168:171], a[216:219], a[48:51]
  ds_read_b64_tr_b16 a[166:167], v52 offset:1032
  v_mfma_f32_16x16x32_bf16 a[56:59], a[168:171], a[220:223], a[56:59]
  ds_read_b128 a[204:207], v56 offset:6144
  v_mfma_f32_16x16x32_bf16 a[64:67], a[168:171], a[224:227], a[64:67]
  ds_read_b128 a[208:211], v56 offset:8192
  v_mfma_f32_16x16x32_bf16 a[72:75], a[168:171], a[228:231], a[72:75]
  ds_read_b64_tr_b16 a[168:169], v53 offset:0
  v_mfma_f32_16x16x32_bf16 a[44:47], a[172:175], a[212:215], a[44:47]
  ds_read_b64_tr_b16 a[170:171], v53 offset:1024
  v_mfma_f32_16x16x32_bf16 a[52:55], a[172:175], a[216:219], a[52:55]
  ds_read_b64_tr_b16 a[184:185], v55 offset:0
  v_mfma_f32_16x16x32_bf16 a[60:63], a[172:175], a[220:223], a[60:63]
  buffer_load_dwordx4 v41, s[4:7], s52 offen offset:1024 lds
  v_mfma_f32_16x16x32_bf16 a[68:71], a[172:175], a[224:227], a[68:71]
  ds_read_b64_tr_b16 a[186:187], v55 offset:1024
  v_mfma_f32_16x16x32_bf16 a[76:79], a[172:175], a[228:231], a[76:79]
  ds_read_b64_tr_b16 a[172:173], v53 offset:8
  v_mfma_f32_16x16x32_bf16 a[80:83], a[176:179], a[212:215], a[80:83]
  ds_read_b64_tr_b16 a[174:175], v53 offset:1032
  v_mfma_f32_16x16x32_bf16 a[88:91], a[176:179], a[216:219], a[88:91]
  v_mfma_f32_16x16x32_bf16 a[96:99], a[176:179], a[220:223], a[96:99]
  v_mfma_f32_16x16x32_bf16 a[104:107], a[176:179], a[224:227], a[104:107]
  v_mfma_f32_16x16x32_bf16 a[112:115], a[176:179], a[228:231], a[112:115]
  buffer_load_dwordx4 v42, s[4:7], s52 offen offset:2048 lds
  v_mfma_f32_16x16x32_bf16 a[84:87], a[180:183], a[212:215], a[84:87]
  ds_read_b64_tr_b16 a[176:177], v54 offset:0
  v_mfma_f32_16x16x32_bf16 a[92:95], a[180:183], a[216:219], a[92:95]
  ds_read_b64_tr_b16 a[178:179], v54 offset:1024
  v_mfma_f32_16x16x32_bf16 a[100:103], a[180:183], a[220:223], a[100:103]
  v_mfma_f32_16x16x32_bf16 a[108:111], a[180:183], a[224:227], a[108:111]
  v_mfma_f32_16x16x32_bf16 a[116:119], a[180:183], a[228:231], a[116:119]
  ds_read_b64_tr_b16 a[180:181], v54 offset:8
  v_mfma_f32_16x16x32_bf16 a[120:123], a[252:255], a[212:215], a[120:123]
  ds_read_b64_tr_b16 a[182:183], v54 offset:1032
  v_mfma_f32_16x16x32_bf16 a[128:131], a[252:255], a[216:219], a[128:131]
  buffer_load_dwordx4 v43, s[4:7], s52 offen offset:3072 lds
  v_mfma_f32_16x16x32_bf16 a[136:139], a[252:255], a[220:223], a[136:139]
  s_add_u32 s52, s52, s57
  s_add_u32 s53, s53, s58
  v_mfma_f32_16x16x32_bf16 a[144:147], a[252:255], a[224:227], a[144:147]
  v_mfma_f32_16x16x32_bf16 a[152:155], a[252:255], a[228:231], a[152:155]
  v_mfma_f32_16x16x32_bf16 a[124:127], a[248:251], a[212:215], a[124:127]
  s_add_u32 s39, s39, 1
  v_mfma_f32_16x16x32_bf16 a[132:135], a[248:251], a[216:219], a[132:135]
  s_cmp_eq_u32 s39, s96
  s_cbranch_scc1 L_vswitch
L_vswitched:
  v_mfma_f32_16x16x32_bf16 a[140:143], a[248:251], a[220:223], a[140:143]
  s_cmp_lt_u32 s39, 7
  v_mfma_f32_16x16x32_bf16 a[148:151], a[248:251], a[224:227], a[148:151]
  s_waitcnt lgkmcnt(0)
  v_mfma_f32_16x16x32_bf16 a[156:159], a[248:251], a[228:231], a[156:159]
  s_cbranch_scc1 L_qloopT
  s_branch L_qswap

L_role_t:
  s_getpc_b64 s[98:99]
L_pcP:
  s_add_u32 s98, s98, L_qside - L_pcP
  s_addc_u32 s99, s99, ((L_qside - L_pcP) >> 32) & 0xffffffff
  s_bfe_u32 s100, s2, 0x20003
  v_lshl_add_u32 v31, v0, 2, s100
  v_lshlrev_b32 v31, 7, v31
  v_min_u32 v31, L_qepi - L_qside - 4, v31
  global_load_dword v31, v31, s[98:99]
  s_lshl_b32 s48, s33, 10
  s_add_u32 s12, s78, s48
  s_addc_u32 s13, s79, 0
  s_sub_u32 s14, 0x400000, s48
  s_lshl_b32 s49, s43, 14
  s_mov_b32 s48, 262144
  buffer_load_dword v35, v30, s[12:15], s48 offen
  v_lshrrev_b32 v29, 5, v0
  v_and_b32 v28, 31, v0
  v_lshlrev_b32 v28, 4, v28
  v_lshl_add_u32 v36, v29, 13, v28
  v_add_u32 v36, s49, v36
  s_mov_b32 s35, 1310720
  s_sub_u32 s4, s8, 0x21000
  s_subb_u32 s5, s9, 0
  s_mov_b32 s6, 0
  s_mov_b32 s52, s45
  s_mov_b32 s53, 155904
  s_mov_b32 s88, s45
  s_sub_u32 s48, s71, s45
  s_mov_b32 s54, 4096
  s_add_u32 s55, s48, 126976
  s_mov_b32 s56, 4096
  s_sub_u32 s57, -126976, s48
  s_mov_b32 s58, 0
  s_mov_b32 s96, 1
  s_mov_b32 s97, 2
  v_mov_b32 v40, v13
  v_mov_b32 v41, v14
  v_mov_b32 v42, v15
  v_mov_b32 v43, v16
  v_mov_b32 v44, 16777216
  v_mov_b32 v45, 16777216
L_role_done:
  s_lshl_b32 s48, s33, 19
  s_add_u32 s26, s26, s48
  s_addc_u32 s27, s27, 0
  s_lshl_b32 s48, s44, 4
  s_add_u32 s48, s48, s43
  s_mul_i32 s49, s48, 1146880
  s_add_u32 s16, s82, s49
  s_addc_u32 s17, s83, 0
  s_mov_b32 s18, 1146880
  s_mov_b32 s19, 0x20000
  s_lshl_b32 s49, s48, 10
  s_add_u32 s49, s49, 36700160
  s_add_u32 s20, s82, s49
  s_addc_u32 s21, s83, 0
  s_mov_b32 s22, 1024
  s_mov_b32 s23, 0x20000
  s_lshl_b32 s49, s48, 2
  s_add_u32 s28, s80, s49
  s_addc_u32 s29, s81, 0
  s_mov_b32 s40, 1040356334
  s_mov_b32 s41, 1040356334
  s_mov_b32 s50, 0
  s_mov_b32 s3, 0
  s_mov_b32 s39, 0
  s_add_u32 s34, s71, 0x6000
  s_or_b32 s48, s33, s30
  s_cmp_eq_u32 s48, 0
  s_cbranch_scc0 L_nostale
  v_lshlrev_b32 v29, 4, v0
  buffer_load_dwordx4 v[60:63], v29, s[20:23], 0 offen sc1
L_nostale:
  s_lshl_b32 s48, s30, 15
  v_lshrrev_b32 v29, 3, v0
  v_lshl_add_u32 v29, v29, 10, s48
  v_lshlrev_b32 v28, 1, v24
  v_and_b32 v22, 7, v0
  v_xor_b32 v28, v28, v22
  v_lshl_add_u32 v22, v28, 4, v29
  s_lshl_b32 s48, s46, 13
  s_add_u32 s49, s48, 65792
  v_lshl_add_u32 v29, v25, 8, s49
  v_xor_b32 v28, v24, v25
  v_xor_b32 v1, 0, v28
  v_lshl_add_u32 v1, v1, 4, v29
  v_xor_b32 v2, 4, v28
  v_lshl_add_u32 v2, v2, 4, v29
  v_xor_b32 v3, 8, v28
  v_lshl_add_u32 v3, v3, 4, v29
  v_xor_b32 v4, 12, v28
  v_lshl_add_u32 v4, v4, 4, v29
  v_lshl_add_u32 v29, v24, 2, v26
  v_and_b32 v28, 7, v29
  v_lshl_add_u32 v29, v29, 8, s48
  v_lshl_add_u32 v29, v27, 3, v29
  v_xor_b32 v5, 0, v28
  v_lshl_add_u32 v5, v5, 5, v29
  v_xor_b32 v6, 1, v28
  v_lshl_add_u32 v6, v6, 5, v29
  v_xor_b32 v7, 2, v28
  v_lshl_add_u32 v7, v7, 5, v29
  v_xor_b32 v8, 3, v28
  v_lshl_add_u32 v8, v8, 5, v29
  v_xor_b32 v9, 4, v28
  v_lshl_add_u32 v9, v9, 5, v29
  v_xor_b32 v10, 5, v28
  v_lshl_add_u32 v10, v10, 5, v29
  v_xor_b32 v11, 6, v28
  v_lshl_add_u32 v11, v11, 5, v29
  v_xor_b32 v12, 7, v28
  v_lshl_add_u32 v12, v12, 5, v29
  s_mul_i32 s48, s46, 8224
  v_lshl_add_u32 v29, v24, 3, v26
  v_lshl_add_u32 v29, v29, 8, s48
  v_lshl_add_u32 v29, v27, 4, v29
  v_mad_u32_u24 v29, v24, 8, v29
  v_xor_b32 v52, 0, v26
  v_lshl_add_u32 v52, v52, 6, v29
  v_xor_b32 v53, 1, v26
  v_lshl_add_u32 v53, v53, 6, v29
  v_xor_b32 v54, 2, v26
  v_lshl_add_u32 v54, v54, 6, v29
  v_xor_b32 v55, 3, v26
  v_lshl_add_u32 v55, v55, 6, v29
  s_mul_i32 s48, s47, 10240
  s_add_u32 s48, s48, 135424
  s_mov_b32 s92, -20480
  v_lshl_add_u32 v29, v25, 7, s48
  v_lshrrev_b32 v28, 1, v25
  v_xor_b32 v28, v28, v24
  v_lshl_add_u32 v56, v28, 4, v29
  v_xor_b32 v57, 64, v56
  v_mov_b32 v28, 0x3f803f80
  v_accvgpr_write_b32 a244, v28
  v_accvgpr_write_b32 a245, v28
  v_accvgpr_write_b32 a246, v28
  v_accvgpr_write_b32 a247, v28
  v_mov_b32 v64, 0
  v_mov_b32 v65, 0
  v_mov_b32 v66, 0
  v_mov_b32 v67, 0
  s_nop 1
  v_mfma_f32_32x32x16_bf16 a[0:15], v[64:67], v[64:67], 0
  v_mfma_f32_32x32x16_bf16 v[96:111], v[64:67], v[64:67], 0
  v_mfma_f32_32x32x16_bf16 a[16:31], v[64:67], v[64:67], 0
  v_mfma_f32_32x32x16_bf16 v[112:127], v[64:67], v[64:67], 0
  v_mfma_f32_32x32x16_bf16 a[32:47], v[64:67], v[64:67], 0
  v_mfma_f32_32x32x16_bf16 v[128:143], v[64:67], v[64:67], 0
  v_mfma_f32_32x32x16_bf16 a[48:63], v[64:67], v[64:67], 0
  v_mfma_f32_32x32x16_bf16 v[144:159], v[64:67], v[64:67], 0
  v_mfma_f32_32x32x16_bf16 a[64:79], v[64:67], v[64:67], 0
  v_mfma_f32_32x32x16_bf16 v[160:175], v[64:67], v[64:67], 0
  v_mfma_f32_32x32x16_bf16 a[80:95], v[64:67], v[64:67], 0
  v_mfma_f32_32x32x16_bf16 v[176:191], v[64:67], v[64:67], 0
  v_mfma_f32_32x32x16_bf16 a[96:111], v[64:67], v[64:67], 0
  v_mfma_f32_32x32x16_bf16 v[192:207], v[64:67], v[64:67], 0
  v_mfma_f32_32x32x16_bf16 a[112:127], v[64:67], v[64:67], 0
  v_mfma_f32_32x32x16_bf16 v[208:223], v[64:67], v[64:67], 0
  v_mfma_f32_32x32x16_bf16 a[128:143], v[64:67], v[64:67], 0
  v_mfma_f32_32x32x16_bf16 v[224:239], v[64:67], v[64:67], 0
  v_mfma_f32_32x32x16_bf16 a[144:159], v[64:67], v[64:67], 0
  v_mfma_f32_32x32x16_bf16 v[240:255], v[64:67], v[64:67], 0
  s_cmp_eq_u32 s97, 0
  s_cbranch_scc0 L_role2_odd
  s_mov_b32 s48, 262144
  s_add_u32 m0, s53, 32896
  s_nop 0
  buffer_load_dwordx4 v36, s[4:7], s48 offen lds
  buffer_load_dwordx4 v37, s[4:7], s48 offen offset:1024 lds
  buffer_load_dwordx4 v38, s[4:7], s48 offen offset:2056 lds
  buffer_load_dwordx4 v39, s[4:7], s48 offen offset:3080 lds
  s_add_u32 m0, s53, 37008
  s_nop 0
  buffer_load_dwordx4 v40, s[4:7], s48 offen lds
  buffer_load_dwordx4 v41, s[4:7], s48 offen offset:1024 lds
  buffer_load_dwordx4 v42, s[4:7], s48 offen offset:2056 lds
  buffer_load_dwordx4 v43, s[4:7], s48 offen offset:3080 lds
  s_mov_b32 s48, 262656
  s_add_u32 m0, s53, 49344
  s_nop 0
  buffer_load_dwordx4 v36, s[4:7], s48 offen lds
  buffer_load_dwordx4 v37, s[4:7], s48 offen offset:1024 lds
  buffer_load_dwordx4 v38, s[4:7], s48 offen offset:2056 lds
  buffer_load_dwordx4 v39, s[4:7], s48 offen offset:3080 lds
  s_add_u32 m0, s53, 53456
  s_nop 0
  buffer_load_dwordx4 v40, s[4:7], s48 offen lds
  buffer_load_dwordx4 v41, s[4:7], s48 offen offset:1024 lds
  buffer_load_dwordx4 v42, s[4:7], s48 offen offset:2056 lds
  buffer_load_dwordx4 v43, s[4:7], s48 offen offset:3080 lds
  s_waitcnt vmcnt(24)
L_role2_done:
  s_barrier
  ds_read_b128 a[192:195], v56 offset:0
  ds_read_b128 a[196:199], v56 offset:2048
  ds_read_b128 a[200:203], v56 offset:4096
  ds_read_b128 a[204:207], v56 offset:6144
  ds_read_b128 a[208:211], v56 offset:8192
  ds_read_b64_tr_b16 a[160:161], v52 offset:0
  ds_read_b64_tr_b16 a[162:163], v52 offset:1024
  ds_read_b64_tr_b16 a[164:165], v52 offset:8
  ds_read_b64_tr_b16 a[166:167], v52 offset:1032
  ds_read_b64_tr_b16 a[168:169], v53 offset:0
  ds_read_b64_tr_b16 a[170:171], v53 offset:1024
  ds_read_b64_tr_b16 a[172:173], v53 offset:8
  ds_read_b64_tr_b16 a[174:175], v53 offset:1032
  ds_read_b64_tr_b16 a[176:177], v54 offset:0
  ds_read_b64_tr_b16 a[178:179], v54 offset:1024
  ds_read_b64_tr_b16 a[180:181], v54 offset:8
  ds_read_b64_tr_b16 a[182:183], v54 offset:1032
  ds_read_b64_tr_b16 a[184:185], v55 offset:0
  ds_read_b64_tr_b16 a[186:187], v55 offset:1024
  ds_read_b64_tr_b16 a[188:189], v55 offset:8
  ds_read_b64_tr_b16 a[190:191], v55 offset:1032
  s_waitcnt lgkmcnt(0)
  s_cmp_eq_u32 s97, 1
  s_cbranch_scc1 L_qloopX
  s_cmp_eq_u32 s97, 2
  s_cbranch_scc1 L_qloopT
L_qloopW:
  v_mfma_f32_16x16x32_bf16 v[96:99], a[160:163], a[192:195], v[96:99]
  s_waitcnt vmcnt(16)
  s_barrier
  v_mfma_f32_16x16x32_bf16 v[104:107], a[160:163], a[196:199], v[104:107]
  s_add_u32 m0, s53, 0
  ds_read_b64_tr_b16 a[248:249], v55 offset:16456
  v_mfma_f32_16x16x32_bf16 v[112:115], a[160:163], a[200:203], v[112:115]
  buffer_load_dwordx4 v36, s[4:7], s52 offen lds
  v_mfma_f32_16x16x32_bf16 v[120:123], a[160:163], a[204:207], v[120:123]
  ds_read_b64_tr_b16 a[250:251], v55 offset:17480
  v_mfma_f32_16x16x32_bf16 v[128:131], a[160:163], a[208:211], v[128:131]
  ds_read_b64_tr_b16 a[160:161], v52 offset:16448
  v_mfma_f32_16x16x32_bf16 v[100:103], a[164:167], a[192:195], v[100:103]
  ds_read_b64_tr_b16 a[162:163], v52 offset:17472
  v_mfma_f32_16x16x32_bf16 v[108:111], a[164:167], a[196:199], v[108:111]
  buffer_load_dwordx4 v37, s[4:7], s52 offen offset:1024 lds
  v_mfma_f32_16x16x32_bf16 v[116:119], a[164:167], a[200:203], v[116:119]
  ds_read_b128 a[212:215], v57 offset:0
  v_mfma_f32_16x16x32_bf16 v[124:127], a[164:167], a[204:207], v[124:127]
  ds_read_b128 a[216:219], v57 offset:2048
  v_mfma_f32_16x16x32_bf16 v[132:135], a[164:167], a[208:211], v[132:135]
  ds_read_b64_tr_b16 a[164:165], v52 offset:16456
  v_mfma_f32_16x16x32_bf16 v[136:139], a[168:171], a[192:195], v[136:139]
  buffer_load_dwordx4 v38, s[4:7], s52 offen offset:2056 lds
  v_mfma_f32_16x16x32_bf16 v[144:147], a[168:171], a[196:199], v[144:147]
  ds_read_b64_tr_b16 a[166:167], v52 offset:17480
  v_mfma_f32_16x16x32_bf16 v[152:155], a[168:171], a[200:203], v[152:155]
  ds_read_b128 a[220:223], v57 offset:4096
  v_mfma_f32_16x16x32_bf16 v[160:163], a[168:171], a[204:207], v[160:163]
  ds_read_b128 a[224:227], v57 offset:6144
  v_mfma_f32_16x16x32_bf16 v[168:171], a[168:171], a[208:211], v[168:171]
  buffer_load_dwordx4 v39, s[4:7], s52 offen offset:3080 lds
  v_mfma_f32_16x16x32_bf16 v[140:143], a[172:175], a[192:195], v[140:143]
  ds_read_b64_tr_b16 a[168:169], v53 offset:16448
  v_mfma_f32_16x16x32_bf16 v[148:151], a[172:175], a[196:199], v[148:151]
  ds_read_b64_tr_b16 a[170:171], v53 offset:17472
  v_mfma_f32_16x16x32_bf16 v[156:159], a[172:175], a[200:203], v[156:159]
  s_add_u32 m0, s53, 4112
  ds_read_b128 a[228:231], v57 offset:8192
  v_mfma_f32_16x16x32_bf16 v[164:167], a[172:175], a[204:207], v[164:167]
  buffer_load_dwordx4 v40, s[4:7], s52 offen lds
  v_mfma_f32_16x16x32_bf16 v[172:175], a[172:175], a[208:211], v[172:175]
  ds_read_b64_tr_b16 a[172:173], v53 offset:16456
  v_mfma_f32_16x16x32_bf16 v[176:179], a[176:179], a[192:195], v[176:179]
  ds_read_b64_tr_b16 a[174:175], v53 offset:17480
  v_mfma_f32_16x16x32_bf16 v[184:187], a[176:179], a[196:199], v[184:187]
  ds_read_b64_tr_b16 a[252:253], v55 offset:16448
  v_mfma_f32_16x16x32_bf16 v[192:195], a[176:179], a[200:203], v[192:195]
  buffer_load_dwordx4 v41, s[4:7], s52 offen offset:1024 lds
  v_mfma_f32_16x16x32_bf16 v[200:203], a[176:179], a[204:207], v[200:203]
  ds_read_b64_tr_b16 a[254:255], v55 offset:17472
  v_mfma_f32_16x16x32_bf16 v[208:211], a[176:179], a[208:211], v[208:211]
  ds_read_b64_tr_b16 a[176:177], v54 offset:16448
  v_mfma_f32_16x16x32_bf16 v[180:183], a[180:183], a[192:195], v[180:183]
  ds_read_b64_tr_b16 a[178:179], v54 offset:17472
  v_mfma_f32_16x16x32_bf16 v[188:191], a[180:183], a[196:199], v[188:191]
  buffer_load_dwordx4 v42, s[4:7], s52 offen offset:2056 lds
  v_mfma_f32_16x16x32_bf16 v[196:199], a[180:183], a[200:203], v[196:199]
  v_mfma_f32_16x16x32_bf16 v[204:207], a[180:183], a[204:207], v[204:207]
  v_mfma_f32_16x16x32_bf16 v[212:215], a[180:183], a[208:211], v[212:215]
  ds_read_b64_tr_b16 a[180:181], v54 offset:16456
  v_mfma_f32_16x16x32_bf16 v[216:219], a[184:187], a[192:195], v[216:219]
  buffer_load_dwordx4 v43, s[4:7], s52 offen offset:3080 lds
  v_mfma_f32_16x16x32_bf16 v[224:227], a[184:187], a[196:199], v[224:227]
  s_add_u32 s52, s52, 512
  ds_read_b64_tr_b16 a[182:183], v54 offset:17480
  v_mfma_f32_16x16x32_bf16 v[232:235], a[184:187], a[200:203], v[232:235]
  v_mfma_f32_16x16x32_bf16 v[240:243], a[184:187], a[204:207], v[240:243]
  v_mfma_f32_16x16x32_bf16 v[248:251], a[184:187], a[208:211], v[248:251]
  v_mfma_f32_16x16x32_bf16 v[220:223], a[188:191], a[192:195], v[220:223]
  v_mfma_f32_16x16x32_bf16 v[228:231], a[188:191], a[196:199], v[228:231]
  v_mfma_f32_16x16x32_bf16 v[236:239], a[188:191], a[200:203], v[236:239]
  v_mfma_f32_16x16x32_bf16 v[244:247], a[188:191], a[204:207], v[244:247]
  s_waitcnt lgkmcnt(0)
  v_mfma_f32_16x16x32_bf16 v[252:255], a[188:191], a[208:211], v[252:255]
  v_mfma_f32_16x16x32_bf16 a[0:3], a[160:163], a[192:195], a[0:3]
  s_waitcnt vmcnt(16)
  s_barrier
  v_mfma_f32_16x16x32_bf16 a[8:11], a[160:163], a[196:199], a[8:11]
  s_add_u32 m0, s53, 16448
  ds_read_b64_tr_b16 a[188:189], v55 offset:32904
  v_mfma_f32_16x16x32_bf16 a[16:19], a[160:163], a[200:203], a[16:19]
  buffer_load_dwordx4 v36, s[4:7], s52 offen lds
  v_mfma_f32_16x16x32_bf16 a[24:27], a[160:163], a[204:207], a[24:27]
  ds_read_b64_tr_b16 a[190:191], v55 offset:33928
  v_mfma_f32_16x16x32_bf16 a[32:35], a[160:163], a[208:211], a[32:35]
  ds_read_b64_tr_b16 a[160:161], v52 offset:32896
  v_mfma_f32_16x16x32_bf16 a[4:7], a[164:167], a[192:195], a[4:7]
  ds_read_b64_tr_b16 a[162:163], v52 offset:33920
  v_mfma_f32_16x16x32_bf16 a[12:15], a[164:167], a[196:199], a[12:15]
  buffer_load_dwordx4 v37, s[4:7], s52 offen offset:1024 lds
  v_mfma_f32_16x16x32_bf16 a[20:23], a[164:167], a[200:203], a[20:23]
  ds_read_b64_tr_b16 a[184:185], v55 offset:32896
  v_mfma_f32_16x16x32_bf16 a[28:31], a[164:167], a[204:207], a[28:31]
  ds_read_b64_tr_b16 a[186:187], v55 offset:33920
  v_mfma_f32_16x16x32_bf16 a[36:39], a[164:167], a[208:211], a[36:39]
  ds_read_b64_tr_b16 a[164:165], v52 offset:32904
  v_mfma_f32_16x16x32_bf16 a[40:43], a[168:171], a[192:195], a[40:43]
  buffer_load_dwordx4 v38, s[4:7], s52 offen offset:2056 lds
  v_mfma_f32_16x16x32_bf16 a[48:51], a[168:171], a[196:199], a[48:51]
  ds_read_b64_tr_b16 a[166:167], v52 offset:33928
  v_mfma_f32_16x16x32_bf16 a[56:59], a[168:171], a[200:203], a[56:59]
  v_mfma_f32_16x16x32_bf16 a[64:67], a[168:171], a[204:207], a[64:67]
  v_mfma_f32_16x16x32_bf16 a[72:75], a[168:171], a[208:211], a[72:75]
  buffer_load_dwordx4 v39, s[4:7], s52 offen offset:3080 lds
  v_mfma_f32_16x16x32_bf16 a[44:47], a[172:175], a[192:195], a[44:47]
  ds_read_b64_tr_b16 a[168:169], v53 offset:32896
  v_mfma_f32_16x16x32_bf16 a[52:55], a[172:175], a[196:199], a[52:55]
  ds_read_b64_tr_b16 a[170:171], v53 offset:33920
  v_mfma_f32_16x16x32_bf16 a[60:63], a[172:175], a[200:203], a[60:63]
  s_add_u32 m0, s53, 20560
  v_mfma_f32_16x16x32_bf16 a[68:71], a[172:175], a[204:207], a[68:71]
  buffer_load_dwordx4 v40, s[4:7], s52 offen lds
  v_mfma_f32_16x16x32_bf16 a[76:79], a[172:175], a[208:211], a[76:79]
  ds_read_b64_tr_b16 a[172:173], v53 offset:32904
  v_mfma_f32_16x16x32_bf16 a[80:83], a[176:179], a[192:195], a[80:83]
  ds_read_b64_tr_b16 a[174:175], v53 offset:33928
  v_mfma_f32_16x16x32_bf16 a[88:91], a[176:179], a[196:199], a[88:91]
  v_mfma_f32_16x16x32_bf16 a[96:99], a[176:179], a[200:203], a[96:99]
  buffer_load_dwordx4 v41, s[4:7], s52 offen offset:1024 lds
  v_mfma_f32_16x16x32_bf16 a[104:107], a[176:179], a[204:207], a[104:107]
  v_mfma_f32_16x16x32_bf16 a[112:115], a[176:179], a[208:211], a[112:115]
  ds_read_b64_tr_b16 a[176:177], v54 offset:32896
  v_mfma_f32_16x16x32_bf16 a[84:87], a[180:183], a[192:195], a[84:87]
  ds_read_b64_tr_b16 a[178:179], v54 offset:33920
  v_mfma_f32_16x16x32_bf16 a[92:95], a[180:183], a[196:199], a[92:95]
  buffer_load_dwordx4 v42, s[4:7], s52 offen offset:2056 lds
  v_mfma_f32_16x16x32_bf16 a[100:103], a[180:183], a[200:203], a[100:103]
  v_mfma_f32_16x16x32_bf16 a[108:111], a[180:183], a[204:207], a[108:111]
  v_mfma_f32_16x16x32_bf16 a[116:119], a[180:183], a[208:211], a[116:119]
  ds_read_b64_tr_b16 a[180:181], v54 offset:32904
  v_mfma_f32_16x16x32_bf16 a[120:123], a[252:255], a[192:195], a[120:123]
  buffer_load_dwordx4 v43, s[4:7], s52 offen offset:3080 lds
  v_mfma_f32_16x16x32_bf16 a[128:131], a[252:255], a[196:199], a[128:131]
  s_add_u32 s52, s52, 261632
  ds_read_b64_tr_b16 a[182:183], v54 offset:33928
  v_mfma_f32_16x16x32_bf16 a[136:139], a[252:255], a[200:203], a[136:139]
  v_mfma_f32_16x16x32_bf16 a[144:147], a[252:255], a[204:207], a[144:147]
  v_mfma_f32_16x16x32_bf16 a[152:155], a[252:255], a[208:211], a[152:155]
  v_add_u32 v56, s92, v56
  v_mfma_f32_16x16x32_bf16 a[124:127], a[248:251], a[192:195], a[124:127]
  v_add_u32 v57, s92, v57
  v_mfma_f32_16x16x32_bf16 a[132:135], a[248:251], a[196:199], a[132:135]
  s_sub_u32 s92, 0, s92
  v_mfma_f32_16x16x32_bf16 a[140:143], a[248:251], a[200:203], a[140:143]
  v_mfma_f32_16x16x32_bf16 a[148:151], a[248:251], a[204:207], a[148:151]
  s_waitcnt lgkmcnt(0)
  v_mfma_f32_16x16x32_bf16 a[156:159], a[248:251], a[208:211], a[156:159]
  v_mfma_f32_16x16x32_bf16 v[96:99], a[160:163], a[212:215], v[96:99]
  s_waitcnt vmcnt(16)
  s_barrier
  v_mfma_f32_16x16x32_bf16 v[104:107], a[160:163], a[216:219], v[104:107]
  s_add_u32 m0, s53, 32896
  ds_read_b64_tr_b16 a[248:249], v55 offset:49352
  v_mfma_f32_16x16x32_bf16 v[112:115], a[160:163], a[220:223], v[112:115]
  buffer_load_dwordx4 v36, s[4:7], s52 offen lds
  v_mfma_f32_16x16x32_bf16 v[120:123], a[160:163], a[224:227], v[120:123]
  ds_read_b64_tr_b16 a[250:251], v55 offset:50376
  v_mfma_f32_16x16x32_bf16 v[128:131], a[160:163], a[228:231], v[128:131]
  ds_read_b64_tr_b16 a[160:161], v52 offset:49344
  v_mfma_f32_16x16x32_bf16 v[100:103], a[164:167], a[212:215], v[100:103]
  ds_read_b64_tr_b16 a[162:163], v52 offset:50368
  v_mfma_f32_16x16x32_bf16 v[108:111], a[164:167], a[216:219], v[108:111]
  buffer_load_dwordx4 v37, s[4:7], s52 offen offset:1024 lds
  v_mfma_f32_16x16x32_bf16 v[116:119], a[164:167], a[220:223], v[116:119]
  ds_read_b64_tr_b16 a[252:253], v55 offset:49344
  v_mfma_f32_16x16x32_bf16 v[124:127], a[164:167], a[224:227], v[124:127]
  ds_read_b64_tr_b16 a[254:255], v55 offset:50368
  v_mfma_f32_16x16x32_bf16 v[132:135], a[164:167], a[228:231], v[132:135]
  ds_read_b64_tr_b16 a[164:165], v52 offset:49352
  v_mfma_f32_16x16x32_bf16 v[136:139], a[168:171], a[212:215], v[136:139]
  buffer_load_dwordx4 v38, s[4:7], s52 offen offset:2056 lds
  v_mfma_f32_16x16x32_bf16 v[144:147], a[168:171], a[216:219], v[144:147]
  ds_read_b64_tr_b16 a[166:167], v52 offset:50376
  v_mfma_f32_16x16x32_bf16 v[152:155], a[168:171], a[220:223], v[152:155]
  v_mfma_f32_16x16x32_bf16 v[160:163], a[168:171], a[224:227], v[160:163]
  v_mfma_f32_16x16x32_bf16 v[168:171], a[168:171], a[228:231], v[168:171]
  buffer_load_dwordx4 v39, s[4:7], s52 offen offset:3080 lds
  v_mfma_f32_16x16x32_bf16 v[140:143], a[172:175], a[212:215], v[140:143]
  ds_read_b64_tr_b16 a[168:169], v53 offset:49344
  v_mfma_f32_16x16x32_bf16 v[148:151], a[172:175], a[216:219], v[148:151]
  ds_read_b64_tr_b16 a[170:171], v53 offset:50368
  v_mfma_f32_16x16x32_bf16 v[156:159], a[172:175], a[220:223], v[156:159]
  s_add_u32 m0, s53, 37008
  v_mfma_f32_16x16x32_bf16 v[164:167], a[172:175], a[224:227], v[164:167]
  buffer_load_dwordx4 v40, s[4:7], s52 offen lds
  v_mfma_f32_16x16x32_bf16 v[172:175], a[172:175], a[228:231], v[172:175]
  ds_read_b64_tr_b16 a[172:173], v53 offset:49352
  v_mfma_f32_16x16x32_bf16 v[176:179], a[176:179], a[212:215], v[176:179]
  ds_read_b64_tr_b16 a[174:175], v53 offset:50376
  v_mfma_f32_16x16x32_bf16 v[184:187], a[176:179], a[216:219], v[184:187]
  v_mfma_f32_16x16x32_bf16 v[192:195], a[176:179], a[220:223], v[192:195]
  buffer_load_dwordx4 v41, s[4:7], s52 offen offset:1024 lds
  v_mfma_f32_16x16x32_bf16 v[200:203], a[176:179], a[224:227], v[200:203]
  v_mfma_f32_16x16x32_bf16 v[208:211], a[176:179], a[228:231], v[208:211]
  ds_read_b64_tr_b16 a[176:177], v54 offset:49344
  v_mfma_f32_16x16x32_bf16 v[180:183], a[180:183], a[212:215], v[180:183]
  ds_read_b64_tr_b16 a[178:179], v54 offset:50368
  v_mfma_f32_16x16x32_bf16 v[188:191], a[180:183], a[216:219], v[188:191]
  buffer_load_dwordx4 v42, s[4:7], s52 offen offset:2056 lds
  v_mfma_f32_16x16x32_bf16 v[196:199], a[180:183], a[220:223], v[196:199]
  v_mfma_f32_16x16x32_bf16 v[204:207], a[180:183], a[224:227], v[204:207]
  v_mfma_f32_16x16x32_bf16 v[212:215], a[180:183], a[228:231], v[212:215]
  ds_read_b64_tr_b16 a[180:181], v54 offset:49352
  v_mfma_f32_16x16x32_bf16 v[216:219], a[184:187], a[212:215], v[216:219]
  buffer_load_dwordx4 v43, s[4:7], s52 offen offset:3080 lds
  v_mfma_f32_16x16x32_bf16 v[224:227], a[184:187], a[216:219], v[224:227]
  s_add_u32 s52, s52, 512
  ds_read_b64_tr_b16 a[182:183], v54 offset:50376
  v_mfma_f32_16x16x32_bf16 v[232:235], a[184:187], a[220:223], v[232:235]
  v_mfma_f32_16x16x32_bf16 v[240:243], a[184:187], a[224:227], v[240:243]
  v_mfma_f32_16x16x32_bf16 v[248:251], a[184:187], a[228:231], v[248:251]
  v_mfma_f32_16x16x32_bf16 v[220:223], a[188:191], a[212:215], v[220:223]
  v_mfma_f32_16x16x32_bf16 v[228:231], a[188:191], a[216:219], v[228:231]
  v_mfma_f32_16x16x32_bf16 v[236:239], a[188:191], a[220:223], v[236:239]
  v_mfma_f32_16x16x32_bf16 v[244:247], a[188:191], a[224:227], v[244:247]
  s_waitcnt lgkmcnt(0)
  v_mfma_f32_16x16x32_bf16 v[252:255], a[188:191], a[228:231], v[252:255]
  v_mfma_f32_16x16x32_bf16 a[0:3], a[160:163], a[212:215], a[0:3]
  s_waitcnt vmcnt(16)
  s_barrier
  v_mfma_f32_16x16x32_bf16 a[8:11], a[160:163], a[216:219], a[8:11]
  s_add_u32 m0, s53, 49344
  ds_read_b64_tr_b16 a[188:189], v55 offset:8
  v_mfma_f32_16x16x32_bf16 a[16:19], a[160:163], a[220:223], a[16:19]
  buffer_load_dwordx4 v36, s[4:7], s52 offen lds
  v_mfma_f32_16x16x32_bf16 a[24:27], a[160:163], a[224:227], a[24:27]
  ds_read_b64_tr_b16 a[190:191], v55 offset:1032
  v_mfma_f32_16x16x32_bf16 a[32:35], a[160:163], a[228:231], a[32:35]
  ds_read_b64_tr_b16 a[160:161], v52 offset:0
  v_mfma_f32_16x16x32_bf16 a[4:7], a[164:167], a[212:215], a[4:7]
  ds_read_b64_tr_b16 a[162:163], v52 offset:1024
  v_mfma_f32_16x16x32_bf16 a[12:15], a[164:167], a[216:219], a[12:15]
  buffer_load_dwordx4 v37, s[4:7], s52 offen offset:1024 lds
  v_mfma_f32_16x16x32_bf16 a[20:23], a[164:167], a[220:223], a[20:23]
  ds_read_b128 a[192:195], v56 offset:0
  v_mfma_f32_16x16x32_bf16 a[28:31], a[164:167], a[224:227], a[28:31]
  ds_read_b128 a[196:199], v56 offset:2048
  v_mfma_f32_16x16x32_bf16 a[36:39], a[164:167], a[228:231], a[36:39]
  ds_read_b64_tr_b16 a[164:165], v52 offset:8
  v_mfma_f32_16x16x32_bf16 a[40:43], a[168:171], a[212:215], a[40:43]
  buffer_load_dwordx4 v38, s[4:7], s52 offen offset:2056 lds
  v_mfma_f32_16x16x32_bf16 a[48:51], a[168:171], a[216:219], a[48:51]
  ds_read_b64_tr_b16 a[166:167], v52 offset:1032
  v_mfma_f32_16x16x32_bf16 a[56:59], a[168:171], a[220:223], a[56:59]
  ds_read_b128 a[200:203], v56 offset:4096
  v_mfma_f32_16x16x32_bf16 a[64:67], a[168:171], a[224:227], a[64:67]
  ds_read_b128 a[204:207], v56 offset:6144
  v_mfma_f32_16x16x32_bf16 a[72:75], a[168:171], a[228:231], a[72:75]
  buffer_load_dwordx4 v39, s[4:7], s52 offen offset:3080 lds
  v_mfma_f32_16x16x32_bf16 a[44:47], a[172:175], a[212:215], a[44:47]
  ds_read_b64_tr_b16 a[168:169], v53 offset:0
  v_mfma_f32_16x16x32_bf16 a[52:55], a[172:175], a[216:219], a[52:55]
  ds_read_b64_tr_b16 a[170:171], v53 offset:1024
  v_mfma_f32_16x16x32_bf16 a[60:63], a[172:175], a[220:223], a[60:63]
  s_add_u32 m0, s53, 53456
  ds_read_b128 a[208:211], v56 offset:8192
  v_mfma_f32_16x16x32_bf16 a[68:71], a[172:175], a[224:227], a[68:71]
  buffer_load_dwordx4 v40, s[4:7], s52 offen lds
  v_mfma_f32_16x16x32_bf16 a[76:79], a[172:175], a[228:231], a[76:79]
  ds_read_b64_tr_b16 a[172:173], v53 offset:8
  v_mfma_f32_16x16x32_bf16 a[80:83], a[176:179], a[212:215], a[80:83]
  ds_read_b64_tr_b16 a[174:175], v53 offset:1032
  v_mfma_f32_16x16x32_bf16 a[88:91], a[176:179], a[216:219], a[88:91]
  ds_read_b64_tr_b16 a[184:185], v55 offset:0
  v_mfma_f32_16x16x32_bf16 a[96:99], a[176:179], a[220:223], a[96:99]
  buffer_load_dwordx4 v41, s[4:7], s52 offen offset:1024 lds
  v_mfma_f32_16x16x32_bf16 a[104:107], a[176:179], a[224:227], a[104:107]
  ds_read_b64_tr_b16 a[186:187], v55 offset:1024
  v_mfma_f32_16x16x32_bf16 a[112:115], a[176:179], a[228:231], a[112:115]
  ds_read_b64_tr_b16 a[176:177], v54 offset:0
  v_mfma_f32_16x16x32_bf16 a[84:87], a[180:183], a[212:215], a[84:87]
  ds_read_b64_tr_b16 a[178:179], v54 offset:1024
  v_mfma_f32_16x16x32_bf16 a[92:95], a[180:183], a[216:219], a[92:95]
  buffer_load_dwordx4 v42, s[4:7], s52 offen offset:2056 lds
  v_mfma_f32_16x16x32_bf16 a[100:103], a[180:183], a[220:223], a[100:103]
  v_mfma_f32_16x16x32_bf16 a[108:111], a[180:183], a[224:227], a[108:111]
  v_mfma_f32_16x16x32_bf16 a[116:119], a[180:183], a[228:231], a[116:119]
  ds_read_b64_tr_b16 a[180:181], v54 offset:8
  v_mfma_f32_16x16x32_bf16 a[120:123], a[252:255], a[212:215], a[120:123]
  buffer_load_dwordx4 v43, s[4:7], s52 offen offset:3080 lds
  v_mfma_f32_16x16x32_bf16 a[128:131], a[252:255], a[216:219], a[128:131]
  s_add_u32 s52, s52, 261632
  ds_read_b64_tr_b16 a[182:183], v54 offset:1032
  v_mfma_f32_16x16x32_bf16 a[136:139], a[252:255], a[220:223], a[136:139]
  v_mfma_f32_16x16x32_bf16 a[144:147], a[252:255], a[224:227], a[144:147]
  v_mfma_f32_16x16x32_bf16 a[152:155], a[252:255], a[228:231], a[152:155]
  v_mfma_f32_16x16x32_bf16 a[124:127], a[248:251], a[212:215], a[124:127]
  s_add_u32 s39, s39, 1
  v_mfma_f32_16x16x32_bf16 a[132:135], a[248:251], a[216:219], a[132:135]
  v_mfma_f32_16x16x32_bf16 a[140:143], a[248:251], a[220:223], a[140:143]
  s_cmp_lt_u32 s39, 7
  v_mfma_f32_16x16x32_bf16 a[148:151], a[248:251], a[224:227], a[148:151]
  s_waitcnt lgkmcnt(0)
  v_mfma_f32_16x16x32_bf16 a[156:159], a[248:251], a[228:231], a[156:159]
  s_cbranch_scc1 L_qloopW
L_qswap:
  s_cmp_eq_u32 s30, 3
  s_cbranch_scc0 L_ctQ
  s_getpc_b64 s[98:99]
L_pcQ:
  s_add_u32 s98, s98, L_qepi - L_pcQ
  s_addc_u32 s99, s99, ((L_qepi - L_pcQ) >> 32) & 0xffffffff
  s_bfe_u32 s100, s2, 0x20003
  v_lshl_add_u32 v31, v0, 2, s100
  v_lshlrev_b32 v31, 7, v31
  v_min_u32 v31, L_at - L_qepi - 4, v31
  global_load_dword v31, v31, s[98:99]
L_ctQ:
  s_mov_b32 s12, s24
  s_mov_b32 s13, s25
  s_mov_b32 s14, 393216
  s_lshl_b32 s35, s50, 18
  s_add_u32 s35, s35, s71
  s_mov_b32 s70, 0x20000
  s_mov_b32 s36, 8192
  v_mov_b32 v17, v21
  v_xor_b32 v18, 0x80, v21
  v_mov_b32 v19, v21
  v_xor_b32 v20, 0x80, v21
  s_or_b32 s48, s33, s30
  s_cmp_eq_u32 s48, 0
  s_cbranch_scc1 L_pick
L_picked:
  v_mfma_f32_16x16x32_bf16 v[96:99], a[160:163], a[192:195], v[96:99]
  s_waitcnt vmcnt(16)
  s_barrier
  v_mfma_f32_16x16x32_bf16 v[104:107], a[160:163], a[196:199], v[104:107]
  s_add_u32 m0, s31, 0
  ds_read_b64_tr_b16 a[248:249], v55 offset:16456
  v_mfma_f32_16x16x32_bf16 v[112:115], a[160:163], a[200:203], v[112:115]
  buffer_load_dwordx4 v17, s[12:15], s35 offen nt lds
  v_mfma_f32_16x16x32_bf16 v[120:123], a[160:163], a[204:207], v[120:123]
  ds_read_b64_tr_b16 a[250:251], v55 offset:17480
  v_mfma_f32_16x16x32_bf16 v[128:131], a[160:163], a[208:211], v[128:131]
  ds_read_b64_tr_b16 a[160:161], v52 offset:16448
  v_mfma_f32_16x16x32_bf16 v[100:103], a[164:167], a[192:195], v[100:103]
  ds_read_b64_tr_b16 a[162:163], v52 offset:17472
  v_mfma_f32_16x16x32_bf16 v[108:111], a[164:167], a[196:199], v[108:111]
  buffer_load_dwordx4 v18, s[12:15], s35 offen offset:1024 nt lds
  v_mfma_f32_16x16x32_bf16 v[116:119], a[164:167], a[200:203], v[116:119]
  ds_read_b128 a[212:215], v57 offset:0
  v_mfma_f32_16x16x32_bf16 v[124:127], a[164:167], a[204:207], v[124:127]
  ds_read_b128 a[216:219], v57 offset:2048
  v_mfma_f32_16x16x32_bf16 v[132:135], a[164:167], a[208:211], v[132:135]
  ds_read_b64_tr_b16 a[164:165], v52 offset:16456
  v_mfma_f32_16x16x32_bf16 v[136:139], a[168:171], a[192:195], v[136:139]
  buffer_load_dwordx4 v19, s[12:15], s35 offen offset:2048 nt lds
  v_mfma_f32_16x16x32_bf16 v[144:147], a[168:171], a[196:199], v[144:147]
  ds_read_b64_tr_b16 a[166:167], v52 offset:17480
  v_mfma_f32_16x16x32_bf16 v[152:155], a[168:171], a[200:203], v[152:155]
  ds_read_b128 a[220:223], v57 offset:4096
  v_mfma_f32_16x16x32_bf16 v[160:163], a[168:171], a[204:207], v[160:163]
  ds_read_b128 a[224:227], v57 offset:6144
  v_mfma_f32_16x16x32_bf16 v[168:171], a[168:171], a[208:211], v[168:171]
  buffer_load_dwordx4 v20, s[12:15], s35 offen offset:3072 nt lds
  v_mfma_f32_16x16x32_bf16 v[140:143], a[172:175], a[192:195], v[140:143]
  s_add_u32 s35, s35, s36
  s_andn2_b32 s35, s35, s70
  ds_read_b64_tr_b16 a[168:169], v53 offset:16448
  v_mfma_f32_16x16x32_bf16 v[148:151], a[172:175], a[196:199], v[148:151]
  ds_read_b64_tr_b16 a[170:171], v53 offset:17472
  v_mfma_f32_16x16x32_bf16 v[156:159], a[172:175], a[200:203], v[156:159]
  ds_read_b128 a[228:231], v57 offset:8192
  v_mfma_f32_16x16x32_bf16 v[164:167], a[172:175], a[204:207], v[164:167]
  ds_read_b64_tr_b16 a[252:253], v55 offset:16448
  v_mfma_f32_16x16x32_bf16 v[172:175], a[172:175], a[208:211], v[172:175]
  ds_read_b64_tr_b16 a[172:173], v53 offset:16456
  v_mfma_f32_16x16x32_bf16 v[176:179], a[176:179], a[192:195], v[176:179]
  ds_read_b64_tr_b16 a[174:175], v53 offset:17480
  v_mfma_f32_16x16x32_bf16 v[184:187], a[176:179], a[196:199], v[184:187]
  ds_read_b64_tr_b16 a[254:255], v55 offset:17472
  v_mfma_f32_16x16x32_bf16 v[192:195], a[176:179], a[200:203], v[192:195]
  v_mfma_f32_16x16x32_bf16 v[200:203], a[176:179], a[204:207], v[200:203]
  v_mfma_f32_16x16x32_bf16 v[208:211], a[176:179], a[208:211], v[208:211]
  ds_read_b64_tr_b16 a[176:177], v54 offset:16448
  v_mfma_f32_16x16x32_bf16 v[180:183], a[180:183], a[192:195], v[180:183]
  ds_read_b64_tr_b16 a[178:179], v54 offset:17472
  v_mfma_f32_16x16x32_bf16 v[188:191], a[180:183], a[196:199], v[188:191]
  v_mfma_f32_16x16x32_bf16 v[196:199], a[180:183], a[200:203], v[196:199]
  v_mfma_f32_16x16x32_bf16 v[204:207], a[180:183], a[204:207], v[204:207]
  v_mfma_f32_16x16x32_bf16 v[212:215], a[180:183], a[208:211], v[212:215]
  ds_read_b64_tr_b16 a[180:181], v54 offset:16456
  v_mfma_f32_16x16x32_bf16 v[216:219], a[184:187], a[192:195], v[216:219]
  ds_read_b64_tr_b16 a[182:183], v54 offset:17480
  v_mfma_f32_16x16x32_bf16 v[224:227], a[184:187], a[196:199], v[224:227]
  v_mfma_f32_16x16x32_bf16 v[232:235], a[184:187], a[200:203], v[232:235]
  v_mfma_f32_16x16x32_bf16 v[240:243], a[184:187], a[204:207], v[240:243]
  v_mfma_f32_16x16x32_bf16 v[248:251], a[184:187], a[208:211], v[248:251]
  v_mfma_f32_16x16x32_bf16 v[220:223], a[188:191], a[192:195], v[220:223]
  v_mfma_f32_16x16x32_bf16 v[228:231], a[188:191], a[196:199], v[228:231]
  v_mfma_f32_16x16x32_bf16 v[236:239], a[188:191], a[200:203], v[236:239]
  v_mfma_f32_16x16x32_bf16 v[244:247], a[188:191], a[204:207], v[244:247]
  s_waitcnt lgkmcnt(0)
  v_mfma_f32_16x16x32_bf16 v[252:255], a[188:191], a[208:211], v[252:255]
  v_mfma_f32_16x16x32_bf16 a[0:3], a[160:163], a[192:195], a[0:3]
  s_waitcnt vmcnt(12)
  s_barrier
  v_mfma_f32_16x16x32_bf16 a[8:11], a[160:163], a[196:199], a[8:11]
  s_add_u32 m0, s31, 16384
  ds_read_b64_tr_b16 a[188:189], v55 offset:32904
  v_mfma_f32_16x16x32_bf16 a[16:19], a[160:163], a[200:203], a[16:19]
  buffer_load_dwordx4 v17, s[12:15], s35 offen nt lds
  v_mfma_f32_16x16x32_bf16 a[24:27], a[160:163], a[204:207], a[24:27]
  ds_read_b64_tr_b16 a[190:191], v55 offset:33928
  v_mfma_f32_16x16x32_bf16 a[32:35], a[160:163], a[208:211], a[32:35]
  ds_read_b64_tr_b16 a[160:161], v52 offset:32896
  v_mfma_f32_16x16x32_bf16 a[4:7], a[164:167], a[192:195], a[4:7]
  ds_read_b64_tr_b16 a[162:163], v52 offset:33920
  v_mfma_f32_16x16x32_bf16 a[12:15], a[164:167], a[196:199], a[12:15]
  buffer_load_dwordx4 v18, s[12:15], s35 offen offset:1024 nt lds
  v_mfma_f32_16x16x32_bf16 a[20:23], a[164:167], a[200:203], a[20:23]
  ds_read_b64_tr_b16 a[184:185], v55 offset:32896
  v_mfma_f32_16x16x32_bf16 a[28:31], a[164:167], a[204:207], a[28:31]
  ds_read_b64_tr_b16 a[186:187], v55 offset:33920
  v_mfma_f32_16x16x32_bf16 a[36:39], a[164:167], a[208:211], a[36:39]
  ds_read_b64_tr_b16 a[164:165], v52 offset:32904
  v_mfma_f32_16x16x32_bf16 a[40:43], a[168:171], a[192:195], a[40:43]
  buffer_load_dwordx4 v19, s[12:15], s35 offen offset:2048 nt lds
  v_mfma_f32_16x16x32_bf16 a[48:51], a[168:171], a[196:199], a[48:51]
  ds_read_b64_tr_b16 a[166:167], v52 offset:33928
  v_mfma_f32_16x16x32_bf16 a[56:59], a[168:171], a[200:203], a[56:59]
  v_mfma_f32_16x16x32_bf16 a[64:67], a[168:171], a[204:207], a[64:67]
  v_mfma_f32_16x16x32_bf16 a[72:75], a[168:171], a[208:211], a[72:75]
  buffer_load_dwordx4 v20, s[12:15], s35 offen offset:3072 nt lds
  v_mfma_f32_16x16x32_bf16 a[44:47], a[172:175], a[192:195], a[44:47]
  s_add_u32 s35, s35, s36
  s_andn2_b32 s35, s35, s70
  ds_read_b64_tr_b16 a[168:169], v53 offset:32896
  v_mfma_f32_16x16x32_bf16 a[52:55], a[172:175], a[196:199], a[52:55]
  ds_read_b64_tr_b16 a[170:171], v53 offset:33920
  v_mfma_f32_16x16x32_bf16 a[60:63], a[172:175], a[200:203], a[60:63]
  v_mfma_f32_16x16x32_bf16 a[68:71], a[172:175], a[204:207], a[68:71]
  v_mfma_f32_16x16x32_bf16 a[76:79], a[172:175], a[208:211], a[76:79]
  ds_read_b64_tr_b16 a[172:173], v53 offset:32904
  v_mfma_f32_16x16x32_bf16 a[80:83], a[176:179], a[192:195], a[80:83]
  ds_read_b64_tr_b16 a[174:175], v53 offset:33928
  v_mfma_f32_16x16x32_bf16 a[88:91], a[176:179], a[196:199], a[88:91]
  v_mfma_f32_16x16x32_bf16 a[96:99], a[176:179], a[200:203], a[96:99]
  v_mfma_f32_16x16x32_bf16 a[104:107], a[176:179], a[204:207], a[104:107]
  v_mfma_f32_16x16x32_bf16 a[112:115], a[176:179], a[208:211], a[112:115]
  ds_read_b64_tr_b16 a[176:177], v54 offset:32896
  v_mfma_f32_16x16x32_bf16 a[84:87], a[180:183], a[192:195], a[84:87]
  ds_read_b64_tr_b16 a[178:179], v54 offset:33920
  v_mfma_f32_16x16x32_bf16 a[92:95], a[180:183], a[196:199], a[92:95]
  v_mfma_f32_16x16x32_bf16 a[100:103], a[180:183], a[200:203], a[100:103]
  v_mfma_f32_16x16x32_bf16 a[108:111], a[180:183], a[204:207], a[108:111]
  v_mfma_f32_16x16x32_bf16 a[116:119], a[180:183], a[208:211], a[116:119]
  ds_read_b64_tr_b16 a[180:181], v54 offset:32904
  v_mfma_f32_16x16x32_bf16 a[120:123], a[252:255], a[192:195], a[120:123]
  ds_read_b64_tr_b16 a[182:183], v54 offset:33928
  v_mfma_f32_16x16x32_bf16 a[128:131], a[252:255], a[196:199], a[128:131]
  v_mfma_f32_16x16x32_bf16 a[136:139], a[252:255], a[200:203], a[136:139]
  v_mfma_f32_16x16x32_bf16 a[144:147], a[252:255], a[204:207], a[144:147]
  v_mfma_f32_16x16x32_bf16 a[152:155], a[252:255], a[208:211], a[152:155]
  v_mfma_f32_16x16x32_bf16 a[124:127], a[248:251], a[192:195], a[124:127]
  v_mfma_f32_16x16x32_bf16 a[132:135], a[248:251], a[196:199], a[132:135]
  v_mfma_f32_16x16x32_bf16 a[140:143], a[248:251], a[200:203], a[140:143]
  v_mfma_f32_16x16x32_bf16 a[148:151], a[248:251], a[204:207], a[148:151]
  s_waitcnt lgkmcnt(0)
  v_mfma_f32_16x16x32_bf16 a[156:159], a[248:251], a[208:211], a[156:159]
  v_mfma_f32_16x16x32_bf16 v[96:99], a[160:163], a[212:215], v[96:99]
  s_waitcnt vmcnt(8)
  s_barrier
  v_mfma_f32_16x16x32_bf16 v[104:107], a[160:163], a[216:219], v[104:107]
  s_add_u32 m0, s31, 32768
  ds_read_b64_tr_b16 a[248:249], v55 offset:49352
  v_mfma_f32_16x16x32_bf16 v[112:115], a[160:163], a[220:223], v[112:115]
  buffer_load_dwordx4 v17, s[12:15], s35 offen nt lds
  v_mfma_f32_16x16x32_bf16 v[120:123], a[160:163], a[224:227], v[120:123]
  ds_read_b64_tr_b16 a[250:251], v55 offset:50376
  v_mfma_f32_16x16x32_bf16 v[128:131], a[160:163], a[228:231], v[128:131]
  ds_read_b64_tr_b16 a[160:161], v52 offset:49344
  v_mfma_f32_16x16x32_bf16 v[100:103], a[164:167], a[212:215], v[100:103]
  ds_read_b64_tr_b16 a[162:163], v52 offset:50368
  v_mfma_f32_16x16x32_bf16 v[108:111], a[164:167], a[216:219], v[108:111]
  buffer_load_dwordx4 v18, s[12:15], s35 offen offset:1024 nt lds
  v_mfma_f32_16x16x32_bf16 v[116:119], a[164:167], a[220:223], v[116:119]
  ds_read_b64_tr_b16 a[252:253], v55 offset:49344
  v_mfma_f32_16x16x32_bf16 v[124:127], a[164:167], a[224:227], v[124:127]
  ds_read_b64_tr_b16 a[254:255], v55 offset:50368
  v_mfma_f32_16x16x32_bf16 v[132:135], a[164:167], a[228:231], v[132:135]
  ds_read_b64_tr_b16 a[164:165], v52 offset:49352
  v_mfma_f32_16x16x32_bf16 v[136:139], a[168:171], a[212:215], v[136:139]
  buffer_load_dwordx4 v19, s[12:15], s35 offen offset:2048 nt lds
  v_mfma_f32_16x16x32_bf16 v[144:147], a[168:171], a[216:219], v[144:147]
  ds_read_b64_tr_b16 a[166:167], v52 offset:50376
  v_mfma_f32_16x16x32_bf16 v[152:155], a[168:171], a[220:223], v[152:155]
  v_mfma_f32_16x16x32_bf16 v[160:163], a[168:171], a[224:227], v[160:163]
  v_mfma_f32_16x16x32_bf16 v[168:171], a[168:171], a[228:231], v[168:171]
  buffer_load_dwordx4 v20, s[12:15], s35 offen offset:3072 nt lds
  v_mfma_f32_16x16x32_bf16 v[140:143], a[172:175], a[212:215], v[140:143]
  s_add_u32 s35, s35, s36
  s_andn2_b32 s35, s35, s70
  ds_read_b64_tr_b16 a[168:169], v53 offset:49344
  v_mfma_f32_16x16x32_bf16 v[148:151], a[172:175], a[216:219], v[148:151]
  ds_read_b64_tr_b16 a[170:171], v53 offset:50368
  v_mfma_f32_16x16x32_bf16 v[156:159], a[172:175], a[220:223], v[156:159]
  v_mfma_f32_16x16x32_bf16 v[164:167], a[172:175], a[224:227], v[164:167]
  v_mfma_f32_16x16x32_bf16 v[172:175], a[172:175], a[228:231], v[172:175]
  ds_read_b64_tr_b16 a[172:173], v53 offset:49352
  v_mfma_f32_16x16x32_bf16 v[176:179], a[176:179], a[212:215], v[176:179]
  ds_read_b64_tr_b16 a[174:175], v53 offset:50376
  v_mfma_f32_16x16x32_bf16 v[184:187], a[176:179], a[216:219], v[184:187]
  v_mfma_f32_16x16x32_bf16 v[192:195], a[176:179], a[220:223], v[192:195]
  v_mfma_f32_16x16x32_bf16 v[200:203], a[176:179], a[224:227], v[200:203]
  v_mfma_f32_16x16x32_bf16 v[208:211], a[176:179], a[228:231], v[208:211]
  ds_read_b64_tr_b16 a[176:177], v54 offset:49344
  v_mfma_f32_16x16x32_bf16 v[180:183], a[180:183], a[212:215], v[180:183]
  ds_read_b64_tr_b16 a[178:179], v54 offset:50368
  v_mfma_f32_16x16x32_bf16 v[188:191], a[180:183], a[216:219], v[188:191]
  v_mfma_f32_16x16x32_bf16 v[196:199], a[180:183], a[220:223], v[196:199]
  v_mfma_f32_16x16x32_bf16 v[204:207], a[180:183], a[224:227], v[204:207]
  v_mfma_f32_16x16x32_bf16 v[212:215], a[180:183], a[228:231], v[212:215]
  ds_read_b64_tr_b16 a[180:181], v54 offset:49352
  v_mfma_f32_16x16x32_bf16 v[216:219], a[184:187], a[212:215], v[216:219]
  ds_read_b64_tr_b16 a[182:183], v54 offset:50376
  v_mfma_f32_16x16x32_bf16 v[224:227], a[184:187], a[216:219], v[224:227]
  v_mfma_f32_16x16x32_bf16 v[232:235], a[184:187], a[220:223], v[232:235]
  v_mfma_f32_16x16x32_bf16 v[240:243], a[184:187], a[224:227], v[240:243]
  v_mfma_f32_16x16x32_bf16 v[248:251], a[184:187], a[228:231], v[248:251]
  v_mfma_f32_16x16x32_bf16 v[220:223], a[188:191], a[212:215], v[220:223]
  v_mfma_f32_16x16x32_bf16 v[228:231], a[188:191], a[216:219], v[228:231]
  v_mfma_f32_16x16x32_bf16 v[236:239], a[188:191], a[220:223], v[236:239]
  v_mfma_f32_16x16x32_bf16 v[244:247], a[188:191], a[224:227], v[244:247]
  s_waitcnt lgkmcnt(0)
  v_mfma_f32_16x16x32_bf16 v[252:255], a[188:191], a[228:231], v[252:255]
  v_mfma_f32_16x16x32_bf16 a[0:3], a[160:163], a[212:215], a[0:3]
  s_waitcnt vmcnt(60)
  s_barrier
  v_mfma_f32_16x16x32_bf16 a[8:11], a[160:163], a[216:219], a[8:11]
  s_add_u32 m0, s31, 114944
  ds_read_b128 a[184:187], v3 offset:4096
  v_mfma_f32_16x16x32_bf16 a[16:19], a[160:163], a[220:223], a[16:19]
  buffer_load_dwordx4 v13, s[8:11], s34 offen nt lds
  v_mfma_f32_16x16x32_bf16 a[24:27], a[160:163], a[224:227], a[24:27]
  ds_read_b128 a[188:191], v4 offset:4096
  v_mul_f32 v96, s40, v96
  v_mfma_f32_16x16x32_bf16 a[32:35], a[160:163], a[228:231], a[32:35]
  ds_read_b128 a[160:163], v1 offset:0
  v_mul_f32 v97, s40, v97
  v_mfma_f32_16x16x32_bf16 a[4:7], a[164:167], a[212:215], a[4:7]
  v_mul_f32 v98, s40, v98
  v_mul_f32 v99, s40, v99
  v_mfma_f32_16x16x32_bf16 a[12:15], a[164:167], a[216:219], a[12:15]
  buffer_load_dwordx4 v14, s[8:11], s34 offen offset:1024 nt lds
  v_mfma_f32_16x16x32_bf16 a[20:23], a[164:167], a[220:223], a[20:23]
  v_mul_f32 v100, s40, v100
  v_mul_f32 v101, s40, v101
  v_mfma_f32_16x16x32_bf16 a[28:31], a[164:167], a[224:227], a[28:31]
  v_mul_f32 v102, s40, v102
  v_mul_f32 v103, s40, v103
  v_mfma_f32_16x16x32_bf16 a[36:39], a[164:167], a[228:231], a[36:39]
  ds_read_b128 a[164:167], v2 offset:0
  v_cvt_pk_bf16_f32 v96, v96, v97
  v_mfma_f32_16x16x32_bf16 a[40:43], a[168:171], a[212:215], a[40:43]
  buffer_load_dwordx4 v15, s[8:11], s34 offen offset:2048 nt lds
  v_mfma_f32_16x16x32_bf16 a[48:51], a[168:171], a[216:219], a[48:51]
  v_cvt_pk_bf16_f32 v97, v98, v99
  v_cvt_pk_bf16_f32 v98, v100, v101
  v_mfma_f32_16x16x32_bf16 a[56:59], a[168:171], a[220:223], a[56:59]
  v_cvt_pk_bf16_f32 v99, v102, v103
  v_mul_f32 v104, s40, v104
  v_mfma_f32_16x16x32_bf16 a[64:67], a[168:171], a[224:227], a[64:67]
  v_mul_f32 v105, s40, v105
  v_mul_f32 v106, s40, v106
  v_mfma_f32_16x16x32_bf16 a[72:75], a[168:171], a[228:231], a[72:75]
  buffer_load_dwordx4 v16, s[8:11], s34 offen offset:3072 nt lds
  v_mfma_f32_16x16x32_bf16 a[44:47], a[172:175], a[212:215], a[44:47]
  s_add_u32 s34, s34, 8192
  s_bitset0_b32 s34, 17
  ds_read_b128 a[168:171], v3 offset:0
  v_mfma_f32_16x16x32_bf16 a[52:55], a[172:175], a[216:219], a[52:55]
  v_mul_f32 v107, s40, v107
  v_mul_f32 v108, s40, v108
  v_mfma_f32_16x16x32_bf16 a[60:63], a[172:175], a[220:223], a[60:63]
  v_mul_f32 v109, s40, v109
  v_mul_f32 v110, s40, v110
  v_mfma_f32_16x16x32_bf16 a[68:71], a[172:175], a[224:227], a[68:71]
  v_mul_f32 v111, s40, v111
  v_cvt_pk_bf16_f32 v104, v104, v105
  v_mfma_f32_16x16x32_bf16 a[76:79], a[172:175], a[228:231], a[76:79]
  ds_read_b128 a[172:175], v4 offset:0
  v_cvt_pk_bf16_f32 v105, v106, v107
  v_mfma_f32_16x16x32_bf16 a[80:83], a[176:179], a[212:215], a[80:83]
  v_cvt_pk_bf16_f32 v106, v108, v109
  v_cvt_pk_bf16_f32 v107, v110, v111
  v_mfma_f32_16x16x32_bf16 a[88:91], a[176:179], a[216:219], a[88:91]
  v_mul_f32 v112, s40, v112
  v_mul_f32 v113, s40, v113
  v_mfma_f32_16x16x32_bf16 a[96:99], a[176:179], a[220:223], a[96:99]
  v_mul_f32 v114, s40, v114
  v_mul_f32 v115, s40, v115
  v_mfma_f32_16x16x32_bf16 a[104:107], a[176:179], a[224:227], a[104:107]
  v_mul_f32 v116, s40, v116
  v_mul_f32 v117, s40, v117
  v_mfma_f32_16x16x32_bf16 a[112:115], a[176:179], a[228:231], a[112:115]
  ds_read_b128 a[176:179], v1 offset:4096
  v_mul_f32 v118, s40, v118
  v_mfma_f32_16x16x32_bf16 a[84:87], a[180:183], a[212:215], a[84:87]
  v_mul_f32 v119, s40, v119
  v_cvt_pk_bf16_f32 v112, v112, v113
  v_mfma_f32_16x16x32_bf16 a[92:95], a[180:183], a[216:219], a[92:95]
  v_cvt_pk_bf16_f32 v113, v114, v115
  v_cvt_pk_bf16_f32 v114, v116, v117
  v_mfma_f32_16x16x32_bf16 a[100:103], a[180:183], a[220:223], a[100:103]
  v_cvt_pk_bf16_f32 v115, v118, v119
  v_mul_f32 v120, s40, v120
  v_mfma_f32_16x16x32_bf16 a[108:111], a[180:183], a[224:227], a[108:111]
  v_mul_f32 v121, s40, v121
  v_mul_f32 v122, s40, v122
  v_mfma_f32_16x16x32_bf16 a[116:119], a[180:183], a[228:231], a[116:119]
  ds_read_b128 a[180:183], v2 offset:4096
  v_mul_f32 v123, s40, v123
  v_mfma_f32_16x16x32_bf16 a[120:123], a[252:255], a[212:215], a[120:123]
  v_mul_f32 v124, s40, v124
  v_mul_f32 v125, s40, v125
  v_mfma_f32_16x16x32_bf16 a[128:131], a[252:255], a[216:219], a[128:131]
  v_mul_f32 v126, s40, v126
  v_mul_f32 v127, s40, v127
  v_mfma_f32_16x16x32_bf16 a[136:139], a[252:255], a[220:223], a[136:139]
  v_cvt_pk_bf16_f32 v120, v120, v121
  v_cvt_pk_bf16_f32 v121, v122, v123
  v_mfma_f32_16x16x32_bf16 a[144:147], a[252:255], a[224:227], a[144:147]
  v_cvt_pk_bf16_f32 v122, v124, v125
  v_cvt_pk_bf16_f32 v123, v126, v127
  v_mfma_f32_16x16x32_bf16 a[152:155], a[252:255], a[228:231], a[152:155]
  v_mul_f32 v128, s40, v128
  v_mul_f32 v129, s40, v129
  v_mfma_f32_16x16x32_bf16 a[124:127], a[248:251], a[212:215], a[124:127]
  v_mul_f32 v130, s40, v130
  v_mul_f32 v131, s40, v131
  v_mfma_f32_16x16x32_bf16 a[132:135], a[248:251], a[216:219], a[132:135]
  v_mul_f32 v132, s40, v132
  v_mul_f32 v133, s40, v133
  v_mfma_f32_16x16x32_bf16 a[140:143], a[248:251], a[220:223], a[140:143]
  v_mul_f32 v134, s40, v134
  v_mul_f32 v135, s40, v135
  v_mfma_f32_16x16x32_bf16 a[148:151], a[248:251], a[224:227], a[148:151]
  s_waitcnt lgkmcnt(0)
  v_cvt_pk_bf16_f32 v128, v128, v129
  v_cvt_pk_bf16_f32 v129, v130, v131
  v_mfma_f32_16x16x32_bf16 a[156:159], a[248:251], a[228:231], a[156:159]
  v_cvt_pk_bf16_f32 v130, v132, v133
  v_cvt_pk_bf16_f32 v131, v134, v135
L_qepi:
  s_nop 7
  v_accvgpr_read_b32 v64, a152
  v_accvgpr_read_b32 v65, a153
  v_accvgpr_read_b32 v66, a154
  v_accvgpr_read_b32 v67, a155
  v_accvgpr_read_b32 v68, a156
  v_accvgpr_read_b32 v69, a157
  v_accvgpr_read_b32 v70, a158
  v_accvgpr_read_b32 v71, a159
  v_pk_mul_f32 v[64:65], v[64:65], s[40:41]
  v_pk_mul_f32 v[66:67], v[66:67], s[40:41]
  v_pk_mul_f32 v[68:69], v[68:69], s[40:41]
  v_pk_mul_f32 v[70:71], v[70:71], s[40:41]
  v_cvt_pk_bf16_f32 v64, v64, v65
  v_cvt_pk_bf16_f32 v65, v66, v67
  v_cvt_pk_bf16_f32 v66, v68, v69
  v_cvt_pk_bf16_f32 v67, v70, v71
  v_accvgpr_write_b32 a156, v64
  v_accvgpr_write_b32 a157, v65
  v_accvgpr_write_b32 a158, v66
  v_accvgpr_write_b32 a159, v67
  v_accvgpr_read_b32 v56, a144
  v_accvgpr_read_b32 v57, a145
  v_accvgpr_read_b32 v58, a146
  v_accvgpr_read_b32 v59, a147
  v_accvgpr_read_b32 v60, a148
  v_accvgpr_read_b32 v61, a149
  v_accvgpr_read_b32 v62, a150
  v_accvgpr_read_b32 v63, a151
  v_pk_mul_f32 v[56:57], v[56:57], s[40:41]
  v_pk_mul_f32 v[58:59], v[58:59], s[40:41]
  v_pk_mul_f32 v[60:61], v[60:61], s[40:41]
  v_pk_mul_f32 v[62:63], v[62:63], s[40:41]
  v_cvt_pk_bf16_f32 v56, v56, v57
  v_cvt_pk_bf16_f32 v57, v58, v59
  v_cvt_pk_bf16_f32 v58, v60, v61
  v_cvt_pk_bf16_f32 v59, v62, v63
  v_accvgpr_write_b32 a152, v56
  v_accvgpr_write_b32 a153, v57
  v_accvgpr_write_b32 a154, v58
  v_accvgpr_write_b32 a155, v59
  v_accvgpr_read_b32 v64, a136
  v_accvgpr_read_b32 v65, a137
  v_accvgpr_read_b32 v66, a138
  v_accvgpr_read_b32 v67, a139
  v_accvgpr_read_b32 v68, a140
  v_accvgpr_read_b32 v69, a141
  v_accvgpr_read_b32 v70, a142
  v_accvgpr_read_b32 v71, a143
  v_pk_mul_f32 v[64:65], v[64:65], s[40:41]
  v_pk_mul_f32 v[66:67], v[66:67], s[40:41]
  v_pk_mul_f32 v[68:69], v[68:69], s[40:41]
  v_pk_mul_f32 v[70:71], v[70:71], s[40:41]
  v_cvt_pk_bf16_f32 v64, v64, v65
  v_cvt_pk_bf16_f32 v65, v66, v67
  v_cvt_pk_bf16_f32 v66, v68, v69
  v_cvt_pk_bf16_f32 v67, v70, v71
  v_accvgpr_write_b32 a148, v64
  v_accvgpr_write_b32 a149, v65
  v_accvgpr_write_b32 a150, v66
  v_accvgpr_write_b32 a151, v67
  v_accvgpr_read_b32 v56, a128
  v_accvgpr_read_b32 v57, a129
  v_accvgpr_read_b32 v58, a130
  v_accvgpr_read_b32 v59, a131
  v_accvgpr_read_b32 v60, a132
  v_accvgpr_read_b32 v61, a133
  v_accvgpr_read_b32 v62, a134
  v_accvgpr_read_b32 v63, a135
  v_pk_mul_f32 v[56:57], v[56:57], s[40:41]
  v_pk_mul_f32 v[58:59], v[58:59], s[40:41]
  v_pk_mul_f32 v[60:61], v[60:61], s[40:41]
  v_pk_mul_f32 v[62:63], v[62:63], s[40:41]
  v_cvt_pk_bf16_f32 v56, v56, v57
  v_cvt_pk_bf16_f32 v57, v58, v59
  v_cvt_pk_bf16_f32 v58, v60, v61
  v_cvt_pk_bf16_f32 v59, v62, v63
  v_accvgpr_write_b32 a144, v56
  v_accvgpr_write_b32 a145, v57
  v_accvgpr_write_b32 a146, v58
  v_accvgpr_write_b32 a147, v59
  v_accvgpr_read_b32 v64, a120
  v_accvgpr_read_b32 v65, a121
  v_accvgpr_read_b32 v66, a122
  v_accvgpr_read_b32 v67, a123
  v_accvgpr_read_b32 v68, a124
  v_accvgpr_read_b32 v69, a125
  v_accvgpr_read_b32 v70, a126
  v_accvgpr_read_b32 v71, a127
  v_pk_mul_f32 v[64:65], v[64:65], s[40:41]
  v_pk_mul_f32 v[66:67], v[66:67], s[40:41]
  v_pk_mul_f32 v[68:69], v[68:69], s[40:41]
  v_pk_mul_f32 v[70:71], v[70:71], s[40:41]
  v_cvt_pk_bf16_f32 v64, v64, v65
  v_cvt_pk_bf16_f32 v65, v66, v67
  v_cvt_pk_bf16_f32 v66, v68, v69
  v_cvt_pk_bf16_f32 v67, v70, v71
  v_accvgpr_write_b32 a140, v64
  v_accvgpr_write_b32 a141, v65
  v_accvgpr_write_b32 a142, v66
  v_accvgpr_write_b32 a143, v67
  v_accvgpr_read_b32 v56, a112
  v_accvgpr_read_b32 v57, a113
  v_accvgpr_read_b32 v58, a114
  v_accvgpr_read_b32 v59, a115
  v_accvgpr_read_b32 v60, a116
  v_accvgpr_read_b32 v61, a117
  v_accvgpr_read_b32 v62, a118
  v_accvgpr_read_b32 v63, a119
  v_pk_mul_f32 v[56:57], v[56:57], s[40:41]
  v_pk_mul_f32 v[58:59], v[58:59], s[40:41]
  v_pk_mul_f32 v[60:61], v[60:61], s[40:41]
  v_pk_mul_f32 v[62:63], v[62:63], s[40:41]
  v_cvt_pk_bf16_f32 v56, v56, v57
  v_cvt_pk_bf16_f32 v57, v58, v59
  v_cvt_pk_bf16_f32 v58, v60, v61
  v_cvt_pk_bf16_f32 v59, v62, v63
  v_accvgpr_write_b32 a136, v56
  v_accvgpr_write_b32 a137, v57
  v_accvgpr_write_b32 a138, v58
  v_accvgpr_write_b32 a139, v59
  v_accvgpr_read_b32 v64, a104
  v_accvgpr_read_b32 v65, a105
  v_accvgpr_read_b32 v66, a106
  v_accvgpr_read_b32 v67, a107
  v_accvgpr_read_b32 v68, a108
  v_accvgpr_read_b32 v69, a109
  v_accvgpr_read_b32 v70, a110
  v_accvgpr_read_b32 v71, a111
  v_pk_mul_f32 v[64:65], v[64:65], s[40:41]
  v_pk_mul_f32 v[66:67], v[66:67], s[40:41]
  v_pk_mul_f32 v[68:69], v[68:69], s[40:41]
  v_pk_mul_f32 v[70:71], v[70:71], s[40:41]
  v_cvt_pk_bf16_f32 v64, v64, v65
  v_cvt_pk_bf16_f32 v65, v66, v67
  v_cvt_pk_bf16_f32 v66, v68, v69
  v_cvt_pk_bf16_f32 v67, v70, v71
  v_accvgpr_write_b32 a132, v64
  v_accvgpr_write_b32 a133, v65
  v_accvgpr_write_b32 a134, v66
  v_accvgpr_write_b32 a135, v67
  v_accvgpr_read_b32 v56, a96
  v_accvgpr_read_b32 v57, a97
  v_accvgpr_read_b32 v58, a98
  v_accvgpr_read_b32 v59, a99
  v_accvgpr_read_b32 v60, a100
  v_accvgpr_read_b32 v61, a101
  v_accvgpr_read_b32 v62, a102
  v_accvgpr_read_b32 v63, a103
  v_pk_mul_f32 v[56:57], v[56:57], s[40:41]
  v_pk_mul_f32 v[58:59], v[58:59], s[40:41]
  v_pk_mul_f32 v[60:61], v[60:61], s[40:41]
  v_pk_mul_f32 v[62:63], v[62:63], s[40:41]
  v_cvt_pk_bf16_f32 v56, v56, v57
  v_cvt_pk_bf16_f32 v57, v58, v59
  v_cvt_pk_bf16_f32 v58, v60, v61
  v_cvt_pk_bf16_f32 v59, v62, v63
  v_accvgpr_write_b32 a128, v56
  v_accvgpr_write_b32 a129, v57
  v_accvgpr_write_b32 a130, v58
  v_accvgpr_write_b32 a131, v59
  v_accvgpr_read_b32 v64, a88
  v_accvgpr_read_b32 v65, a89
  v_accvgpr_read_b32 v66, a90
  v_accvgpr_read_b32 v67, a91
  v_accvgpr_read_b32 v68, a92
  v_accvgpr_read_b32 v69, a93
  v_accvgpr_read_b32 v70, a94
  v_accvgpr_read_b32 v71, a95
  v_pk_mul_f32 v[64:65], v[64:65], s[40:41]
  v_pk_mul_f32 v[66:67], v[66:67], s[40:41]
  v_pk_mul_f32 v[68:69], v[68:69], s[40:41]
  v_pk_mul_f32 v[70:71], v[70:71], s[40:41]
  v_cvt_pk_bf16_f32 v64, v64, v65
  v_cvt_pk_bf16_f32 v65, v66, v67
  v_cvt_pk_bf16_f32 v66, v68, v69
  v_cvt_pk_bf16_f32 v67, v70, v71
  v_accvgpr_write_b32 a124, v64
  v_accvgpr_write_b32 a125, v65
  v_accvgpr_write_b32 a126, v66
  v_lshrrev_b32 v34, 3, v0
  v_min_u32 v34, 5, v34
  s_and_b32 s48, s30, 1
  s_mul_i32 s48, s48, 0xc000
  s_add_u32 s48, s48, s71
  s_add_u32 s48, s48, 0x8000
  v_lshl_add_u32 v34, v34, 13, s48
  v_and_b32 v34, 0x1ffff, v34
  v_and_b32 v35, 7, v0
  v_lshl_add_u32 v34, v35, 7, v34
  s_mov_b32 s48, 0
  v_accvgpr_write_b32 a127, v67
  v_accvgpr_read_b32 v56, a80
  buffer_load_dword v35, v34, s[8:11], s48 offen
  v_accvgpr_read_b32 v57, a81
  v_accvgpr_read_b32 v58, a82
  v_accvgpr_read_b32 v59, a83
  v_accvgpr_read_b32 v60, a84
  v_accvgpr_read_b32 v61, a85
  v_accvgpr_read_b32 v62, a86
  v_accvgpr_read_b32 v63, a87
  v_pk_mul_f32 v[56:57], v[56:57], s[40:41]
  v_pk_mul_f32 v[58:59], v[58:59], s[40:41]
  v_pk_mul_f32 v[60:61], v[60:61], s[40:41]
  v_pk_mul_f32 v[62:63], v[62:63], s[40:41]
  v_cvt_pk_bf16_f32 v56, v56, v57
  v_cvt_pk_bf16_f32 v57, v58, v59
  v_cvt_pk_bf16_f32 v58, v60, v61
  v_cvt_pk_bf16_f32 v59, v62, v63
  v_accvgpr_write_b32 a120, v56
  v_accvgpr_write_b32 a121, v57
  v_accvgpr_write_b32 a122, v58
  v_accvgpr_write_b32 a123, v59
  v_accvgpr_read_b32 v64, a72
  v_accvgpr_read_b32 v65, a73
  v_accvgpr_read_b32 v66, a74
  v_accvgpr_read_b32 v67, a75
  v_accvgpr_read_b32 v68, a76
  v_accvgpr_read_b32 v69, a77
  v_accvgpr_read_b32 v70, a78
  v_accvgpr_read_b32 v71, a79
  v_pk_mul_f32 v[64:65], v[64:65], s[40:41]
  v_pk_mul_f32 v[66:67], v[66:67], s[40:41]
  v_pk_mul_f32 v[68:69], v[68:69], s[40:41]
  v_pk_mul_f32 v[70:71], v[70:71], s[40:41]
  v_cvt_pk_bf16_f32 v64, v64, v65
  v_cvt_pk_bf16_f32 v65, v66, v67
  v_cvt_pk_bf16_f32 v66, v68, v69
  v_cvt_pk_bf16_f32 v67, v70, v71
  v_accvgpr_write_b32 a116, v64
  v_accvgpr_write_b32 a117, v65
  v_accvgpr_write_b32 a118, v66
  v_accvgpr_write_b32 a119, v67
  v_accvgpr_read_b32 v56, a64
  v_accvgpr_read_b32 v57, a65
  v_accvgpr_read_b32 v58, a66
  v_accvgpr_read_b32 v59, a67
  v_accvgpr_read_b32 v60, a68
  v_accvgpr_read_b32 v61, a69
  v_accvgpr_read_b32 v62, a70
  v_accvgpr_read_b32 v63, a71
  v_pk_mul_f32 v[56:57], v[56:57], s[40:41]
  v_pk_mul_f32 v[58:59], v[58:59], s[40:41]
  v_pk_mul_f32 v[60:61], v[60:61], s[40:41]
  v_pk_mul_f32 v[62:63], v[62:63], s[40:41]
  v_cvt_pk_bf16_f32 v56, v56, v57
  v_cvt_pk_bf16_f32 v57, v58, v59
  v_cvt_pk_bf16_f32 v58, v60, v61
  v_cvt_pk_bf16_f32 v59, v62, v63
  v_accvgpr_write_b32 a112, v56
  v_accvgpr_write_b32 a113, v57
  v_accvgpr_write_b32 a114, v58
  v_accvgpr_write_b32 a115, v59
  v_accvgpr_read_b32 v64, a56
  v_accvgpr_read_b32 v65, a57
  v_accvgpr_read_b32 v66, a58
  v_accvgpr_read_b32 v67, a59
  v_accvgpr_read_b32 v68, a60
  v_accvgpr_read_b32 v69, a61
  v_accvgpr_read_b32 v70, a62
  v_accvgpr_read_b32 v71, a63
  v_pk_mul_f32 v[64:65], v[64:65], s[40:41]
  v_pk_mul_f32 v[66:67], v[66:67], s[40:41]
  v_pk_mul_f32 v[68:69], v[68:69], s[40:41]
  v_pk_mul_f32 v[70:71], v[70:71], s[40:41]
  v_cvt_pk_bf16_f32 v64, v64, v65
  v_cvt_pk_bf16_f32 v65, v66, v67
  v_cvt_pk_bf16_f32 v66, v68, v69
  v_cvt_pk_bf16_f32 v67, v70, v71
  v_accvgpr_write_b32 a108, v64
  v_accvgpr_write_b32 a109, v65
  v_accvgpr_write_b32 a110, v66
  v_accvgpr_write_b32 a111, v67
  v_accvgpr_read_b32 v56, a48
  v_accvgpr_read_b32 v57, a49
  v_accvgpr_read_b32 v58, a50
  v_accvgpr_read_b32 v59, a51
  v_accvgpr_read_b32 v60, a52
  v_accvgpr_read_b32 v61, a53
  v_accvgpr_read_b32 v62, a54
  v_accvgpr_read_b32 v63, a55
  v_pk_mul_f32 v[56:57], v[56:57], s[40:41]
  v_pk_mul_f32 v[58:59], v[58:59], s[40:41]
  v_pk_mul_f32 v[60:61], v[60:61], s[40:41]
  v_pk_mul_f32 v[62:63], v[62:63], s[40:41]
  v_cvt_pk_bf16_f32 v56, v56, v57
  v_cvt_pk_bf16_f32 v57, v58, v59
  v_cvt_pk_bf16_f32 v58, v60, v61
  v_cvt_pk_bf16_f32 v59, v62, v63
  v_accvgpr_write_b32 a104, v56
  v_accvgpr_write_b32 a105, v57
  v_accvgpr_write_b32 a106, v58
  v_accvgpr_write_b32 a107, v59
  v_accvgpr_read_b32 v64, a40
  v_accvgpr_read_b32 v65, a41
  v_accvgpr_read_b32 v66, a42
  v_accvgpr_read_b32 v67, a43
  v_accvgpr_read_b32 v68, a44
  v_accvgpr_read_b32 v69, a45
  v_accvgpr_read_b32 v70, a46
  v_accvgpr_read_b32 v71, a47
  v_pk_mul_f32 v[64:65], v[64:65], s[40:41]
  v_pk_mul_f32 v[66:67], v[66:67], s[40:41]
  v_pk_mul_f32 v[68:69], v[68:69], s[40:41]
  v_pk_mul_f32 v[70:71], v[70:71], s[40:41]
  v_cvt_pk_bf16_f32 v64, v64, v65
  v_cvt_pk_bf16_f32 v65, v66, v67
  v_cvt_pk_bf16_f32 v66, v68, v69
  v_cvt_pk_bf16_f32 v67, v70, v71
  v_accvgpr_write_b32 a100, v64
  v_accvgpr_write_b32 a101, v65
  v_accvgpr_write_b32 a102, v66
  v_accvgpr_write_b32 a103, v67
  v_accvgpr_read_b32 v56, a32
  v_accvgpr_read_b32 v57, a33
  v_accvgpr_read_b32 v58, a34
  v_accvgpr_read_b32 v59, a35
  v_accvgpr_read_b32 v60, a36
  v_accvgpr_read_b32 v61, a37
  v_accvgpr_read_b32 v62, a38
  v_accvgpr_read_b32 v63, a39
  v_pk_mul_f32 v[56:57], v[56:57], s[40:41]
  v_pk_mul_f32 v[58:59], v[58:59], s[40:41]
  v_pk_mul_f32 v[60:61], v[60:61], s[40:41]
  v_pk_mul_f32 v[62:63], v[62:63], s[40:41]
  v_cvt_pk_bf16_f32 v56, v56, v57
  v_cvt_pk_bf16_f32 v57, v58, v59
  v_cvt_pk_bf16_f32 v58, v60, v61
  v_cvt_pk_bf16_f32 v59, v62, v63
  v_accvgpr_write_b32 a96, v56
  v_accvgpr_write_b32 a97, v57
  v_accvgpr_write_b32 a98, v58
  v_accvgpr_write_b32 a99, v59
  v_accvgpr_read_b32 v64, a24
  v_accvgpr_read_b32 v65, a25
  v_accvgpr_read_b32 v66, a26
  v_accvgpr_read_b32 v67, a27
  v_accvgpr_read_b32 v68, a28
  v_accvgpr_read_b32 v69, a29
  v_accvgpr_read_b32 v70, a30
  v_accvgpr_read_b32 v71, a31
  v_pk_mul_f32 v[64:65], v[64:65], s[40:41]
  v_pk_mul_f32 v[66:67], v[66:67], s[40:41]
  v_pk_mul_f32 v[68:69], v[68:69], s[40:41]
  v_pk_mul_f32 v[70:71], v[70:71], s[40:41]
  v_cvt_pk_bf16_f32 v64, v64, v65
  v_cvt_pk_bf16_f32 v65, v66, v67
  v_cvt_pk_bf16_f32 v66, v68, v69
  v_cvt_pk_bf16_f32 v67, v70, v71
  v_accvgpr_write_b32 a92, v64
  v_accvgpr_write_b32 a93, v65
  v_accvgpr_write_b32 a94, v66
  v_accvgpr_write_b32 a95, v67
  v_accvgpr_read_b32 v56, a16
  v_accvgpr_read_b32 v57, a17
  v_accvgpr_read_b32 v58, a18
  v_accvgpr_read_b32 v59, a19
  v_accvgpr_read_b32 v60, a20
  v_accvgpr_read_b32 v61, a21
  v_accvgpr_read_b32 v62, a22
  v_accvgpr_read_b32 v63, a23
  v_pk_mul_f32 v[56:57], v[56:57], s[40:41]
  v_pk_mul_f32 v[58:59], v[58:59], s[40:41]
  v_pk_mul_f32 v[60:61], v[60:61], s[40:41]
  v_pk_mul_f32 v[62:63], v[62:63], s[40:41]
  v_cvt_pk_bf16_f32 v56, v56, v57
  v_cvt_pk_bf16_f32 v57, v58, v59
  v_cvt_pk_bf16_f32 v58, v60, v61
  v_cvt_pk_bf16_f32 v59, v62, v63
  v_accvgpr_write_b32 a88, v56
  v_accvgpr_write_b32 a89, v57
  v_accvgpr_write_b32 a90, v58
  v_accvgpr_write_b32 a91, v59
  v_accvgpr_read_b32 v64, a8
  v_accvgpr_read_b32 v65, a9
  v_accvgpr_read_b32 v66, a10
  v_accvgpr_read_b32 v67, a11
  v_accvgpr_read_b32 v68, a12
  v_accvgpr_read_b32 v69, a13
  v_accvgpr_read_b32 v70, a14
  v_accvgpr_read_b32 v71, a15
  v_pk_mul_f32 v[64:65], v[64:65], s[40:41]
  v_pk_mul_f32 v[66:67], v[66:67], s[40:41]
  v_pk_mul_f32 v[68:69], v[68:69], s[40:41]
  v_pk_mul_f32 v[70:71], v[70:71], s[40:41]
  v_cvt_pk_bf16_f32 v64, v64, v65
  v_cvt_pk_bf16_f32 v65, v66, v67
  v_cvt_pk_bf16_f32 v66, v68, v69
  v_cvt_pk_bf16_f32 v67, v70, v71
  v_accvgpr_write_b32 a84, v64
  v_accvgpr_write_b32 a85, v65
  v_accvgpr_write_b32 a86, v66
  v_accvgpr_write_b32 a87, v67
  v_accvgpr_read_b32 v56, a0
  v_accvgpr_read_b32 v57, a1
  v_accvgpr_read_b32 v58, a2
  v_accvgpr_read_b32 v59, a3
  v_accvgpr_read_b32 v60, a4
  v_accvgpr_read_b32 v61, a5
  v_accvgpr_read_b32 v62, a6
  v_accvgpr_read_b32 v63, a7
  v_pk_mul_f32 v[56:57], v[56:57], s[40:41]
  v_pk_mul_f32 v[58:59], v[58:59], s[40:41]
  v_pk_mul_f32 v[60:61], v[60:61], s[40:41]
  v_pk_mul_f32 v[62:63], v[62:63], s[40:41]
  v_cvt_pk_bf16_f32 v56, v56, v57
  v_cvt_pk_bf16_f32 v57, v58, v59
  v_cvt_pk_bf16_f32 v58, v60, v61
  v_cvt_pk_bf16_f32 v59, v62, v63
  v_accvgpr_write_b32 a80, v56
  v_accvgpr_write_b32 a81, v57
  v_accvgpr_write_b32 a82, v58
  v_accvgpr_write_b32 a83, v59
  v_accvgpr_write_b32 a0, v96
  v_accvgpr_write_b32 a1, v97
  v_accvgpr_write_b32 a2, v98
  v_accvgpr_write_b32 a3, v99
  v_accvgpr_write_b32 a4, v104
  v_accvgpr_write_b32 a5, v105
  v_accvgpr_write_b32 a6, v106
  v_accvgpr_write_b32 a7, v107
  v_accvgpr_write_b32 a8, v112
  v_accvgpr_write_b32 a9, v113
  v_accvgpr_write_b32 a10, v114
  v_accvgpr_write_b32 a11, v115
  v_accvgpr_write_b32 a12, v120
  v_accvgpr_write_b32 a13, v121
  v_accvgpr_write_b32 a14, v122
  v_accvgpr_write_b32 a15, v123
  v_accvgpr_write_b32 a16, v128
  v_accvgpr_write_b32 a17, v129
  v_accvgpr_write_b32 a18, v130
  v_accvgpr_write_b32 a19, v131
  v_pk_mul_f32 v[136:137], v[136:137], s[40:41]
  v_pk_mul_f32 v[138:139], v[138:139], s[40:41]
  v_pk_mul_f32 v[140:141], v[140:141], s[40:41]
  v_pk_mul_f32 v[142:143], v[142:143], s[40:41]
  v_cvt_pk_bf16_f32 v136, v136, v137
  v_cvt_pk_bf16_f32 v137, v138, v139
  v_cvt_pk_bf16_f32 v138, v140, v141
  v_cvt_pk_bf16_f32 v139, v142, v143
  v_accvgpr_write_b32 a20, v136
  v_accvgpr_write_b32 a21, v137
  v_accvgpr_write_b32 a22, v138
  v_accvgpr_write_b32 a23, v139
  v_pk_mul_f32 v[144:145], v[144:145], s[40:41]
  v_pk_mul_f32 v[146:147], v[146:147], s[40:41]
  v_pk_mul_f32 v[148:149], v[148:149], s[40:41]
  v_pk_mul_f32 v[150:151], v[150:151], s[40:41]
  v_cvt_pk_bf16_f32 v144, v144, v145
  v_cvt_pk_bf16_f32 v145, v146, v147
  v_cvt_pk_bf16_f32 v146, v148, v149
  v_cvt_pk_bf16_f32 v147, v150, v151
  v_accvgpr_write_b32 a24, v144
  v_accvgpr_write_b32 a25, v145
  v_accvgpr_write_b32 a26, v146
  v_accvgpr_write_b32 a27, v147
  v_pk_mul_f32 v[152:153], v[152:153], s[40:41]
  v_pk_mul_f32 v[154:155], v[154:155], s[40:41]
  v_pk_mul_f32 v[156:157], v[156:157], s[40:41]
  v_pk_mul_f32 v[158:159], v[158:159], s[40:41]
  v_cvt_pk_bf16_f32 v152, v152, v153
  v_cvt_pk_bf16_f32 v153, v154, v155
  v_cvt_pk_bf16_f32 v154, v156, v157
  v_cvt_pk_bf16_f32 v155, v158, v159
  v_accvgpr_write_b32 a28, v152
  v_accvgpr_write_b32 a29, v153
  v_accvgpr_write_b32 a30, v154
  v_accvgpr_write_b32 a31, v155
  v_pk_mul_f32 v[160:161], v[160:161], s[40:41]
  v_pk_mul_f32 v[162:163], v[162:163], s[40:41]
  v_pk_mul_f32 v[164:165], v[164:165], s[40:41]
  v_pk_mul_f32 v[166:167], v[166:167], s[40:41]
  v_cvt_pk_bf16_f32 v160, v160, v161
  v_cvt_pk_bf16_f32 v161, v162, v163
  v_cvt_pk_bf16_f32 v162, v164, v165
  v_cvt_pk_bf16_f32 v163, v166, v167
  v_accvgpr_write_b32 a32, v160
  v_accvgpr_write_b32 a33, v161
  v_accvgpr_write_b32 a34, v162
  v_accvgpr_write_b32 a35, v163
  v_pk_mul_f32 v[168:169], v[168:169], s[40:41]
  v_pk_mul_f32 v[170:171], v[170:171], s[40:41]
  v_pk_mul_f32 v[172:173], v[172:173], s[40:41]
  v_pk_mul_f32 v[174:175], v[174:175], s[40:41]
  v_cvt_pk_bf16_f32 v168, v168, v169
  v_cvt_pk_bf16_f32 v169, v170, v171
  v_cvt_pk_bf16_f32 v170, v172, v173
  v_cvt_pk_bf16_f32 v171, v174, v175
  v_accvgpr_write_b32 a36, v168
  v_accvgpr_write_b32 a37, v169
  v_accvgpr_write_b32 a38, v170
  v_accvgpr_write_b32 a39, v171
  v_pk_mul_f32 v[176:177], v[176:177], s[40:41]
  v_pk_mul_f32 v[178:179], v[178:179], s[40:41]
  v_pk_mul_f32 v[180:181], v[180:181], s[40:41]
  v_pk_mul_f32 v[182:183], v[182:183], s[40:41]
  v_cvt_pk_bf16_f32 v176, v176, v177
  v_cvt_pk_bf16_f32 v177, v178, v179
  v_cvt_pk_bf16_f32 v178, v180, v181
  v_cvt_pk_bf16_f32 v179, v182, v183
  v_accvgpr_write_b32 a40, v176
  v_accvgpr_write_b32 a41, v177
  v_accvgpr_write_b32 a42, v178
  v_accvgpr_write_b32 a43, v179
  v_pk_mul_f32 v[184:185], v[184:185], s[40:41]
  v_pk_mul_f32 v[186:187], v[186:187], s[40:41]
  v_pk_mul_f32 v[188:189], v[188:189], s[40:41]
  v_pk_mul_f32 v[190:191], v[190:191], s[40:41]
  v_cvt_pk_bf16_f32 v184, v184, v185
  v_cvt_pk_bf16_f32 v185, v186, v187
  v_cvt_pk_bf16_f32 v186, v188, v189
  v_cvt_pk_bf16_f32 v187, v190, v191
  v_accvgpr_write_b32 a44, v184
  v_accvgpr_write_b32 a45, v185
  v_accvgpr_write_b32 a46, v186
  v_accvgpr_write_b32 a47, v187
  v_pk_mul_f32 v[192:193], v[192:193], s[40:41]
  v_pk_mul_f32 v[194:195], v[194:195], s[40:41]
  v_pk_mul_f32 v[196:197], v[196:197], s[40:41]
  v_pk_mul_f32 v[198:199], v[198:199], s[40:41]
  v_cvt_pk_bf16_f32 v192, v192, v193
  v_cvt_pk_bf16_f32 v193, v194, v195
  v_cvt_pk_bf16_f32 v194, v196, v197
  v_cvt_pk_bf16_f32 v195, v198, v199
  v_accvgpr_write_b32 a48, v192
  v_accvgpr_write_b32 a49, v193
  v_accvgpr_write_b32 a50, v194
  v_accvgpr_write_b32 a51, v195
  v_pk_mul_f32 v[200:201], v[200:201], s[40:41]
  v_pk_mul_f32 v[202:203], v[202:203], s[40:41]
  v_pk_mul_f32 v[204:205], v[204:205], s[40:41]
  v_pk_mul_f32 v[206:207], v[206:207], s[40:41]
  v_cvt_pk_bf16_f32 v200, v200, v201
  v_cvt_pk_bf16_f32 v201, v202, v203
  v_cvt_pk_bf16_f32 v202, v204, v205
  v_cvt_pk_bf16_f32 v203, v206, v207
  v_accvgpr_write_b32 a52, v200
  v_accvgpr_write_b32 a53, v201
  v_accvgpr_write_b32 a54, v202
  v_accvgpr_write_b32 a55, v203
  v_pk_mul_f32 v[208:209], v[208:209], s[40:41]
  v_pk_mul_f32 v[210:211], v[210:211], s[40:41]
  v_pk_mul_f32 v[212:213], v[212:213], s[40:41]
  v_pk_mul_f32 v[214:215], v[214:215], s[40:41]
  v_cvt_pk_bf16_f32 v208, v208, v209
  v_cvt_pk_bf16_f32 v209, v210, v211
  v_cvt_pk_bf16_f32 v210, v212, v213
  v_cvt_pk_bf16_f32 v211, v214, v215
  v_accvgpr_write_b32 a56, v208
  v_accvgpr_write_b32 a57, v209
  v_accvgpr_write_b32 a58, v210
  v_accvgpr_write_b32 a59, v211
  v_pk_mul_f32 v[216:217], v[216:217], s[40:41]
  v_pk_mul_f32 v[218:219], v[218:219], s[40:41]
  v_pk_mul_f32 v[220:221], v[220:221], s[40:41]
  v_pk_mul_f32 v[222:223], v[222:223], s[40:41]
  v_cvt_pk_bf16_f32 v216, v216, v217
  v_cvt_pk_bf16_f32 v217, v218, v219
  v_cvt_pk_bf16_f32 v218, v220, v221
  v_cvt_pk_bf16_f32 v219, v222, v223
  v_accvgpr_write_b32 a60, v216
  v_accvgpr_write_b32 a61, v217
  v_accvgpr_write_b32 a62, v218
  v_accvgpr_write_b32 a63, v219
  v_pk_mul_f32 v[224:225], v[224:225], s[40:41]
  v_pk_mul_f32 v[226:227], v[226:227], s[40:41]
  v_pk_mul_f32 v[228:229], v[228:229], s[40:41]
  v_pk_mul_f32 v[230:231], v[230:231], s[40:41]
  v_cvt_pk_bf16_f32 v224, v224, v225
  v_cvt_pk_bf16_f32 v225, v226, v227
  v_cvt_pk_bf16_f32 v226, v228, v229
  v_cvt_pk_bf16_f32 v227, v230, v231
  v_accvgpr_write_b32 a64, v224
  v_accvgpr_write_b32 a65, v225
  v_accvgpr_write_b32 a66, v226
  v_accvgpr_write_b32 a67, v227
  v_pk_mul_f32 v[232:233], v[232:233], s[40:41]
  v_pk_mul_f32 v[234:235], v[234:235], s[40:41]
  v_pk_mul_f32 v[236:237], v[236:237], s[40:41]
  v_pk_mul_f32 v[238:239], v[238:239], s[40:41]
  v_cvt_pk_bf16_f32 v232, v232, v233
  v_cvt_pk_bf16_f32 v233, v234, v235
  v_cvt_pk_bf16_f32 v234, v236, v237
  v_cvt_pk_bf16_f32 v235, v238, v239
  v_accvgpr_write_b32 a68, v232
  v_accvgpr_write_b32 a69, v233
  v_accvgpr_write_b32 a70, v234
  v_accvgpr_write_b32 a71, v235
  v_pk_mul_f32 v[240:241], v[240:241], s[40:41]
  v_pk_mul_f32 v[242:243], v[242:243], s[40:41]
  v_pk_mul_f32 v[244:245], v[244:245], s[40:41]
  v_pk_mul_f32 v[246:247], v[246:247], s[40:41]
  v_cvt_pk_bf16_f32 v240, v240, v241
  v_cvt_pk_bf16_f32 v241, v242, v243
  v_cvt_pk_bf16_f32 v242, v244, v245
  v_cvt_pk_bf16_f32 v243, v246, v247
  v_accvgpr_write_b32 a72, v240
  v_accvgpr_write_b32 a73, v241
  v_accvgpr_write_b32 a74, v242
  v_accvgpr_write_b32 a75, v243
  v_pk_mul_f32 v[248:249], v[248:249], s[40:41]
  v_pk_mul_f32 v[250:251], v[250:251], s[40:41]
  v_pk_mul_f32 v[252:253], v[252:253], s[40:41]
  v_pk_mul_f32 v[254:255], v[254:255], s[40:41]
  v_cvt_pk_bf16_f32 v248, v248, v249
  v_cvt_pk_bf16_f32 v249, v250, v251
  v_cvt_pk_bf16_f32 v250, v252, v253
  v_cvt_pk_bf16_f32 v251, v254, v255
  v_accvgpr_write_b32 a76, v248
  v_accvgpr_write_b32 a77, v249
  v_accvgpr_write_b32 a78, v250
  v_accvgpr_write_b32 a79, v251
L_apre:
  s_mov_b32 s39, 0
  s_mov_b32 s37, 8192
  s_mov_b64 vcc, 0
  s_xor_b32 s48, s30, 0
  s_lshl_b32 s48, s48, 10
  s_add_u32 s48, s48, 65792
  v_lshl_add_u32 v26, v0, 4, s48
  v_add_u32 v27, 0x10000, v26
  v_mfma_f32_16x16x32_bf16 v[56:59], a[160:163], a[0:3], 0
  s_waitcnt vmcnt(13)
  s_barrier
  v_mfma_f32_16x16x32_bf16 v[56:59], a[164:167], a[20:23], v[56:59]
  s_add_u32 m0, s31, 65792
  ds_read_b64_tr_b16 a[192:193], v5 offset:0
  v_mfma_f32_16x16x32_bf16 v[56:59], a[168:171], a[40:43], v[56:59]
  buffer_load_dwordx4 v13, s[8:11], s34 offen nt lds
  v_mfma_f32_16x16x32_bf16 v[56:59], a[172:175], a[60:63], v[56:59]
  ds_read_b64_tr_b16 a[194:195], v5 offset:4096
  v_mfma_f32_16x16x32_bf16 v[60:63], a[176:179], a[0:3], 0
  ds_read_b64_tr_b16 a[196:197], v6 offset:0
  v_mfma_f32_16x16x32_bf16 v[60:63], a[180:183], a[20:23], v[60:63]
  ds_read_b64_tr_b16 a[198:199], v6 offset:4096
  v_mfma_f32_16x16x32_bf16 v[60:63], a[184:187], a[40:43], v[60:63]
  ds_read_b64_tr_b16 a[200:201], v7 offset:0
  v_mfma_f32_16x16x32_bf16 v[60:63], a[188:191], a[60:63], v[60:63]
  ds_read_b64_tr_b16 a[202:203], v7 offset:4096
  v_max3_f32 v24, v56, v57, v58
  v_mfma_f32_16x16x32_bf16 v[64:67], a[160:163], a[4:7], 0
  buffer_load_dwordx4 v14, s[8:11], s34 offen offset:1024 nt lds
  v_mfma_f32_16x16x32_bf16 v[64:67], a[164:167], a[24:27], v[64:67]
  ds_read_b64_tr_b16 a[204:205], v8 offset:0
  v_mfma_f32_16x16x32_bf16 v[64:67], a[168:171], a[44:47], v[64:67]
  ds_read_b64_tr_b16 a[206:207], v8 offset:4096
  v_max3_f32 v24, v24, v59, v60
  v_mfma_f32_16x16x32_bf16 v[64:67], a[172:175], a[64:67], v[64:67]
  v_max3_f32 v24, v24, v61, v62
  v_max_f32 v24, v24, v63
  v_mfma_f32_16x16x32_bf16 v[68:71], a[176:179], a[4:7], 0
  ds_read_b64_tr_b16 a[208:209], v9 offset:0
  v_mov_b32 v25, v24
  v_mfma_f32_16x16x32_bf16 v[68:71], a[180:183], a[24:27], v[68:71]
  v_mfma_f32_16x16x32_bf16 v[68:71], a[184:187], a[44:47], v[68:71]
  buffer_load_dwordx4 v15, s[8:11], s34 offen offset:2048 nt lds
  v_mfma_f32_16x16x32_bf16 v[68:71], a[188:191], a[64:67], v[68:71]
  ds_read_b64_tr_b16 a[210:211], v9 offset:4096
  v_permlane32_swap_b32 v25, v24
  v_mfma_f32_16x16x32_bf16 v[72:75], a[160:163], a[8:11], 0
  v_max_f32 v24, v24, v25
  v_mov_b32 v25, v24
  v_mfma_f32_16x16x32_bf16 v[72:75], a[164:167], a[28:31], v[72:75]
  v_mfma_f32_16x16x32_bf16 v[72:75], a[168:171], a[48:51], v[72:75]
  ds_read_b64_tr_b16 a[212:213], v10 offset:0
  v_permlane16_swap_b32 v25, v24
  v_mfma_f32_16x16x32_bf16 v[72:75], a[172:175], a[68:71], v[72:75]
  v_max_f32 v24, v24, v25
  v_sub_f32 v36, 0, v24
  v_mfma_f32_16x16x32_bf16 v[76:79], a[176:179], a[8:11], 0
  buffer_load_dwordx4 v16, s[8:11], s34 offen offset:3072 nt lds
  v_mfma_f32_16x16x32_bf16 v[76:79], a[180:183], a[28:31], v[76:79]
  ds_read_b64_tr_b16 a[214:215], v10 offset:4096
  v_sub_f32 v37, 0, v24
  v_mfma_f32_16x16x32_bf16 v[76:79], a[184:187], a[48:51], v[76:79]
  v_sub_f32 v38, 0, v24
  v_sub_f32 v39, 0, v24
  v_mfma_f32_16x16x32_bf16 v[76:79], a[188:191], a[68:71], v[76:79]
  ds_read_b64_tr_b16 a[216:217], v11 offset:0
  v_sub_f32 v56, v56, v24
  v_mfma_f32_16x16x32_bf16 v[80:83], a[160:163], a[12:15], 0
  v_sub_f32 v57, v57, v24
  v_sub_f32 v58, v58, v24
  v_mfma_f32_16x16x32_bf16 v[80:83], a[164:167], a[32:35], v[80:83]
  s_add_u32 m0, s31, 49152
  v_sub_f32 v59, v59, v24
  v_sub_f32 v60, v60, v24
  v_mfma_f32_16x16x32_bf16 v[80:83], a[168:171], a[52:55], v[80:83]
  buffer_load_dwordx4 v17, s[12:15], s35 offen nt lds
  v_mfma_f32_16x16x32_bf16 v[80:83], a[172:175], a[72:75], v[80:83]
  ds_read_b64_tr_b16 a[218:219], v11 offset:4096
  v_sub_f32 v61, v61, v24
  v_mfma_f32_16x16x32_bf16 v[84:87], a[176:179], a[12:15], 0
  v_sub_f32 v62, v62, v24
  v_sub_f32 v63, v63, v24
  v_mfma_f32_16x16x32_bf16 v[84:87], a[180:183], a[32:35], v[84:87]
  ds_read_b64_tr_b16 a[220:221], v12 offset:0
  v_mfma_f32_16x16x32_bf16 v[84:87], a[184:187], a[52:55], v[84:87]
  v_exp_f32 v56, v56
  v_mfma_f32_16x16x32_bf16 v[84:87], a[188:191], a[72:75], v[84:87]
  ds_read_b64_tr_b16 a[222:223], v12 offset:4096
  v_max3_f32 v24, v64, v65, v66
  v_mfma_f32_16x16x32_bf16 v[88:91], a[160:163], a[16:19], 0
  buffer_load_dwordx4 v18, s[12:15], s35 offen offset:1024 nt lds
  v_mfma_f32_16x16x32_bf16 v[88:91], a[164:167], a[36:39], v[88:91]
  v_exp_f32 v57, v57
  v_mfma_f32_16x16x32_bf16 v[88:91], a[168:171], a[56:59], v[88:91]
  v_exp_f32 v58, v58
  v_mfma_f32_16x16x32_bf16 v[88:91], a[172:175], a[76:79], v[88:91]
  v_exp_f32 v59, v59
  v_mfma_f32_16x16x32_bf16 v[92:95], a[176:179], a[16:19], 0
  v_exp_f32 v60, v60
  v_mfma_f32_16x16x32_bf16 v[92:95], a[180:183], a[36:39], v[92:95]
  v_exp_f32 v61, v61
  v_mfma_f32_16x16x32_bf16 v[92:95], a[184:187], a[56:59], v[92:95]
  buffer_load_dwordx4 v19, s[12:15], s35 offen offset:2048 nt lds
  v_mfma_f32_16x16x32_bf16 v[92:95], a[188:191], a[76:79], v[92:95]
  s_waitcnt lgkmcnt(0)
  v_exp_f32 v62, v62
  v_exp_f32 v63, v63
  v_cvt_pk_bf16_f32 v56, v56, v57
  v_cvt_pk_bf16_f32 v57, v58, v59
  v_cvt_pk_bf16_f32 v58, v60, v61
  v_cvt_pk_bf16_f32 v59, v62, v63
  s_nop 1
  v_mfma_f32_16x16x32_bf16 v[96:99], a[192:195], v[56:59], 0
  v_max3_f32 v24, v24, v67, v68
  v_max3_f32 v24, v24, v69, v70
  v_mfma_f32_16x16x32_bf16 v[100:103], a[196:199], v[56:59], 0
  v_max_f32 v24, v24, v71
  v_mov_b32 v25, v24
  v_mfma_f32_16x16x32_bf16 v[136:139], a[200:203], v[56:59], 0
  v_mfma_f32_16x16x32_bf16 v[140:143], a[204:207], v[56:59], 0
  v_permlane32_swap_b32 v25, v24
  v_max_f32 v24, v24, v25
  v_mfma_f32_16x16x32_bf16 v[176:179], a[208:211], v[56:59], 0
  buffer_load_dwordx4 v20, s[12:15], s35 offen offset:3072 nt lds
  v_mfma_f32_16x16x32_bf16 v[180:183], a[212:215], v[56:59], 0
  v_mov_b32 v25, v24
  v_mfma_f32_16x16x32_bf16 v[216:219], a[216:219], v[56:59], 0
  v_mfma_f32_16x16x32_bf16 v[220:223], a[220:223], v[56:59], 0
  v_permlane16_swap_b32 v25, v24
  v_max_f32 v24, v24, v25
  v_mfma_f32_16x16x32_bf16 a[224:227], a[244:247], v[56:59], 0
  v_sub_f32 v40, 0, v24
  v_sub_f32 v41, 0, v24
  v_sub_f32 v42, 0, v24
  v_sub_f32 v43, 0, v24
  v_sub_f32 v64, v64, v24
  v_sub_f32 v65, v65, v24
  v_sub_f32 v66, v66, v24
  v_sub_f32 v67, v67, v24
  v_sub_f32 v68, v68, v24
  v_sub_f32 v69, v69, v24
  v_sub_f32 v70, v70, v24
  v_sub_f32 v71, v71, v24
  v_exp_f32 v64, v64
  v_exp_f32 v65, v65
  v_exp_f32 v66, v66
  v_exp_f32 v67, v67
  v_exp_f32 v68, v68
  v_exp_f32 v69, v69
  v_exp_f32 v70, v70
  v_exp_f32 v71, v71
  v_cvt_pk_bf16_f32 v64, v64, v65
  v_cvt_pk_bf16_f32 v65, v66, v67
  v_cvt_pk_bf16_f32 v66, v68, v69
  v_cvt_pk_bf16_f32 v67, v70, v71
  s_nop 1
  v_mfma_f32_16x16x32_bf16 v[104:107], a[192:195], v[64:67], 0
  v_max3_f32 v24, v72, v73, v74
  v_max3_f32 v24, v24, v75, v76
  v_mfma_f32_16x16x32_bf16 v[108:111], a[196:199], v[64:67], 0
  v_max3_f32 v24, v24, v77, v78
  v_max_f32 v24, v24, v79
  v_mfma_f32_16x16x32_bf16 v[144:147], a[200:203], v[64:67], 0
  v_mov_b32 v25, v24
  v_mfma_f32_16x16x32_bf16 v[148:151], a[204:207], v[64:67], 0
  ds_read_b128 a[160:163], v1 offset:16384
  v_permlane32_swap_b32 v25, v24
  v_mfma_f32_16x16x32_bf16 v[184:187], a[208:211], v[64:67], 0
  v_max_f32 v24, v24, v25
  v_mov_b32 v25, v24
  v_mfma_f32_16x16x32_bf16 v[188:191], a[212:215], v[64:67], 0
  v_mfma_f32_16x16x32_bf16 v[224:227], a[216:219], v[64:67], 0
  ds_read_b128 a[164:167], v2 offset:16384
  v_permlane16_swap_b32 v25, v24
  v_mfma_f32_16x16x32_bf16 v[228:231], a[220:223], v[64:67], 0
  v_max_f32 v24, v24, v25
  v_sub_f32 v44, 0, v24
  v_mfma_f32_16x16x32_bf16 a[228:231], a[244:247], v[64:67], 0
  v_sub_f32 v45, 0, v24
  v_sub_f32 v46, 0, v24
  v_sub_f32 v47, 0, v24
  v_sub_f32 v72, v72, v24
  v_sub_f32 v73, v73, v24
  v_sub_f32 v74, v74, v24
  v_sub_f32 v75, v75, v24
  v_sub_f32 v76, v76, v24
  v_sub_f32 v77, v77, v24
  v_sub_f32 v78, v78, v24
  v_sub_f32 v79, v79, v24
  v_exp_f32 v72, v72
  v_exp_f32 v73, v73
  v_exp_f32 v74, v74
  v_exp_f32 v75, v75
  v_exp_f32 v76, v76
  v_exp_f32 v77, v77
  v_exp_f32 v78, v78
  v_exp_f32 v79, v79
  v_cvt_pk_bf16_f32 v72, v72, v73
  v_cvt_pk_bf16_f32 v73, v74, v75
  v_cvt_pk_bf16_f32 v74, v76, v77
  v_cvt_pk_bf16_f32 v75, v78, v79
  s_nop 1
  v_mfma_f32_16x16x32_bf16 v[112:115], a[192:195], v[72:75], 0
  v_max3_f32 v24, v80, v81, v82
  v_max3_f32 v24, v24, v83, v84
  v_mfma_f32_16x16x32_bf16 v[116:119], a[196:199], v[72:75], 0
  v_max3_f32 v24, v24, v85, v86
  v_max_f32 v24, v24, v87
  v_mfma_f32_16x16x32_bf16 v[152:155], a[200:203], v[72:75], 0
  v_mov_b32 v25, v24
  v_mfma_f32_16x16x32_bf16 v[156:159], a[204:207], v[72:75], 0
  ds_read_b128 a[168:171], v3 offset:16384
  v_permlane32_swap_b32 v25, v24
  v_mfma_f32_16x16x32_bf16 v[192:195], a[208:211], v[72:75], 0
  v_max_f32 v24, v24, v25
  v_mov_b32 v25, v24
  v_mfma_f32_16x16x32_bf16 v[196:199], a[212:215], v[72:75], 0
  v_mfma_f32_16x16x32_bf16 v[232:235], a[216:219], v[72:75], 0
  ds_read_b128 a[172:175], v4 offset:16384
  v_permlane16_swap_b32 v25, v24
  v_mfma_f32_16x16x32_bf16 v[236:239], a[220:223], v[72:75], 0
  v_max_f32 v24, v24, v25
  v_sub_f32 v48, 0, v24
  v_mfma_f32_16x16x32_bf16 a[232:235], a[244:247], v[72:75], 0
  v_sub_f32 v49, 0, v24
  v_sub_f32 v50, 0, v24
  v_sub_f32 v51, 0, v24
  v_sub_f32 v80, v80, v24
  v_sub_f32 v81, v81, v24
  v_sub_f32 v82, v82, v24
  v_sub_f32 v83, v83, v24
  v_sub_f32 v84, v84, v24
  v_sub_f32 v85, v85, v24
  v_sub_f32 v86, v86, v24
  v_sub_f32 v87, v87, v24
  v_exp_f32 v80, v80
  v_exp_f32 v81, v81
  v_exp_f32 v82, v82
  v_exp_f32 v83, v83
  v_exp_f32 v84, v84
  v_exp_f32 v85, v85
  v_exp_f32 v86, v86
  v_exp_f32 v87, v87
  v_cvt_pk_bf16_f32 v80, v80, v81
  v_cvt_pk_bf16_f32 v81, v82, v83
  v_cvt_pk_bf16_f32 v82, v84, v85
  v_cvt_pk_bf16_f32 v83, v86, v87
  s_nop 1
  v_mfma_f32_16x16x32_bf16 v[120:123], a[192:195], v[80:83], 0
  v_max3_f32 v24, v88, v89, v90
  v_max3_f32 v24, v24, v91, v92
  v_mfma_f32_16x16x32_bf16 v[124:127], a[196:199], v[80:83], 0
  v_max3_f32 v24, v24, v93, v94
  v_max_f32 v24, v24, v95
  v_mfma_f32_16x16x32_bf16 v[160:163], a[200:203], v[80:83], 0
  v_mov_b32 v25, v24
  v_mfma_f32_16x16x32_bf16 v[164:167], a[204:207], v[80:83], 0
  ds_read_b128 a[176:179], v1 offset:20480
  v_permlane32_swap_b32 v25, v24
  v_mfma_f32_16x16x32_bf16 v[200:203], a[208:211], v[80:83], 0
  v_max_f32 v24, v24, v25
  v_mov_b32 v25, v24
  v_mfma_f32_16x16x32_bf16 v[204:207], a[212:215], v[80:83], 0
  v_mfma_f32_16x16x32_bf16 v[240:243], a[216:219], v[80:83], 0
  v_permlane16_swap_b32 v25, v24
  v_max_f32 v24, v24, v25
  v_mfma_f32_16x16x32_bf16 v[244:247], a[220:223], v[80:83], 0
  v_sub_f32 v52, 0, v24
  v_sub_f32 v53, 0, v24
  v_mfma_f32_16x16x32_bf16 a[236:239], a[244:247], v[80:83], 0
  ds_read_b128 a[180:183], v2 offset:20480
  v_sub_f32 v54, 0, v24
  v_sub_f32 v55, 0, v24
  v_sub_f32 v88, v88, v24
  v_sub_f32 v89, v89, v24
  v_sub_f32 v90, v90, v24
  v_sub_f32 v91, v91, v24
  v_sub_f32 v92, v92, v24
  v_sub_f32 v93, v93, v24
  v_sub_f32 v94, v94, v24
  v_sub_f32 v95, v95, v24
  v_exp_f32 v88, v88
  v_exp_f32 v89, v89
  v_exp_f32 v90, v90
  v_exp_f32 v91, v91
  v_exp_f32 v92, v92
  v_exp_f32 v93, v93
  v_exp_f32 v94, v94
  v_exp_f32 v95, v95
  v_cvt_pk_bf16_f32 v88, v88, v89
  v_cvt_pk_bf16_f32 v89, v90, v91
  v_cvt_pk_bf16_f32 v90, v92, v93
  v_cvt_pk_bf16_f32 v91, v94, v95
  s_nop 1
  v_mfma_f32_16x16x32_bf16 v[128:131], a[192:195], v[88:91], 0
  ds_read_b128 a[184:187], v3 offset:20480
  v_mfma_f32_16x16x32_bf16 v[132:135], a[196:199], v[88:91], 0
  ds_read_b128 a[188:191], v4 offset:20480
  v_mfma_f32_16x16x32_bf16 v[168:171], a[200:203], v[88:91], 0
  v_mfma_f32_16x16x32_bf16 v[172:175], a[204:207], v[88:91], 0
  s_add_u32 s34, s34, 8192
  s_bitset0_b32 s34, 17
  v_mfma_f32_16x16x32_bf16 v[208:211], a[208:211], v[88:91], 0
  s_add_u32 s35, s35, s36
  s_andn2_b32 s35, s35, s70
  v_mfma_f32_16x16x32_bf16 v[212:215], a[212:215], v[88:91], 0
  v_mfma_f32_16x16x32_bf16 v[248:251], a[216:219], v[88:91], 0
  v_mfma_f32_16x16x32_bf16 v[252:255], a[220:223], v[88:91], 0
  s_waitcnt lgkmcnt(0)
  v_mfma_f32_16x16x32_bf16 a[240:243], a[244:247], v[88:91], 0
L_aloop:
  v_mfma_f32_16x16x32_bf16 v[56:59], a[160:163], a[0:3], v[36:39]
  s_waitcnt vmcnt(2)
  s_barrier
  v_mfma_f32_16x16x32_bf16 v[56:59], a[164:167], a[20:23], v[56:59]
  s_add_u32 m0, s31, 82176
  ds_read_b64_tr_b16 a[192:193], v5 offset:16384
  v_mfma_f32_16x16x32_bf16 v[56:59], a[168:171], a[40:43], v[56:59]
  buffer_load_dwordx4 v13, s[8:11], s34 offen nt lds
  v_mfma_f32_16x16x32_bf16 v[56:59], a[172:175], a[60:63], v[56:59]
  ds_read_b64_tr_b16 a[194:195], v5 offset:20480
  v_mfma_f32_16x16x32_bf16 v[60:63], a[176:179], a[0:3], v[36:39]
  ds_read_b64_tr_b16 a[196:197], v6 offset:16384
  v_mfma_f32_16x16x32_bf16 v[60:63], a[180:183], a[20:23], v[60:63]
  ds_read_b64_tr_b16 a[198:199], v6 offset:20480
  v_mfma_f32_16x16x32_bf16 v[60:63], a[184:187], a[40:43], v[60:63]
  ds_read_b64_tr_b16 a[200:201], v7 offset:16384
  v_mfma_f32_16x16x32_bf16 v[60:63], a[188:191], a[60:63], v[60:63]
  ds_read_b64_tr_b16 a[202:203], v7 offset:20480
  v_mfma_f32_16x16x32_bf16 v[64:67], a[160:163], a[4:7], v[40:43]
  buffer_load_dwordx4 v14, s[8:11], s34 offen offset:1024 nt lds
  v_mfma_f32_16x16x32_bf16 v[64:67], a[164:167], a[24:27], v[64:67]
  ds_read_b64_tr_b16 a[204:205], v8 offset:16384
  v_mfma_f32_16x16x32_bf16 v[64:67], a[168:171], a[44:47], v[64:67]
  ds_read_b64_tr_b16 a[206:207], v8 offset:20480
  v_mfma_f32_16x16x32_bf16 v[64:67], a[172:175], a[64:67], v[64:67]
  v_exp_f32 v56, v56
  v_mfma_f32_16x16x32_bf16 v[68:71], a[176:179], a[4:7], v[40:43]
  ds_read_b64_tr_b16 a[208:209], v9 offset:16384
  v_mfma_f32_16x16x32_bf16 v[68:71], a[180:183], a[24:27], v[68:71]
  v_exp_f32 v57, v57
  v_mfma_f32_16x16x32_bf16 v[68:71], a[184:187], a[44:47], v[68:71]
  buffer_load_dwordx4 v15, s[8:11], s34 offen offset:2048 nt lds
  v_mfma_f32_16x16x32_bf16 v[68:71], a[188:191], a[64:67], v[68:71]
  ds_read_b64_tr_b16 a[210:211], v9 offset:20480
  v_cvt_pk_bf16_f32 v56, v56, v57
  v_mfma_f32_16x16x32_bf16 v[72:75], a[160:163], a[8:11], v[44:47]
  v_exp_f32 v58, v58
  v_mfma_f32_16x16x32_bf16 v[72:75], a[164:167], a[28:31], v[72:75]
  v_exp_f32 v59, v59
  v_mfma_f32_16x16x32_bf16 v[72:75], a[168:171], a[48:51], v[72:75]
  ds_read_b64_tr_b16 a[212:213], v10 offset:16384
  v_cvt_pk_bf16_f32 v57, v58, v59
  v_mfma_f32_16x16x32_bf16 v[72:75], a[172:175], a[68:71], v[72:75]
  v_exp_f32 v60, v60
  v_mfma_f32_16x16x32_bf16 v[76:79], a[176:179], a[8:11], v[44:47]
  buffer_load_dwordx4 v16, s[8:11], s34 offen offset:3072 nt lds
  v_mfma_f32_16x16x32_bf16 v[76:79], a[180:183], a[28:31], v[76:79]
  ds_read_b64_tr_b16 a[214:215], v10 offset:20480
  v_mfma_f32_16x16x32_bf16 v[76:79], a[184:187], a[48:51], v[76:79]
  v_exp_f32 v61, v61
  v_mfma_f32_16x16x32_bf16 v[76:79], a[188:191], a[68:71], v[76:79]
  ds_read_b64_tr_b16 a[216:217], v11 offset:16384
  v_cvt_pk_bf16_f32 v58, v60, v61
  v_mfma_f32_16x16x32_bf16 v[80:83], a[160:163], a[12:15], v[48:51]
  v_exp_f32 v62, v62
  v_mfma_f32_16x16x32_bf16 v[80:83], a[164:167], a[32:35], v[80:83]
  s_add_u32 m0, s31, 0
  v_exp_f32 v63, v63
  v_mfma_f32_16x16x32_bf16 v[80:83], a[168:171], a[52:55], v[80:83]
  buffer_load_dwordx4 v17, s[12:15], s35 offen nt lds
  v_mfma_f32_16x16x32_bf16 v[80:83], a[172:175], a[72:75], v[80:83]
  ds_read_b64_tr_b16 a[218:219], v11 offset:20480
  v_cvt_pk_bf16_f32 v59, v62, v63
  v_mfma_f32_16x16x32_bf16 v[84:87], a[176:179], a[12:15], v[48:51]
  v_exp_f32 v64, v64
  v_mfma_f32_16x16x32_bf16 v[84:87], a[180:183], a[32:35], v[84:87]
  ds_read_b64_tr_b16 a[220:221], v12 offset:16384
  v_mfma_f32_16x16x32_bf16 v[84:87], a[184:187], a[52:55], v[84:87]
  v_exp_f32 v65, v65
  v_mfma_f32_16x16x32_bf16 v[84:87], a[188:191], a[72:75], v[84:87]
  ds_read_b64_tr_b16 a[222:223], v12 offset:20480
  v_cvt_pk_bf16_f32 v64, v64, v65
  v_mfma_f32_16x16x32_bf16 v[88:91], a[160:163], a[16:19], v[52:55]
  buffer_load_dwordx4 v18, s[12:15], s35 offen offset:1024 nt lds
  v_mfma_f32_16x16x32_bf16 v[88:91], a[164:167], a[36:39], v[88:91]
  v_exp_f32 v66, v66
  v_mfma_f32_16x16x32_bf16 v[88:91], a[168:171], a[56:59], v[88:91]
  v_exp_f32 v67, v67
  v_mfma_f32_16x16x32_bf16 v[88:91], a[172:175], a[76:79], v[88:91]
  v_exp_f32 v68, v68
  v_mfma_f32_16x16x32_bf16 v[92:95], a[176:179], a[16:19], v[52:55]
  v_exp_f32 v69, v69
  v_mfma_f32_16x16x32_bf16 v[92:95], a[180:183], a[36:39], v[92:95]
  v_exp_f32 v70, v70
  v_mfma_f32_16x16x32_bf16 v[92:95], a[184:187], a[56:59], v[92:95]
  buffer_load_dwordx4 v19, s[12:15], s35 offen offset:2048 nt lds
  v_mfma_f32_16x16x32_bf16 v[92:95], a[188:191], a[76:79], v[92:95]
  s_waitcnt lgkmcnt(0)
  v_exp_f32 v71, v71
  v_mfma_f32_16x16x32_bf16 v[96:99], a[192:195], v[56:59], v[96:99]
  v_cvt_pk_bf16_f32 v65, v66, v67
  v_cvt_pk_bf16_f32 v66, v68, v69
  v_mfma_f32_16x16x32_bf16 v[100:103], a[196:199], v[56:59], v[100:103]
  v_cvt_pk_bf16_f32 v67, v70, v71
  v_mfma_f32_16x16x32_bf16 v[136:139], a[200:203], v[56:59], v[136:139]
  v_exp_f32 v72, v72
  v_mfma_f32_16x16x32_bf16 v[140:143], a[204:207], v[56:59], v[140:143]
  v_exp_f32 v73, v73
  v_mfma_f32_16x16x32_bf16 v[176:179], a[208:211], v[56:59], v[176:179]
  buffer_load_dwordx4 v20, s[12:15], s35 offen offset:3072 nt lds
  v_mfma_f32_16x16x32_bf16 v[180:183], a[212:215], v[56:59], v[180:183]
  v_exp_f32 v74, v74
  v_mfma_f32_16x16x32_bf16 v[216:219], a[216:219], v[56:59], v[216:219]
  v_exp_f32 v75, v75
  v_mfma_f32_16x16x32_bf16 v[220:223], a[220:223], v[56:59], v[220:223]
  v_exp_f32 v76, v76
  v_mfma_f32_16x16x32_bf16 a[224:227], a[244:247], v[56:59], a[224:227]
  v_exp_f32 v77, v77
  v_mfma_f32_16x16x32_bf16 v[104:107], a[192:195], v[64:67], v[104:107]
  v_exp_f32 v78, v78
  v_mfma_f32_16x16x32_bf16 v[108:111], a[196:199], v[64:67], v[108:111]
  v_exp_f32 v79, v79
  v_mfma_f32_16x16x32_bf16 v[144:147], a[200:203], v[64:67], v[144:147]
  v_cvt_pk_bf16_f32 v72, v72, v73
  v_cvt_pk_bf16_f32 v73, v74, v75
  v_mfma_f32_16x16x32_bf16 v[148:151], a[204:207], v[64:67], v[148:151]
  ds_read_b128 a[160:163], v1 offset:32768
  v_cvt_pk_bf16_f32 v74, v76, v77
  v_mfma_f32_16x16x32_bf16 v[184:187], a[208:211], v[64:67], v[184:187]
  v_cvt_pk_bf16_f32 v75, v78, v79
  v_mfma_f32_16x16x32_bf16 v[188:191], a[212:215], v[64:67], v[188:191]
  v_exp_f32 v80, v80
  v_mfma_f32_16x16x32_bf16 v[224:227], a[216:219], v[64:67], v[224:227]
  ds_read_b128 a[164:167], v2 offset:32768
  v_mfma_f32_16x16x32_bf16 v[228:231], a[220:223], v[64:67], v[228:231]
  v_exp_f32 v81, v81
  v_mfma_f32_16x16x32_bf16 a[228:231], a[244:247], v[64:67], a[228:231]
  v_exp_f32 v82, v82
  v_mfma_f32_16x16x32_bf16 v[112:115], a[192:195], v[72:75], v[112:115]
  v_exp_f32 v83, v83
  v_mfma_f32_16x16x32_bf16 v[116:119], a[196:199], v[72:75], v[116:119]
  v_exp_f32 v84, v84
  v_mfma_f32_16x16x32_bf16 v[152:155], a[200:203], v[72:75], v[152:155]
  v_exp_f32 v85, v85
  v_mfma_f32_16x16x32_bf16 v[156:159], a[204:207], v[72:75], v[156:159]
  ds_read_b128 a[168:171], v3 offset:32768
  v_cvt_pk_bf16_f32 v80, v80, v81
  v_mfma_f32_16x16x32_bf16 v[192:195], a[208:211], v[72:75], v[192:195]
  v_exp_f32 v86, v86
  v_mfma_f32_16x16x32_bf16 v[196:199], a[212:215], v[72:75], v[196:199]
  v_exp_f32 v87, v87
  v_mfma_f32_16x16x32_bf16 v[232:235], a[216:219], v[72:75], v[232:235]
  ds_read_b128 a[172:175], v4 offset:32768
  v_cvt_pk_bf16_f32 v81, v82, v83
  v_mfma_f32_16x16x32_bf16 v[236:239], a[220:223], v[72:75], v[236:239]
  v_cvt_pk_bf16_f32 v82, v84, v85
  v_cvt_pk_bf16_f32 v83, v86, v87
  v_mfma_f32_16x16x32_bf16 a[232:235], a[244:247], v[72:75], a[232:235]
  v_exp_f32 v88, v88
  v_mfma_f32_16x16x32_bf16 v[120:123], a[192:195], v[80:83], v[120:123]
  v_exp_f32 v89, v89
  v_mfma_f32_16x16x32_bf16 v[124:127], a[196:199], v[80:83], v[124:127]
  v_exp_f32 v90, v90
  v_mfma_f32_16x16x32_bf16 v[160:163], a[200:203], v[80:83], v[160:163]
  v_exp_f32 v91, v91
  v_mfma_f32_16x16x32_bf16 v[164:167], a[204:207], v[80:83], v[164:167]
  ds_read_b128 a[176:179], v1 offset:36864
  v_cvt_pk_bf16_f32 v88, v88, v89
  v_mfma_f32_16x16x32_bf16 v[200:203], a[208:211], v[80:83], v[200:203]
  v_exp_f32 v92, v92
  v_mfma_f32_16x16x32_bf16 v[204:207], a[212:215], v[80:83], v[204:207]
  v_exp_f32 v93, v93
  v_mfma_f32_16x16x32_bf16 v[240:243], a[216:219], v[80:83], v[240:243]
  v_exp_f32 v94, v94
  v_mfma_f32_16x16x32_bf16 v[244:247], a[220:223], v[80:83], v[244:247]
  v_exp_f32 v95, v95
  v_mfma_f32_16x16x32_bf16 a[236:239], a[244:247], v[80:83], a[236:239]
  ds_read_b128 a[180:183], v2 offset:36864
  v_cvt_pk_bf16_f32 v89, v90, v91
  v_cvt_pk_bf16_f32 v90, v92, v93
  v_cvt_pk_bf16_f32 v91, v94, v95
  s_nop 1
  v_mfma_f32_16x16x32_bf16 v[128:131], a[192:195], v[88:91], v[128:131]
  ds_read_b128 a[184:187], v3 offset:36864
  v_mfma_f32_16x16x32_bf16 v[132:135], a[196:199], v[88:91], v[132:135]
  ds_read_b128 a[188:191], v4 offset:36864
  v_mfma_f32_16x16x32_bf16 v[168:171], a[200:203], v[88:91], v[168:171]
  v_mfma_f32_16x16x32_bf16 v[172:175], a[204:207], v[88:91], v[172:175]
  s_add_u32 s34, s34, 8192
  s_bitset0_b32 s34, 17
  v_mfma_f32_16x16x32_bf16 v[208:211], a[208:211], v[88:91], v[208:211]
  s_add_u32 s35, s35, s36
  s_andn2_b32 s35, s35, s70
  v_mfma_f32_16x16x32_bf16 v[212:215], a[212:215], v[88:91], v[212:215]
  v_mfma_f32_16x16x32_bf16 v[248:251], a[216:219], v[88:91], v[248:251]
  v_mfma_f32_16x16x32_bf16 v[252:255], a[220:223], v[88:91], v[252:255]
  s_waitcnt lgkmcnt(0)
  v_mfma_f32_16x16x32_bf16 a[240:243], a[244:247], v[88:91], a[240:243]
  v_mfma_f32_16x16x32_bf16 v[56:59], a[160:163], a[0:3], v[36:39]
  s_waitcnt vmcnt(2)
  s_barrier
  v_mfma_f32_16x16x32_bf16 v[56:59], a[164:167], a[20:23], v[56:59]
  s_add_u32 m0, s31, 98560
  ds_read_b64_tr_b16 a[192:193], v5 offset:32768
  v_mfma_f32_16x16x32_bf16 v[56:59], a[168:171], a[40:43], v[56:59]
  buffer_load_dwordx4 v13, s[8:11], s34 offen nt lds
  v_mfma_f32_16x16x32_bf16 v[56:59], a[172:175], a[60:63], v[56:59]
  ds_read_b64_tr_b16 a[194:195], v5 offset:36864
  v_mfma_f32_16x16x32_bf16 v[60:63], a[176:179], a[0:3], v[36:39]
  ds_read_b64_tr_b16 a[196:197], v6 offset:32768
  v_mfma_f32_16x16x32_bf16 v[60:63], a[180:183], a[20:23], v[60:63]
  ds_read_b64_tr_b16 a[198:199], v6 offset:36864
  v_mfma_f32_16x16x32_bf16 v[60:63], a[184:187], a[40:43], v[60:63]
  ds_read_b64_tr_b16 a[200:201], v7 offset:32768
  v_mfma_f32_16x16x32_bf16 v[60:63], a[188:191], a[60:63], v[60:63]
  ds_read_b64_tr_b16 a[202:203], v7 offset:36864
  v_mfma_f32_16x16x32_bf16 v[64:67], a[160:163], a[4:7], v[40:43]
  buffer_load_dwordx4 v14, s[8:11], s34 offen offset:1024 nt lds
  v_mfma_f32_16x16x32_bf16 v[64:67], a[164:167], a[24:27], v[64:67]
  ds_read_b64_tr_b16 a[204:205], v8 offset:32768
  v_mfma_f32_16x16x32_bf16 v[64:67], a[168:171], a[44:47], v[64:67]
  ds_read_b64_tr_b16 a[206:207], v8 offset:36864
  v_mfma_f32_16x16x32_bf16 v[64:67], a[172:175], a[64:67], v[64:67]
  v_exp_f32 v56, v56
  v_mfma_f32_16x16x32_bf16 v[68:71], a[176:179], a[4:7], v[40:43]
  ds_read_b64_tr_b16 a[208:209], v9 offset:32768
  v_mfma_f32_16x16x32_bf16 v[68:71], a[180:183], a[24:27], v[68:71]
  v_exp_f32 v57, v57
  v_mfma_f32_16x16x32_bf16 v[68:71], a[184:187], a[44:47], v[68:71]
  buffer_load_dwordx4 v15, s[8:11], s34 offen offset:2048 nt lds
  v_mfma_f32_16x16x32_bf16 v[68:71], a[188:191], a[64:67], v[68:71]
  ds_read_b64_tr_b16 a[210:211], v9 offset:36864
  v_cvt_pk_bf16_f32 v56, v56, v57
  v_mfma_f32_16x16x32_bf16 v[72:75], a[160:163], a[8:11], v[44:47]
  v_exp_f32 v58, v58
  v_mfma_f32_16x16x32_bf16 v[72:75], a[164:167], a[28:31], v[72:75]
  v_exp_f32 v59, v59
  v_mfma_f32_16x16x32_bf16 v[72:75], a[168:171], a[48:51], v[72:75]
  ds_read_b64_tr_b16 a[212:213], v10 offset:32768
  v_cvt_pk_bf16_f32 v57, v58, v59
  v_mfma_f32_16x16x32_bf16 v[72:75], a[172:175], a[68:71], v[72:75]
  v_exp_f32 v60, v60
  v_mfma_f32_16x16x32_bf16 v[76:79], a[176:179], a[8:11], v[44:47]
  buffer_load_dwordx4 v16, s[8:11], s34 offen offset:3072 nt lds
  v_mfma_f32_16x16x32_bf16 v[76:79], a[180:183], a[28:31], v[76:79]
  ds_read_b64_tr_b16 a[214:215], v10 offset:36864
  v_mfma_f32_16x16x32_bf16 v[76:79], a[184:187], a[48:51], v[76:79]
  v_exp_f32 v61, v61
  v_mfma_f32_16x16x32_bf16 v[76:79], a[188:191], a[68:71], v[76:79]
  ds_read_b64_tr_b16 a[216:217], v11 offset:32768
  v_cvt_pk_bf16_f32 v58, v60, v61
  v_mfma_f32_16x16x32_bf16 v[80:83], a[160:163], a[12:15], v[48:51]
  v_exp_f32 v62, v62
  v_mfma_f32_16x16x32_bf16 v[80:83], a[164:167], a[32:35], v[80:83]
  s_add_u32 m0, s31, 16384
  v_exp_f32 v63, v63
  v_mfma_f32_16x16x32_bf16 v[80:83], a[168:171], a[52:55], v[80:83]
  buffer_load_dwordx4 v17, s[12:15], s35 offen nt lds
  v_mfma_f32_16x16x32_bf16 v[80:83], a[172:175], a[72:75], v[80:83]
  ds_read_b64_tr_b16 a[218:219], v11 offset:36864
  v_cvt_pk_bf16_f32 v59, v62, v63
  v_mfma_f32_16x16x32_bf16 v[84:87], a[176:179], a[12:15], v[48:51]
  v_exp_f32 v64, v64
  v_mfma_f32_16x16x32_bf16 v[84:87], a[180:183], a[32:35], v[84:87]
  ds_read_b64_tr_b16 a[220:221], v12 offset:32768
  v_mfma_f32_16x16x32_bf16 v[84:87], a[184:187], a[52:55], v[84:87]
  v_exp_f32 v65, v65
  v_mfma_f32_16x16x32_bf16 v[84:87], a[188:191], a[72:75], v[84:87]
  ds_read_b64_tr_b16 a[222:223], v12 offset:36864
  v_cvt_pk_bf16_f32 v64, v64, v65
  v_mfma_f32_16x16x32_bf16 v[88:91], a[160:163], a[16:19], v[52:55]
  buffer_load_dwordx4 v18, s[12:15], s35 offen offset:1024 nt lds
  v_mfma_f32_16x16x32_bf16 v[88:91], a[164:167], a[36:39], v[88:91]
  v_exp_f32 v66, v66
  v_mfma_f32_16x16x32_bf16 v[88:91], a[168:171], a[56:59], v[88:91]
  v_exp_f32 v67, v67
  v_mfma_f32_16x16x32_bf16 v[88:91], a[172:175], a[76:79], v[88:91]
  v_exp_f32 v68, v68
  v_mfma_f32_16x16x32_bf16 v[92:95], a[176:179], a[16:19], v[52:55]
  v_exp_f32 v69, v69
  v_mfma_f32_16x16x32_bf16 v[92:95], a[180:183], a[36:39], v[92:95]
  v_exp_f32 v70, v70
  v_mfma_f32_16x16x32_bf16 v[92:95], a[184:187], a[56:59], v[92:95]
  buffer_load_dwordx4 v19, s[12:15], s35 offen offset:2048 nt lds
  v_mfma_f32_16x16x32_bf16 v[92:95], a[188:191], a[76:79], v[92:95]
  s_waitcnt lgkmcnt(0)
  v_exp_f32 v71, v71
  v_mfma_f32_16x16x32_bf16 v[96:99], a[192:195], v[56:59], v[96:99]
  v_cvt_pk_bf16_f32 v65, v66, v67
  v_cvt_pk_bf16_f32 v66, v68, v69
  v_mfma_f32_16x16x32_bf16 v[100:103], a[196:199], v[56:59], v[100:103]
  v_cvt_pk_bf16_f32 v67, v70, v71
  v_mfma_f32_16x16x32_bf16 v[136:139], a[200:203], v[56:59], v[136:139]
  v_exp_f32 v72, v72
  v_mfma_f32_16x16x32_bf16 v[140:143], a[204:207], v[56:59], v[140:143]
  v_exp_f32 v73, v73
  v_mfma_f32_16x16x32_bf16 v[176:179], a[208:211], v[56:59], v[176:179]
  buffer_load_dwordx4 v20, s[12:15], s35 offen offset:3072 nt lds
  v_mfma_f32_16x16x32_bf16 v[180:183], a[212:215], v[56:59], v[180:183]
  v_exp_f32 v74, v74
  v_mfma_f32_16x16x32_bf16 v[216:219], a[216:219], v[56:59], v[216:219]
  v_exp_f32 v75, v75
  v_mfma_f32_16x16x32_bf16 v[220:223], a[220:223], v[56:59], v[220:223]
  v_exp_f32 v76, v76
  v_mfma_f32_16x16x32_bf16 a[224:227], a[244:247], v[56:59], a[224:227]
  v_exp_f32 v77, v77
  v_mfma_f32_16x16x32_bf16 v[104:107], a[192:195], v[64:67], v[104:107]
  v_exp_f32 v78, v78
  v_mfma_f32_16x16x32_bf16 v[108:111], a[196:199], v[64:67], v[108:111]
  v_exp_f32 v79, v79
  v_mfma_f32_16x16x32_bf16 v[144:147], a[200:203], v[64:67], v[144:147]
  v_cvt_pk_bf16_f32 v72, v72, v73
  v_cvt_pk_bf16_f32 v73, v74, v75
  v_mfma_f32_16x16x32_bf16 v[148:151], a[204:207], v[64:67], v[148:151]
  ds_read_b128 a[160:163], v1 offset:49152
  v_cvt_pk_bf16_f32 v74, v76, v77
  v_mfma_f32_16x16x32_bf16 v[184:187], a[208:211], v[64:67], v[184:187]
  v_cvt_pk_bf16_f32 v75, v78, v79
  v_mfma_f32_16x16x32_bf16 v[188:191], a[212:215], v[64:67], v[188:191]
  v_exp_f32 v80, v80
  v_mfma_f32_16x16x32_bf16 v[224:227], a[216:219], v[64:67], v[224:227]
  ds_read_b128 a[164:167], v2 offset:49152
  v_mfma_f32_16x16x32_bf16 v[228:231], a[220:223], v[64:67], v[228:231]
  v_exp_f32 v81, v81
  v_mfma_f32_16x16x32_bf16 a[228:231], a[244:247], v[64:67], a[228:231]
  v_exp_f32 v82, v82
  v_mfma_f32_16x16x32_bf16 v[112:115], a[192:195], v[72:75], v[112:115]
  v_exp_f32 v83, v83
  v_mfma_f32_16x16x32_bf16 v[116:119], a[196:199], v[72:75], v[116:119]
  v_exp_f32 v84, v84
  v_mfma_f32_16x16x32_bf16 v[152:155], a[200:203], v[72:75], v[152:155]
  v_exp_f32 v85, v85
  v_mfma_f32_16x16x32_bf16 v[156:159], a[204:207], v[72:75], v[156:159]
  ds_read_b128 a[168:171], v3 offset:49152
  v_cvt_pk_bf16_f32 v80, v80, v81
  v_mfma_f32_16x16x32_bf16 v[192:195], a[208:211], v[72:75], v[192:195]
  v_exp_f32 v86, v86
  v_mfma_f32_16x16x32_bf16 v[196:199], a[212:215], v[72:75], v[196:199]
  v_exp_f32 v87, v87
  v_mfma_f32_16x16x32_bf16 v[232:235], a[216:219], v[72:75], v[232:235]
  ds_read_b128 a[172:175], v4 offset:49152
  v_cvt_pk_bf16_f32 v81, v82, v83
  v_mfma_f32_16x16x32_bf16 v[236:239], a[220:223], v[72:75], v[236:239]
  v_cvt_pk_bf16_f32 v82, v84, v85
  v_cvt_pk_bf16_f32 v83, v86, v87
  v_mfma_f32_16x16x32_bf16 a[232:235], a[244:247], v[72:75], a[232:235]
  v_exp_f32 v88, v88
  v_mfma_f32_16x16x32_bf16 v[120:123], a[192:195], v[80:83], v[120:123]
  v_exp_f32 v89, v89
  v_mfma_f32_16x16x32_bf16 v[124:127], a[196:199], v[80:83], v[124:127]
  v_exp_f32 v90, v90
  v_mfma_f32_16x16x32_bf16 v[160:163], a[200:203], v[80:83], v[160:163]
  v_exp_f32 v91, v91
  v_mfma_f32_16x16x32_bf16 v[164:167], a[204:207], v[80:83], v[164:167]
  ds_read_b128 a[176:179], v1 offset:53248
  v_cvt_pk_bf16_f32 v88, v88, v89
  v_mfma_f32_16x16x32_bf16 v[200:203], a[208:211], v[80:83], v[200:203]
  v_exp_f32 v92, v92
  v_mfma_f32_16x16x32_bf16 v[204:207], a[212:215], v[80:83], v[204:207]
  v_exp_f32 v93, v93
  v_mfma_f32_16x16x32_bf16 v[240:243], a[216:219], v[80:83], v[240:243]
  v_exp_f32 v94, v94
  v_mfma_f32_16x16x32_bf16 v[244:247], a[220:223], v[80:83], v[244:247]
  v_exp_f32 v95, v95
  v_mfma_f32_16x16x32_bf16 a[236:239], a[244:247], v[80:83], a[236:239]
  ds_read_b128 a[180:183], v2 offset:53248
  v_cvt_pk_bf16_f32 v89, v90, v91
  v_cvt_pk_bf16_f32 v90, v92, v93
  v_cvt_pk_bf16_f32 v91, v94, v95
  s_nop 1
  v_mfma_f32_16x16x32_bf16 v[128:131], a[192:195], v[88:91], v[128:131]
  ds_read_b128 a[184:187], v3 offset:53248
  v_mfma_f32_16x16x32_bf16 v[132:135], a[196:199], v[88:91], v[132:135]
  ds_read_b128 a[188:191], v4 offset:53248
  v_mfma_f32_16x16x32_bf16 v[168:171], a[200:203], v[88:91], v[168:171]
  v_mfma_f32_16x16x32_bf16 v[172:175], a[204:207], v[88:91], v[172:175]
  s_add_u32 s34, s34, 8192
  s_bitset0_b32 s34, 17
  v_mfma_f32_16x16x32_bf16 v[208:211], a[208:211], v[88:91], v[208:211]
  s_add_u32 s35, s35, s36
  s_andn2_b32 s35, s35, s70
  v_mfma_f32_16x16x32_bf16 v[212:215], a[212:215], v[88:91], v[212:215]
  v_mfma_f32_16x16x32_bf16 v[248:251], a[216:219], v[88:91], v[248:251]
  v_mfma_f32_16x16x32_bf16 v[252:255], a[220:223], v[88:91], v[252:255]
  s_waitcnt lgkmcnt(0)
  v_mfma_f32_16x16x32_bf16 a[240:243], a[244:247], v[88:91], a[240:243]
  v_mfma_f32_16x16x32_bf16 v[56:59], a[160:163], a[0:3], v[36:39]
  s_waitcnt vmcnt(2)
  s_barrier
  v_mfma_f32_16x16x32_bf16 v[56:59], a[164:167], a[20:23], v[56:59]
  s_add_u32 m0, s31, 114944
  ds_read_b64_tr_b16 a[192:193], v5 offset:49152
  v_mfma_f32_16x16x32_bf16 v[56:59], a[168:171], a[40:43], v[56:59]
  buffer_load_dwordx4 v13, s[8:11], s34 offen nt lds
  v_mfma_f32_16x16x32_bf16 v[56:59], a[172:175], a[60:63], v[56:59]
  ds_read_b64_tr_b16 a[194:195], v5 offset:53248
  v_mfma_f32_16x16x32_bf16 v[60:63], a[176:179], a[0:3], v[36:39]
  ds_read_b64_tr_b16 a[196:197], v6 offset:49152
  v_mfma_f32_16x16x32_bf16 v[60:63], a[180:183], a[20:23], v[60:63]
  ds_read_b64_tr_b16 a[198:199], v6 offset:53248
  v_mfma_f32_16x16x32_bf16 v[60:63], a[184:187], a[40:43], v[60:63]
  ds_read_b64_tr_b16 a[200:201], v7 offset:49152
  v_mfma_f32_16x16x32_bf16 v[60:63], a[188:191], a[60:63], v[60:63]
  ds_read_b64_tr_b16 a[202:203], v7 offset:53248
  v_mfma_f32_16x16x32_bf16 v[64:67], a[160:163], a[4:7], v[40:43]
  buffer_load_dwordx4 v14, s[8:11], s34 offen offset:1024 nt lds
  v_mfma_f32_16x16x32_bf16 v[64:67], a[164:167], a[24:27], v[64:67]
  ds_read_b64_tr_b16 a[204:205], v8 offset:49152
  v_mfma_f32_16x16x32_bf16 v[64:67], a[168:171], a[44:47], v[64:67]
  ds_read_b64_tr_b16 a[206:207], v8 offset:53248
  v_mfma_f32_16x16x32_bf16 v[64:67], a[172:175], a[64:67], v[64:67]
  v_exp_f32 v56, v56
  v_mfma_f32_16x16x32_bf16 v[68:71], a[176:179], a[4:7], v[40:43]
  ds_read_b64_tr_b16 a[208:209], v9 offset:49152
  v_mfma_f32_16x16x32_bf16 v[68:71], a[180:183], a[24:27], v[68:71]
  v_exp_f32 v57, v57
  v_mfma_f32_16x16x32_bf16 v[68:71], a[184:187], a[44:47], v[68:71]
  buffer_load_dwordx4 v15, s[8:11], s34 offen offset:2048 nt lds
  v_mfma_f32_16x16x32_bf16 v[68:71], a[188:191], a[64:67], v[68:71]
  ds_read_b64_tr_b16 a[210:211], v9 offset:53248
  v_cvt_pk_bf16_f32 v56, v56, v57
  v_mfma_f32_16x16x32_bf16 v[72:75], a[160:163], a[8:11], v[44:47]
  v_exp_f32 v58, v58
  v_mfma_f32_16x16x32_bf16 v[72:75], a[164:167], a[28:31], v[72:75]
  v_exp_f32 v59, v59
  v_mfma_f32_16x16x32_bf16 v[72:75], a[168:171], a[48:51], v[72:75]
  ds_read_b64_tr_b16 a[212:213], v10 offset:49152
  v_cvt_pk_bf16_f32 v57, v58, v59
  v_mfma_f32_16x16x32_bf16 v[72:75], a[172:175], a[68:71], v[72:75]
  v_exp_f32 v60, v60
  v_mfma_f32_16x16x32_bf16 v[76:79], a[176:179], a[8:11], v[44:47]
  buffer_load_dwordx4 v16, s[8:11], s34 offen offset:3072 nt lds
  v_mfma_f32_16x16x32_bf16 v[76:79], a[180:183], a[28:31], v[76:79]
  ds_read_b64_tr_b16 a[214:215], v10 offset:53248
  v_mfma_f32_16x16x32_bf16 v[76:79], a[184:187], a[48:51], v[76:79]
  v_exp_f32 v61, v61
  v_mfma_f32_16x16x32_bf16 v[76:79], a[188:191], a[68:71], v[76:79]
  ds_read_b64_tr_b16 a[216:217], v11 offset:49152
  v_cvt_pk_bf16_f32 v58, v60, v61
  v_mfma_f32_16x16x32_bf16 v[80:83], a[160:163], a[12:15], v[48:51]
  v_exp_f32 v62, v62
  v_mfma_f32_16x16x32_bf16 v[80:83], a[164:167], a[32:35], v[80:83]
  s_add_u32 m0, s31, 32768
  v_exp_f32 v63, v63
  v_mfma_f32_16x16x32_bf16 v[80:83], a[168:171], a[52:55], v[80:83]
  buffer_load_dwordx4 v17, s[12:15], s35 offen nt lds
  v_mfma_f32_16x16x32_bf16 v[80:83], a[172:175], a[72:75], v[80:83]
  ds_read_b64_tr_b16 a[218:219], v11 offset:53248
  v_cvt_pk_bf16_f32 v59, v62, v63
  v_mfma_f32_16x16x32_bf16 v[84:87], a[176:179], a[12:15], v[48:51]
  v_exp_f32 v64, v64
  v_mfma_f32_16x16x32_bf16 v[84:87], a[180:183], a[32:35], v[84:87]
  ds_read_b64_tr_b16 a[220:221], v12 offset:49152
  v_mfma_f32_16x16x32_bf16 v[84:87], a[184:187], a[52:55], v[84:87]
  v_exp_f32 v65, v65
  v_mfma_f32_16x16x32_bf16 v[84:87], a[188:191], a[72:75], v[84:87]
  ds_read_b64_tr_b16 a[222:223], v12 offset:53248
  v_cvt_pk_bf16_f32 v64, v64, v65
  v_mfma_f32_16x16x32_bf16 v[88:91], a[160:163], a[16:19], v[52:55]
  buffer_load_dwordx4 v18, s[12:15], s35 offen offset:1024 nt lds
  v_mfma_f32_16x16x32_bf16 v[88:91], a[164:167], a[36:39], v[88:91]
  v_exp_f32 v66, v66
  v_mfma_f32_16x16x32_bf16 v[88:91], a[168:171], a[56:59], v[88:91]
  v_exp_f32 v67, v67
  v_mfma_f32_16x16x32_bf16 v[88:91], a[172:175], a[76:79], v[88:91]
  v_exp_f32 v68, v68
  v_mfma_f32_16x16x32_bf16 v[92:95], a[176:179], a[16:19], v[52:55]
  v_exp_f32 v69, v69
  v_mfma_f32_16x16x32_bf16 v[92:95], a[180:183], a[36:39], v[92:95]
  v_exp_f32 v70, v70
  v_mfma_f32_16x16x32_bf16 v[92:95], a[184:187], a[56:59], v[92:95]
  buffer_load_dwordx4 v19, s[12:15], s35 offen offset:2048 nt lds
  v_mfma_f32_16x16x32_bf16 v[92:95], a[188:191], a[76:79], v[92:95]
  s_waitcnt lgkmcnt(0)
  v_exp_f32 v71, v71
  v_mfma_f32_16x16x32_bf16 v[96:99], a[192:195], v[56:59], v[96:99]
  v_cvt_pk_bf16_f32 v65, v66, v67
  v_cvt_pk_bf16_f32 v66, v68, v69
  v_mfma_f32_16x16x32_bf16 v[100:103], a[196:199], v[56:59], v[100:103]
  v_cvt_pk_bf16_f32 v67, v70, v71
  v_mfma_f32_16x16x32_bf16 v[136:139], a[200:203], v[56:59], v[136:139]
  v_exp_f32 v72, v72
  v_mfma_f32_16x16x32_bf16 v[140:143], a[204:207], v[56:59], v[140:143]
  v_exp_f32 v73, v73
  v_mfma_f32_16x16x32_bf16 v[176:179], a[208:211], v[56:59], v[176:179]
  buffer_load_dwordx4 v20, s[12:15], s35 offen offset:3072 nt lds
  v_mfma_f32_16x16x32_bf16 v[180:183], a[212:215], v[56:59], v[180:183]
  v_exp_f32 v74, v74
  v_mfma_f32_16x16x32_bf16 v[216:219], a[216:219], v[56:59], v[216:219]
  v_exp_f32 v75, v75
  v_mfma_f32_16x16x32_bf16 v[220:223], a[220:223], v[56:59], v[220:223]
  v_exp_f32 v76, v76
  v_mfma_f32_16x16x32_bf16 a[224:227], a[244:247], v[56:59], a[224:227]
  v_exp_f32 v77, v77
  v_mfma_f32_16x16x32_bf16 v[104:107], a[192:195], v[64:67], v[104:107]
  v_exp_f32 v78, v78
  v_mfma_f32_16x16x32_bf16 v[108:111], a[196:199], v[64:67], v[108:111]
  v_exp_f32 v79, v79
  v_mfma_f32_16x16x32_bf16 v[144:147], a[200:203], v[64:67], v[144:147]
  v_cvt_pk_bf16_f32 v72, v72, v73
  v_cvt_pk_bf16_f32 v73, v74, v75
  v_mfma_f32_16x16x32_bf16 v[148:151], a[204:207], v[64:67], v[148:151]
  ds_read_b128 a[160:163], v1 offset:0
  v_cvt_pk_bf16_f32 v74, v76, v77
  v_mfma_f32_16x16x32_bf16 v[184:187], a[208:211], v[64:67], v[184:187]
  v_cvt_pk_bf16_f32 v75, v78, v79
  v_mfma_f32_16x16x32_bf16 v[188:191], a[212:215], v[64:67], v[188:191]
  v_exp_f32 v80, v80
  v_mfma_f32_16x16x32_bf16 v[224:227], a[216:219], v[64:67], v[224:227]
  ds_read_b128 a[164:167], v2 offset:0
  v_mfma_f32_16x16x32_bf16 v[228:231], a[220:223], v[64:67], v[228:231]
  v_exp_f32 v81, v81
  v_mfma_f32_16x16x32_bf16 a[228:231], a[244:247], v[64:67], a[228:231]
  v_exp_f32 v82, v82
  v_mfma_f32_16x16x32_bf16 v[112:115], a[192:195], v[72:75], v[112:115]
  v_exp_f32 v83, v83
  v_mfma_f32_16x16x32_bf16 v[116:119], a[196:199], v[72:75], v[116:119]
  v_exp_f32 v84, v84
  v_mfma_f32_16x16x32_bf16 v[152:155], a[200:203], v[72:75], v[152:155]
  v_exp_f32 v85, v85
  v_mfma_f32_16x16x32_bf16 v[156:159], a[204:207], v[72:75], v[156:159]
  ds_read_b128 a[168:171], v3 offset:0
  v_cvt_pk_bf16_f32 v80, v80, v81
  v_mfma_f32_16x16x32_bf16 v[192:195], a[208:211], v[72:75], v[192:195]
  v_exp_f32 v86, v86
  v_mfma_f32_16x16x32_bf16 v[196:199], a[212:215], v[72:75], v[196:199]
  v_exp_f32 v87, v87
  v_mfma_f32_16x16x32_bf16 v[232:235], a[216:219], v[72:75], v[232:235]
  ds_read_b128 a[172:175], v4 offset:0
  v_cvt_pk_bf16_f32 v81, v82, v83
  v_mfma_f32_16x16x32_bf16 v[236:239], a[220:223], v[72:75], v[236:239]
  v_cvt_pk_bf16_f32 v82, v84, v85
  v_cvt_pk_bf16_f32 v83, v86, v87
  v_mfma_f32_16x16x32_bf16 a[232:235], a[244:247], v[72:75], a[232:235]
  v_exp_f32 v88, v88
  v_mfma_f32_16x16x32_bf16 v[120:123], a[192:195], v[80:83], v[120:123]
  v_exp_f32 v89, v89
  v_mfma_f32_16x16x32_bf16 v[124:127], a[196:199], v[80:83], v[124:127]
  v_exp_f32 v90, v90
  v_mfma_f32_16x16x32_bf16 v[160:163], a[200:203], v[80:83], v[160:163]
  v_exp_f32 v91, v91
  v_mfma_f32_16x16x32_bf16 v[164:167], a[204:207], v[80:83], v[164:167]
  ds_read_b128 a[176:179], v1 offset:4096
  v_cvt_pk_bf16_f32 v88, v88, v89
  v_mfma_f32_16x16x32_bf16 v[200:203], a[208:211], v[80:83], v[200:203]
  v_exp_f32 v92, v92
  v_mfma_f32_16x16x32_bf16 v[204:207], a[212:215], v[80:83], v[204:207]
  v_exp_f32 v93, v93
  v_mfma_f32_16x16x32_bf16 v[240:243], a[216:219], v[80:83], v[240:243]
  v_exp_f32 v94, v94
  v_mfma_f32_16x16x32_bf16 v[244:247], a[220:223], v[80:83], v[244:247]
  v_exp_f32 v95, v95
  v_mfma_f32_16x16x32_bf16 a[236:239], a[244:247], v[80:83], a[236:239]
  ds_read_b128 a[180:183], v2 offset:4096
  v_cvt_pk_bf16_f32 v89, v90, v91
  v_cvt_pk_bf16_f32 v90, v92, v93
  v_cvt_pk_bf16_f32 v91, v94, v95
  s_nop 1
  v_mfma_f32_16x16x32_bf16 v[128:131], a[192:195], v[88:91], v[128:131]
  ds_read_b128 a[184:187], v3 offset:4096
  v_mfma_f32_16x16x32_bf16 v[132:135], a[196:199], v[88:91], v[132:135]
  ds_read_b128 a[188:191], v4 offset:4096
  v_mfma_f32_16x16x32_bf16 v[168:171], a[200:203], v[88:91], v[168:171]
  v_mfma_f32_16x16x32_bf16 v[172:175], a[204:207], v[88:91], v[172:175]
  s_add_u32 s34, s34, s37
  s_bitset0_b32 s34, 17
  v_mfma_f32_16x16x32_bf16 v[208:211], a[208:211], v[88:91], v[208:211]
  s_add_u32 s35, s35, s36
  s_andn2_b32 s35, s35, s70
  v_mfma_f32_16x16x32_bf16 v[212:215], a[212:215], v[88:91], v[212:215]
  v_mfma_f32_16x16x32_bf16 v[248:251], a[216:219], v[88:91], v[248:251]
  s_cmp_eq_u32 s39, 3
  v_mfma_f32_16x16x32_bf16 v[252:255], a[220:223], v[88:91], v[252:255]
  s_waitcnt lgkmcnt(0)
  v_mfma_f32_16x16x32_bf16 a[240:243], a[244:247], v[88:91], a[240:243]
  s_cbranch_scc1 L_aend
L_a3:
  v_mfma_f32_16x16x32_bf16 v[56:59], a[160:163], a[0:3], v[36:39]
  s_waitcnt vmcnt(2)
  s_barrier
  v_mfma_f32_16x16x32_bf16 v[56:59], a[164:167], a[20:23], v[56:59]
  s_add_u32 m0, s31, 65792
  ds_read_b64_tr_b16 a[192:193], v5 offset:0
  v_mfma_f32_16x16x32_bf16 v[56:59], a[168:171], a[40:43], v[56:59]
  buffer_load_dwordx4 v13, s[8:11], s34 offen nt lds
  v_mfma_f32_16x16x32_bf16 v[56:59], a[172:175], a[60:63], v[56:59]
  ds_read_b64_tr_b16 a[194:195], v5 offset:4096
  v_mfma_f32_16x16x32_bf16 v[60:63], a[176:179], a[0:3], v[36:39]
  ds_read_b64_tr_b16 a[196:197], v6 offset:0
  v_mfma_f32_16x16x32_bf16 v[60:63], a[180:183], a[20:23], v[60:63]
  ds_read_b64_tr_b16 a[198:199], v6 offset:4096
  v_mfma_f32_16x16x32_bf16 v[60:63], a[184:187], a[40:43], v[60:63]
  ds_read_b64_tr_b16 a[200:201], v7 offset:0
  v_mfma_f32_16x16x32_bf16 v[60:63], a[188:191], a[60:63], v[60:63]
  ds_read_b64_tr_b16 a[202:203], v7 offset:4096
  v_mfma_f32_16x16x32_bf16 v[64:67], a[160:163], a[4:7], v[40:43]
  buffer_load_dwordx4 v14, s[8:11], s34 offen offset:1024 nt lds
  v_mfma_f32_16x16x32_bf16 v[64:67], a[164:167], a[24:27], v[64:67]
  ds_read_b64_tr_b16 a[204:205], v8 offset:0
  v_mfma_f32_16x16x32_bf16 v[64:67], a[168:171], a[44:47], v[64:67]
  ds_read_b64_tr_b16 a[206:207], v8 offset:4096
  v_mfma_f32_16x16x32_bf16 v[64:67], a[172:175], a[64:67], v[64:67]
  v_exp_f32 v56, v56
  v_mfma_f32_16x16x32_bf16 v[68:71], a[176:179], a[4:7], v[40:43]
  ds_read_b64_tr_b16 a[208:209], v9 offset:0
  v_mfma_f32_16x16x32_bf16 v[68:71], a[180:183], a[24:27], v[68:71]
  v_exp_f32 v57, v57
  v_mfma_f32_16x16x32_bf16 v[68:71], a[184:187], a[44:47], v[68:71]
  buffer_load_dwordx4 v15, s[8:11], s34 offen offset:2048 nt lds
  v_mfma_f32_16x16x32_bf16 v[68:71], a[188:191], a[64:67], v[68:71]
  ds_read_b64_tr_b16 a[210:211], v9 offset:4096
  v_cvt_pk_bf16_f32 v56, v56, v57
  v_mfma_f32_16x16x32_bf16 v[72:75], a[160:163], a[8:11], v[44:47]
  v_exp_f32 v58, v58
  v_mfma_f32_16x16x32_bf16 v[72:75], a[164:167], a[28:31], v[72:75]
  v_exp_f32 v59, v59
  v_mfma_f32_16x16x32_bf16 v[72:75], a[168:171], a[48:51], v[72:75]
  ds_read_b64_tr_b16 a[212:213], v10 offset:0
  v_cvt_pk_bf16_f32 v57, v58, v59
  v_mfma_f32_16x16x32_bf16 v[72:75], a[172:175], a[68:71], v[72:75]
  v_exp_f32 v60, v60
  v_mfma_f32_16x16x32_bf16 v[76:79], a[176:179], a[8:11], v[44:47]
  buffer_load_dwordx4 v16, s[8:11], s34 offen offset:3072 nt lds
  v_mfma_f32_16x16x32_bf16 v[76:79], a[180:183], a[28:31], v[76:79]
  ds_read_b64_tr_b16 a[214:215], v10 offset:4096
  v_mfma_f32_16x16x32_bf16 v[76:79], a[184:187], a[48:51], v[76:79]
  v_exp_f32 v61, v61
  v_mfma_f32_16x16x32_bf16 v[76:79], a[188:191], a[68:71], v[76:79]
  ds_read_b64_tr_b16 a[216:217], v11 offset:0
  v_cvt_pk_bf16_f32 v58, v60, v61
  v_mfma_f32_16x16x32_bf16 v[80:83], a[160:163], a[12:15], v[48:51]
  v_exp_f32 v62, v62
  v_mfma_f32_16x16x32_bf16 v[80:83], a[164:167], a[32:35], v[80:83]
  s_add_u32 m0, s31, 49152
  v_exp_f32 v63, v63
  v_mfma_f32_16x16x32_bf16 v[80:83], a[168:171], a[52:55], v[80:83]
  buffer_load_dwordx4 v17, s[12:15], s35 offen nt lds
  v_mfma_f32_16x16x32_bf16 v[80:83], a[172:175], a[72:75], v[80:83]
  ds_read_b64_tr_b16 a[218:219], v11 offset:4096
  v_cvt_pk_bf16_f32 v59, v62, v63
  v_mfma_f32_16x16x32_bf16 v[84:87], a[176:179], a[12:15], v[48:51]
  v_exp_f32 v64, v64
  v_mfma_f32_16x16x32_bf16 v[84:87], a[180:183], a[32:35], v[84:87]
  ds_read_b64_tr_b16 a[220:221], v12 offset:0
  v_mfma_f32_16x16x32_bf16 v[84:87], a[184:187], a[52:55], v[84:87]
  v_exp_f32 v65, v65
  v_mfma_f32_16x16x32_bf16 v[84:87], a[188:191], a[72:75], v[84:87]
  ds_read_b64_tr_b16 a[222:223], v12 offset:4096
  v_cvt_pk_bf16_f32 v64, v64, v65
  v_mfma_f32_16x16x32_bf16 v[88:91], a[160:163], a[16:19], v[52:55]
  buffer_load_dwordx4 v18, s[12:15], s35 offen offset:1024 nt lds
  v_mfma_f32_16x16x32_bf16 v[88:91], a[164:167], a[36:39], v[88:91]
  v_exp_f32 v66, v66
  v_mfma_f32_16x16x32_bf16 v[88:91], a[168:171], a[56:59], v[88:91]
  v_exp_f32 v67, v67
  v_mfma_f32_16x16x32_bf16 v[88:91], a[172:175], a[76:79], v[88:91]
  v_exp_f32 v68, v68
  v_mfma_f32_16x16x32_bf16 v[92:95], a[176:179], a[16:19], v[52:55]
  v_exp_f32 v69, v69
  v_mfma_f32_16x16x32_bf16 v[92:95], a[180:183], a[36:39], v[92:95]
  v_exp_f32 v70, v70
  v_mfma_f32_16x16x32_bf16 v[92:95], a[184:187], a[56:59], v[92:95]
  buffer_load_dwordx4 v19, s[12:15], s35 offen offset:2048 nt lds
  v_mfma_f32_16x16x32_bf16 v[92:95], a[188:191], a[76:79], v[92:95]
  s_waitcnt lgkmcnt(0)
  v_exp_f32 v71, v71
  v_mfma_f32_16x16x32_bf16 v[96:99], a[192:195], v[56:59], v[96:99]
  v_cvt_pk_bf16_f32 v65, v66, v67
  v_cvt_pk_bf16_f32 v66, v68, v69
  v_mfma_f32_16x16x32_bf16 v[100:103], a[196:199], v[56:59], v[100:103]
  v_cvt_pk_bf16_f32 v67, v70, v71
  v_mfma_f32_16x16x32_bf16 v[136:139], a[200:203], v[56:59], v[136:139]
  v_exp_f32 v72, v72
  v_mfma_f32_16x16x32_bf16 v[140:143], a[204:207], v[56:59], v[140:143]
  v_exp_f32 v73, v73
  v_mfma_f32_16x16x32_bf16 v[176:179], a[208:211], v[56:59], v[176:179]
  buffer_load_dwordx4 v20, s[12:15], s35 offen offset:3072 nt lds
  v_mfma_f32_16x16x32_bf16 v[180:183], a[212:215], v[56:59], v[180:183]
  v_exp_f32 v74, v74
  v_mfma_f32_16x16x32_bf16 v[216:219], a[216:219], v[56:59], v[216:219]
  v_exp_f32 v75, v75
  v_mfma_f32_16x16x32_bf16 v[220:223], a[220:223], v[56:59], v[220:223]
  v_exp_f32 v76, v76
  v_mfma_f32_16x16x32_bf16 a[224:227], a[244:247], v[56:59], a[224:227]
  v_exp_f32 v77, v77
  v_mfma_f32_16x16x32_bf16 v[104:107], a[192:195], v[64:67], v[104:107]
  v_exp_f32 v78, v78
  v_mfma_f32_16x16x32_bf16 v[108:111], a[196:199], v[64:67], v[108:111]
  v_exp_f32 v79, v79
  v_mfma_f32_16x16x32_bf16 v[144:147], a[200:203], v[64:67], v[144:147]
  v_cvt_pk_bf16_f32 v72, v72, v73
  v_cvt_pk_bf16_f32 v73, v74, v75
  v_mfma_f32_16x16x32_bf16 v[148:151], a[204:207], v[64:67], v[148:151]
  ds_read_b128 a[160:163], v1 offset:16384
  v_cvt_pk_bf16_f32 v74, v76, v77
  v_mfma_f32_16x16x32_bf16 v[184:187], a[208:211], v[64:67], v[184:187]
  v_cvt_pk_bf16_f32 v75, v78, v79
  v_mfma_f32_16x16x32_bf16 v[188:191], a[212:215], v[64:67], v[188:191]
  v_exp_f32 v80, v80
  v_mfma_f32_16x16x32_bf16 v[224:227], a[216:219], v[64:67], v[224:227]
  ds_read_b128 a[164:167], v2 offset:16384
  v_mfma_f32_16x16x32_bf16 v[228:231], a[220:223], v[64:67], v[228:231]
  v_exp_f32 v81, v81
  v_mfma_f32_16x16x32_bf16 a[228:231], a[244:247], v[64:67], a[228:231]
  v_exp_f32 v82, v82
  v_mfma_f32_16x16x32_bf16 v[112:115], a[192:195], v[72:75], v[112:115]
  v_exp_f32 v83, v83
  v_mfma_f32_16x16x32_bf16 v[116:119], a[196:199], v[72:75], v[116:119]
  v_exp_f32 v84, v84
  v_mfma_f32_16x16x32_bf16 v[152:155], a[200:203], v[72:75], v[152:155]
  v_exp_f32 v85, v85
  v_mfma_f32_16x16x32_bf16 v[156:159], a[204:207], v[72:75], v[156:159]
  ds_read_b128 a[168:171], v3 offset:16384
  v_cvt_pk_bf16_f32 v80, v80, v81
  v_mfma_f32_16x16x32_bf16 v[192:195], a[208:211], v[72:75], v[192:195]
  v_exp_f32 v86, v86
  v_mfma_f32_16x16x32_bf16 v[196:199], a[212:215], v[72:75], v[196:199]
  v_exp_f32 v87, v87
  v_mfma_f32_16x16x32_bf16 v[232:235], a[216:219], v[72:75], v[232:235]
  ds_read_b128 a[172:175], v4 offset:16384
  v_cvt_pk_bf16_f32 v81, v82, v83
  v_mfma_f32_16x16x32_bf16 v[236:239], a[220:223], v[72:75], v[236:239]
  v_cvt_pk_bf16_f32 v82, v84, v85
  v_cvt_pk_bf16_f32 v83, v86, v87
  v_mfma_f32_16x16x32_bf16 a[232:235], a[244:247], v[72:75], a[232:235]
  v_exp_f32 v88, v88
  v_mfma_f32_16x16x32_bf16 v[120:123], a[192:195], v[80:83], v[120:123]
  v_exp_f32 v89, v89
  v_mfma_f32_16x16x32_bf16 v[124:127], a[196:199], v[80:83], v[124:127]
  v_exp_f32 v90, v90
  v_mfma_f32_16x16x32_bf16 v[160:163], a[200:203], v[80:83], v[160:163]
  v_exp_f32 v91, v91
  v_mfma_f32_16x16x32_bf16 v[164:167], a[204:207], v[80:83], v[164:167]
  ds_read_b128 a[176:179], v1 offset:20480
  v_cvt_pk_bf16_f32 v88, v88, v89
  v_mfma_f32_16x16x32_bf16 v[200:203], a[208:211], v[80:83], v[200:203]
  v_exp_f32 v92, v92
  v_mfma_f32_16x16x32_bf16 v[204:207], a[212:215], v[80:83], v[204:207]
  v_exp_f32 v93, v93
  v_mfma_f32_16x16x32_bf16 v[240:243], a[216:219], v[80:83], v[240:243]
  v_exp_f32 v94, v94
  v_mfma_f32_16x16x32_bf16 v[244:247], a[220:223], v[80:83], v[244:247]
  v_exp_f32 v95, v95
  v_mfma_f32_16x16x32_bf16 a[236:239], a[244:247], v[80:83], a[236:239]
  ds_read_b128 a[180:183], v2 offset:20480
  v_cvt_pk_bf16_f32 v89, v90, v91
  v_cvt_pk_bf16_f32 v90, v92, v93
  v_cvt_pk_bf16_f32 v91, v94, v95
  s_nop 1
  v_mfma_f32_16x16x32_bf16 v[128:131], a[192:195], v[88:91], v[128:131]
  ds_read_b128 a[184:187], v3 offset:20480
  v_mfma_f32_16x16x32_bf16 v[132:135], a[196:199], v[88:91], v[132:135]
  ds_read_b128 a[188:191], v4 offset:20480
  v_mfma_f32_16x16x32_bf16 v[168:171], a[200:203], v[88:91], v[168:171]
  v_mfma_f32_16x16x32_bf16 v[172:175], a[204:207], v[88:91], v[172:175]
  s_add_u32 s34, s34, 8192
  s_bitset0_b32 s34, 17
  v_mfma_f32_16x16x32_bf16 v[208:211], a[208:211], v[88:91], v[208:211]
  s_add_u32 s35, s35, s36
  s_andn2_b32 s35, s35, s70
  v_mfma_f32_16x16x32_bf16 v[212:215], a[212:215], v[88:91], v[212:215]
  s_add_u32 s39, s39, 1
  s_cmp_eq_u32 s39, 2
  v_mfma_f32_16x16x32_bf16 v[248:251], a[216:219], v[88:91], v[248:251]
  s_cselect_b32 s37, 0x42000, s37
  s_cmp_lg_u32 s39, 3
  v_mfma_f32_16x16x32_bf16 v[252:255], a[220:223], v[88:91], v[252:255]
  s_waitcnt lgkmcnt(0)
  v_mfma_f32_16x16x32_bf16 a[240:243], a[244:247], v[88:91], a[240:243]
  s_cbranch_scc1 L_aloop
  s_mov_b32 s37, 8192
  s_mov_b64 vcc, -1
  s_cmp_eq_u32 s50, 0
  s_cbranch_scc0 L_aswap1
  s_add_u32 s35, s35, 0x40000
  s_cmp_eq_u32 s30, 3
  s_cbranch_scc0 L_ctA
  s_getpc_b64 s[98:99]
L_pcA:
  s_add_u32 s98, s98, L_at - L_pcA
  s_addc_u32 s99, s99, ((L_at - L_pcA) >> 32) & 0xffffffff
  s_bfe_u32 s100, s2, 0x20003
  v_lshl_add_u32 v31, v0, 2, s100
  v_lshlrev_b32 v31, 7, v31
  v_min_u32 v31, L_aepi1 - L_at - 4, v31
  global_load_dword v31, v31, s[98:99]
L_ctA:
  s_branch L_aloop
L_aswap1:
  s_cmp_eq_u32 s30, 3
  s_cbranch_scc0 L_ctO
  s_getpc_b64 s[98:99]
L_pcO:
  s_add_u32 s98, s98, L_aepi1 - L_pcO
  s_addc_u32 s99, s99, ((L_aepi1 - L_pcO) >> 32) & 0xffffffff
  s_bfe_u32 s100, s2, 0x20003
  v_lshl_add_u32 v31, v0, 2, s100
  v_lshlrev_b32 v31, 7, v31
  v_min_u32 v31, L_otail - L_aepi1 - 4, v31
  global_load_dword v31, v31, s[98:99]
L_ctO:
  s_mov_b32 s12, s26
  s_mov_b32 s13, s27
  s_mov_b32 s14, 0x80000
  s_add_u32 s48, s33, 1
  s_and_b32 s48, s48, 7
  s_lshl_b32 s52, s48, 7
  s_mov_b32 s54, s52
  s_mul_i32 s53, s48, 143360
  s_mov_b32 s35, s52
  s_mov_b32 s70, 0
  s_mov_b32 s36, 0x20000
  v_mov_b32 v17, v22
  v_add_u32 v18, 7168, v22
  v_add_u32 v19, 14336, v22
  v_add_u32 v20, 21504, v22
  s_lshr_b32 s48, s2, 4
  s_lshl_b32 s48, s48, 2
  s_add_u32 s48, s48, s30
  s_lshl_b32 s48, s48, 13
  v_lshlrev_b32 v28, 7, v0
  v_mov_b32 v33, 0
  buffer_load_dword v35, v28, s[12:15], s48 offen
  global_load_dword v34, v33, s[28:29] sc1
L_at:
  v_mfma_f32_16x16x32_bf16 v[56:59], a[160:163], a[0:3], v[36:39]
  s_waitcnt vmcnt(18)
  s_barrier
  v_mfma_f32_16x16x32_bf16 v[56:59], a[164:167], a[20:23], v[56:59]
  ds_read_b64_tr_b16 a[192:193], v5 offset:16384
  v_mfma_f32_16x16x32_bf16 v[56:59], a[168:171], a[40:43], v[56:59]
  ds_write_b128 v27, a[80:83] offset:0
  v_mfma_f32_16x16x32_bf16 v[56:59], a[172:175], a[60:63], v[56:59]
  ds_read_b64_tr_b16 a[194:195], v5 offset:20480
  v_mfma_f32_16x16x32_bf16 v[60:63], a[176:179], a[0:3], v[36:39]
  ds_read_b64_tr_b16 a[196:197], v6 offset:16384
  v_mfma_f32_16x16x32_bf16 v[60:63], a[180:183], a[20:23], v[60:63]
  ds_read_b64_tr_b16 a[198:199], v6 offset:20480
  v_mfma_f32_16x16x32_bf16 v[60:63], a[184:187], a[40:43], v[60:63]
  ds_write_b128 v27, a[84:87] offset:4096
  v_mfma_f32_16x16x32_bf16 v[60:63], a[188:191], a[60:63], v[60:63]
  ds_read_b64_tr_b16 a[200:201], v7 offset:16384
  v_mfma_f32_16x16x32_bf16 v[64:67], a[160:163], a[4:7], v[40:43]
  ds_read_b64_tr_b16 a[202:203], v7 offset:20480
  v_mfma_f32_16x16x32_bf16 v[64:67], a[164:167], a[24:27], v[64:67]
  ds_read_b64_tr_b16 a[204:205], v8 offset:16384
  v_mfma_f32_16x16x32_bf16 v[64:67], a[168:171], a[44:47], v[64:67]
  ds_write_b128 v27, a[88:91] offset:8192
  v_mfma_f32_16x16x32_bf16 v[64:67], a[172:175], a[64:67], v[64:67]
  ds_read_b64_tr_b16 a[206:207], v8 offset:20480
  v_mfma_f32_16x16x32_bf16 v[68:71], a[176:179], a[4:7], v[40:43]
  v_exp_f32 v56, v56
  v_mfma_f32_16x16x32_bf16 v[68:71], a[180:183], a[24:27], v[68:71]
  ds_read_b64_tr_b16 a[208:209], v9 offset:16384
  v_mfma_f32_16x16x32_bf16 v[68:71], a[184:187], a[44:47], v[68:71]
  ds_write_b128 v27, a[92:95] offset:12288
  v_mfma_f32_16x16x32_bf16 v[68:71], a[188:191], a[64:67], v[68:71]
  v_exp_f32 v57, v57
  v_mfma_f32_16x16x32_bf16 v[72:75], a[160:163], a[8:11], v[44:47]
  ds_read_b64_tr_b16 a[210:211], v9 offset:20480
  v_cvt_pk_bf16_f32 v56, v56, v57
  v_mfma_f32_16x16x32_bf16 v[72:75], a[164:167], a[28:31], v[72:75]
  v_exp_f32 v58, v58
  v_mfma_f32_16x16x32_bf16 v[72:75], a[168:171], a[48:51], v[72:75]
  v_exp_f32 v59, v59
  v_mfma_f32_16x16x32_bf16 v[72:75], a[172:175], a[68:71], v[72:75]
  ds_read_b64_tr_b16 a[212:213], v10 offset:16384
  v_cvt_pk_bf16_f32 v57, v58, v59
  v_mfma_f32_16x16x32_bf16 v[76:79], a[176:179], a[8:11], v[44:47]
  v_exp_f32 v60, v60
  v_mfma_f32_16x16x32_bf16 v[76:79], a[180:183], a[28:31], v[76:79]
  ds_read_b64_tr_b16 a[214:215], v10 offset:20480
  v_mfma_f32_16x16x32_bf16 v[76:79], a[184:187], a[48:51], v[76:79]
  v_exp_f32 v61, v61
  v_mfma_f32_16x16x32_bf16 v[76:79], a[188:191], a[68:71], v[76:79]
  ds_read_b64_tr_b16 a[216:217], v11 offset:16384
  v_cvt_pk_bf16_f32 v58, v60, v61
  v_mfma_f32_16x16x32_bf16 v[80:83], a[160:163], a[12:15], v[48:51]
  v_exp_f32 v62, v62
  v_mfma_f32_16x16x32_bf16 v[80:83], a[164:167], a[32:35], v[80:83]
  s_add_u32 m0, s31, 0
  v_exp_f32 v63, v63
  v_mfma_f32_16x16x32_bf16 v[80:83], a[168:171], a[52:55], v[80:83]
  buffer_load_dwordx4 v17, s[12:15], s35 offen lds
  v_mfma_f32_16x16x32_bf16 v[80:83], a[172:175], a[72:75], v[80:83]
  ds_read_b64_tr_b16 a[218:219], v11 offset:20480
  v_cvt_pk_bf16_f32 v59, v62, v63
  v_mfma_f32_16x16x32_bf16 v[84:87], a[176:179], a[12:15], v[48:51]
  v_exp_f32 v64, v64
  v_mfma_f32_16x16x32_bf16 v[84:87], a[180:183], a[32:35], v[84:87]
  ds_read_b64_tr_b16 a[220:221], v12 offset:16384
  v_mfma_f32_16x16x32_bf16 v[84:87], a[184:187], a[52:55], v[84:87]
  v_exp_f32 v65, v65
  v_mfma_f32_16x16x32_bf16 v[84:87], a[188:191], a[72:75], v[84:87]
  ds_read_b64_tr_b16 a[222:223], v12 offset:20480
  v_cvt_pk_bf16_f32 v64, v64, v65
  v_mfma_f32_16x16x32_bf16 v[88:91], a[160:163], a[16:19], v[52:55]
  buffer_load_dwordx4 v18, s[12:15], s35 offen offset:1024 lds
  v_mfma_f32_16x16x32_bf16 v[88:91], a[164:167], a[36:39], v[88:91]
  v_exp_f32 v66, v66
  v_mfma_f32_16x16x32_bf16 v[88:91], a[168:171], a[56:59], v[88:91]
  v_exp_f32 v67, v67
  v_mfma_f32_16x16x32_bf16 v[88:91], a[172:175], a[76:79], v[88:91]
  v_exp_f32 v68, v68
  v_mfma_f32_16x16x32_bf16 v[92:95], a[176:179], a[16:19], v[52:55]
  v_exp_f32 v69, v69
  v_mfma_f32_16x16x32_bf16 v[92:95], a[180:183], a[36:39], v[92:95]
  v_exp_f32 v70, v70
  v_mfma_f32_16x16x32_bf16 v[92:95], a[184:187], a[56:59], v[92:95]
  buffer_load_dwordx4 v19, s[12:15], s35 offen offset:2048 lds
  v_mfma_f32_16x16x32_bf16 v[92:95], a[188:191], a[76:79], v[92:95]
  s_waitcnt lgkmcnt(0)
  v_exp_f32 v71, v71
  v_mfma_f32_16x16x32_bf16 v[96:99], a[192:195], v[56:59], v[96:99]
  v_cvt_pk_bf16_f32 v65, v66, v67
  v_cvt_pk_bf16_f32 v66, v68, v69
  v_mfma_f32_16x16x32_bf16 v[100:103], a[196:199], v[56:59], v[100:103]
  v_cvt_pk_bf16_f32 v67, v70, v71
  v_mfma_f32_16x16x32_bf16 v[136:139], a[200:203], v[56:59], v[136:139]
  v_exp_f32 v72, v72
  v_mfma_f32_16x16x32_bf16 v[140:143], a[204:207], v[56:59], v[140:143]
  v_exp_f32 v73, v73
  v_mfma_f32_16x16x32_bf16 v[176:179], a[208:211], v[56:59], v[176:179]
  buffer_load_dwordx4 v20, s[12:15], s35 offen offset:3072 lds
  v_mfma_f32_16x16x32_bf16 v[180:183], a[212:215], v[56:59], v[180:183]
  ds_write_b128 v27, a[100:103] offset:20480
  v_mfma_f32_16x16x32_bf16 v[216:219], a[216:219], v[56:59], v[216:219]
  v_exp_f32 v74, v74
  v_mfma_f32_16x16x32_bf16 v[220:223], a[220:223], v[56:59], v[220:223]
  v_exp_f32 v75, v75
  v_mfma_f32_16x16x32_bf16 a[224:227], a[244:247], v[56:59], a[224:227]
  v_exp_f32 v76, v76
  v_mfma_f32_16x16x32_bf16 v[104:107], a[192:195], v[64:67], v[104:107]
  v_exp_f32 v77, v77
  v_mfma_f32_16x16x32_bf16 v[108:111], a[196:199], v[64:67], v[108:111]
  v_exp_f32 v78, v78
  v_mfma_f32_16x16x32_bf16 v[144:147], a[200:203], v[64:67], v[144:147]
  v_exp_f32 v79, v79
  v_mfma_f32_16x16x32_bf16 v[148:151], a[204:207], v[64:67], v[148:151]
  ds_read_b128 a[160:163], v1 offset:32768
  v_cvt_pk_bf16_f32 v72, v72, v73
  v_mfma_f32_16x16x32_bf16 v[184:187], a[208:211], v[64:67], v[184:187]
  v_cvt_pk_bf16_f32 v73, v74, v75
  v_cvt_pk_bf16_f32 v74, v76, v77
  v_mfma_f32_16x16x32_bf16 v[188:191], a[212:215], v[64:67], v[188:191]
  v_cvt_pk_bf16_f32 v75, v78, v79
  v_mfma_f32_16x16x32_bf16 v[224:227], a[216:219], v[64:67], v[224:227]
  ds_read_b128 a[164:167], v2 offset:32768
  v_mfma_f32_16x16x32_bf16 v[228:231], a[220:223], v[64:67], v[228:231]
  v_exp_f32 v80, v80
  v_mfma_f32_16x16x32_bf16 a[228:231], a[244:247], v[64:67], a[228:231]
  v_exp_f32 v81, v81
  v_mfma_f32_16x16x32_bf16 v[112:115], a[192:195], v[72:75], v[112:115]
  v_exp_f32 v82, v82
  v_mfma_f32_16x16x32_bf16 v[116:119], a[196:199], v[72:75], v[116:119]
  v_exp_f32 v83, v83
  v_mfma_f32_16x16x32_bf16 v[152:155], a[200:203], v[72:75], v[152:155]
  ds_write_b128 v27, a[104:107] offset:24576
  v_mfma_f32_16x16x32_bf16 v[156:159], a[204:207], v[72:75], v[156:159]
  ds_read_b128 a[168:171], v3 offset:32768
  v_cvt_pk_bf16_f32 v80, v80, v81
  v_mfma_f32_16x16x32_bf16 v[192:195], a[208:211], v[72:75], v[192:195]
  v_exp_f32 v84, v84
  v_mfma_f32_16x16x32_bf16 v[196:199], a[212:215], v[72:75], v[196:199]
  v_exp_f32 v85, v85
  v_mfma_f32_16x16x32_bf16 v[232:235], a[216:219], v[72:75], v[232:235]
  ds_read_b128 a[172:175], v4 offset:32768
  v_cvt_pk_bf16_f32 v81, v82, v83
  v_mfma_f32_16x16x32_bf16 v[236:239], a[220:223], v[72:75], v[236:239]
  v_exp_f32 v86, v86
  v_mfma_f32_16x16x32_bf16 a[232:235], a[244:247], v[72:75], a[232:235]
  v_exp_f32 v87, v87
  v_cvt_pk_bf16_f32 v82, v84, v85
  v_cvt_pk_bf16_f32 v83, v86, v87
  s_nop 1
  v_mfma_f32_16x16x32_bf16 v[120:123], a[192:195], v[80:83], v[120:123]
  v_exp_f32 v88, v88
  v_mfma_f32_16x16x32_bf16 v[124:127], a[196:199], v[80:83], v[124:127]
  v_exp_f32 v89, v89
  v_mfma_f32_16x16x32_bf16 v[160:163], a[200:203], v[80:83], v[160:163]
  v_exp_f32 v90, v90
  v_mfma_f32_16x16x32_bf16 v[164:167], a[204:207], v[80:83], v[164:167]
  ds_read_b128 a[176:179], v1 offset:36864
  v_cvt_pk_bf16_f32 v88, v88, v89
  v_mfma_f32_16x16x32_bf16 v[200:203], a[208:211], v[80:83], v[200:203]
  v_exp_f32 v91, v91
  v_mfma_f32_16x16x32_bf16 v[204:207], a[212:215], v[80:83], v[204:207]
  v_exp_f32 v92, v92
  v_mfma_f32_16x16x32_bf16 v[240:243], a[216:219], v[80:83], v[240:243]
  v_exp_f32 v93, v93
  v_mfma_f32_16x16x32_bf16 v[244:247], a[220:223], v[80:83], v[244:247]
  v_exp_f32 v94, v94
  v_mfma_f32_16x16x32_bf16 a[236:239], a[244:247], v[80:83], a[236:239]
  ds_read_b128 a[180:183], v2 offset:36864
  v_cvt_pk_bf16_f32 v89, v90, v91
  v_exp_f32 v95, v95
  v_cvt_pk_bf16_f32 v90, v92, v93
  v_cvt_pk_bf16_f32 v91, v94, v95
  s_nop 1
  v_mfma_f32_16x16x32_bf16 v[128:131], a[192:195], v[88:91], v[128:131]
  ds_read_b128 a[184:187], v3 offset:36864
  v_mfma_f32_16x16x32_bf16 v[132:135], a[196:199], v[88:91], v[132:135]
  ds_read_b128 a[188:191], v4 offset:36864
  v_mfma_f32_16x16x32_bf16 v[168:171], a[200:203], v[88:91], v[168:171]
  v_mfma_f32_16x16x32_bf16 v[172:175], a[204:207], v[88:91], v[172:175]
  ds_write_b128 v27, a[96:99] offset:16384
  v_mfma_f32_16x16x32_bf16 v[208:211], a[208:211], v[88:91], v[208:211]
  s_add_u32 s35, s35, s36
  s_andn2_b32 s35, s35, s70
  v_mfma_f32_16x16x32_bf16 v[212:215], a[212:215], v[88:91], v[212:215]
  v_mfma_f32_16x16x32_bf16 v[248:251], a[216:219], v[88:91], v[248:251]
  v_mfma_f32_16x16x32_bf16 v[252:255], a[220:223], v[88:91], v[252:255]
  s_waitcnt lgkmcnt(0)
  v_mfma_f32_16x16x32_bf16 a[240:243], a[244:247], v[88:91], a[240:243]
  v_mfma_f32_16x16x32_bf16 v[56:59], a[160:163], a[0:3], v[36:39]
  s_waitcnt vmcnt(10)
  s_barrier
  v_mfma_f32_16x16x32_bf16 v[56:59], a[164:167], a[20:23], v[56:59]
  ds_read_b64_tr_b16 a[192:193], v5 offset:32768
  v_mfma_f32_16x16x32_bf16 v[56:59], a[168:171], a[40:43], v[56:59]
  ds_write_b128 v26, a[108:111] offset:0
  v_mfma_f32_16x16x32_bf16 v[56:59], a[172:175], a[60:63], v[56:59]
  ds_read_b64_tr_b16 a[194:195], v5 offset:36864
  v_mfma_f32_16x16x32_bf16 v[60:63], a[176:179], a[0:3], v[36:39]
  ds_read_b64_tr_b16 a[196:197], v6 offset:32768
  v_mfma_f32_16x16x32_bf16 v[60:63], a[180:183], a[20:23], v[60:63]
  ds_read_b64_tr_b16 a[198:199], v6 offset:36864
  v_mfma_f32_16x16x32_bf16 v[60:63], a[184:187], a[40:43], v[60:63]
  ds_write_b128 v26, a[112:115] offset:4096
  v_mfma_f32_16x16x32_bf16 v[60:63], a[188:191], a[60:63], v[60:63]
  ds_read_b64_tr_b16 a[200:201], v7 offset:32768
  v_mfma_f32_16x16x32_bf16 v[64:67], a[160:163], a[4:7], v[40:43]
  ds_read_b64_tr_b16 a[202:203], v7 offset:36864
  v_mfma_f32_16x16x32_bf16 v[64:67], a[164:167], a[24:27], v[64:67]
  ds_read_b64_tr_b16 a[204:205], v8 offset:32768
  v_mfma_f32_16x16x32_bf16 v[64:67], a[168:171], a[44:47], v[64:67]
  ds_write_b128 v26, a[116:119] offset:8192
  v_mfma_f32_16x16x32_bf16 v[64:67], a[172:175], a[64:67], v[64:67]
  ds_read_b64_tr_b16 a[206:207], v8 offset:36864
  v_mfma_f32_16x16x32_bf16 v[68:71], a[176:179], a[4:7], v[40:43]
  v_exp_f32 v56, v56
  v_mfma_f32_16x16x32_bf16 v[68:71], a[180:183], a[24:27], v[68:71]
  ds_read_b64_tr_b16 a[208:209], v9 offset:32768
  v_mfma_f32_16x16x32_bf16 v[68:71], a[184:187], a[44:47], v[68:71]
  ds_write_b128 v26, a[120:123] offset:12288
  v_mfma_f32_16x16x32_bf16 v[68:71], a[188:191], a[64:67], v[68:71]
  v_exp_f32 v57, v57
  v_mfma_f32_16x16x32_bf16 v[72:75], a[160:163], a[8:11], v[44:47]
  ds_read_b64_tr_b16 a[210:211], v9 offset:36864
  v_cvt_pk_bf16_f32 v56, v56, v57
  v_mfma_f32_16x16x32_bf16 v[72:75], a[164:167], a[28:31], v[72:75]
  v_exp_f32 v58, v58
  v_mfma_f32_16x16x32_bf16 v[72:75], a[168:171], a[48:51], v[72:75]
  v_exp_f32 v59, v59
  v_mfma_f32_16x16x32_bf16 v[72:75], a[172:175], a[68:71], v[72:75]
  ds_read_b64_tr_b16 a[212:213], v10 offset:32768
  v_cvt_pk_bf16_f32 v57, v58, v59
  v_mfma_f32_16x16x32_bf16 v[76:79], a[176:179], a[8:11], v[44:47]
  v_exp_f32 v60, v60
  v_mfma_f32_16x16x32_bf16 v[76:79], a[180:183], a[28:31], v[76:79]
  ds_read_b64_tr_b16 a[214:215], v10 offset:36864
  v_mfma_f32_16x16x32_bf16 v[76:79], a[184:187], a[48:51], v[76:79]
  v_exp_f32 v61, v61
  v_mfma_f32_16x16x32_bf16 v[76:79], a[188:191], a[68:71], v[76:79]
  ds_read_b64_tr_b16 a[216:217], v11 offset:32768
  v_cvt_pk_bf16_f32 v58, v60, v61
  v_mfma_f32_16x16x32_bf16 v[80:83], a[160:163], a[12:15], v[48:51]
  v_exp_f32 v62, v62
  v_mfma_f32_16x16x32_bf16 v[80:83], a[164:167], a[32:35], v[80:83]
  s_add_u32 m0, s31, 16384
  v_exp_f32 v63, v63
  v_mfma_f32_16x16x32_bf16 v[80:83], a[168:171], a[52:55], v[80:83]
  buffer_load_dwordx4 v17, s[12:15], s35 offen lds
  v_mfma_f32_16x16x32_bf16 v[80:83], a[172:175], a[72:75], v[80:83]
  ds_read_b64_tr_b16 a[218:219], v11 offset:36864
  v_cvt_pk_bf16_f32 v59, v62, v63
  v_mfma_f32_16x16x32_bf16 v[84:87], a[176:179], a[12:15], v[48:51]
  v_exp_f32 v64, v64
  v_mfma_f32_16x16x32_bf16 v[84:87], a[180:183], a[32:35], v[84:87]
  ds_read_b64_tr_b16 a[220:221], v12 offset:32768
  v_mfma_f32_16x16x32_bf16 v[84:87], a[184:187], a[52:55], v[84:87]
  v_exp_f32 v65, v65
  v_mfma_f32_16x16x32_bf16 v[84:87], a[188:191], a[72:75], v[84:87]
  ds_read_b64_tr_b16 a[222:223], v12 offset:36864
  v_cvt_pk_bf16_f32 v64, v64, v65
  v_mfma_f32_16x16x32_bf16 v[88:91], a[160:163], a[16:19], v[52:55]
  buffer_load_dwordx4 v18, s[12:15], s35 offen offset:1024 lds
  v_mfma_f32_16x16x32_bf16 v[88:91], a[164:167], a[36:39], v[88:91]
  v_exp_f32 v66, v66
  v_mfma_f32_16x16x32_bf16 v[88:91], a[168:171], a[56:59], v[88:91]
  v_exp_f32 v67, v67
  v_mfma_f32_16x16x32_bf16 v[88:91], a[172:175], a[76:79], v[88:91]
  v_exp_f32 v68, v68
  v_mfma_f32_16x16x32_bf16 v[92:95], a[176:179], a[16:19], v[52:55]
  v_exp_f32 v69, v69
  v_mfma_f32_16x16x32_bf16 v[92:95], a[180:183], a[36:39], v[92:95]
  v_exp_f32 v70, v70
  v_mfma_f32_16x16x32_bf16 v[92:95], a[184:187], a[56:59], v[92:95]
  buffer_load_dwordx4 v19, s[12:15], s35 offen offset:2048 lds
  v_mfma_f32_16x16x32_bf16 v[92:95], a[188:191], a[76:79], v[92:95]
  s_waitcnt lgkmcnt(0)
  v_exp_f32 v71, v71
  v_mfma_f32_16x16x32_bf16 v[96:99], a[192:195], v[56:59], v[96:99]
  v_cvt_pk_bf16_f32 v65, v66, v67
  v_cvt_pk_bf16_f32 v66, v68, v69
  v_mfma_f32_16x16x32_bf16 v[100:103], a[196:199], v[56:59], v[100:103]
  v_cvt_pk_bf16_f32 v67, v70, v71
  v_mfma_f32_16x16x32_bf16 v[136:139], a[200:203], v[56:59], v[136:139]
  v_exp_f32 v72, v72
  v_mfma_f32_16x16x32_bf16 v[140:143], a[204:207], v[56:59], v[140:143]
  v_exp_f32 v73, v73
  v_mfma_f32_16x16x32_bf16 v[176:179], a[208:211], v[56:59], v[176:179]
  buffer_load_dwordx4 v20, s[12:15], s35 offen offset:3072 lds
  v_mfma_f32_16x16x32_bf16 v[180:183], a[212:215], v[56:59], v[180:183]
  ds_write_b128 v26, a[128:131] offset:20480
  v_mfma_f32_16x16x32_bf16 v[216:219], a[216:219], v[56:59], v[216:219]
  v_exp_f32 v74, v74
  v_mfma_f32_16x16x32_bf16 v[220:223], a[220:223], v[56:59], v[220:223]
  v_exp_f32 v75, v75
  v_mfma_f32_16x16x32_bf16 a[224:227], a[244:247], v[56:59], a[224:227]
  v_exp_f32 v76, v76
  v_mfma_f32_16x16x32_bf16 v[104:107], a[192:195], v[64:67], v[104:107]
  v_exp_f32 v77, v77
  v_mfma_f32_16x16x32_bf16 v[108:111], a[196:199], v[64:67], v[108:111]
  v_exp_f32 v78, v78
  v_mfma_f32_16x16x32_bf16 v[144:147], a[200:203], v[64:67], v[144:147]
  v_exp_f32 v79, v79
  v_mfma_f32_16x16x32_bf16 v[148:151], a[204:207], v[64:67], v[148:151]
  ds_read_b128 a[160:163], v1 offset:49152
  v_cvt_pk_bf16_f32 v72, v72, v73
  v_mfma_f32_16x16x32_bf16 v[184:187], a[208:211], v[64:67], v[184:187]
  v_cvt_pk_bf16_f32 v73, v74, v75
  v_cvt_pk_bf16_f32 v74, v76, v77
  v_mfma_f32_16x16x32_bf16 v[188:191], a[212:215], v[64:67], v[188:191]
  v_cvt_pk_bf16_f32 v75, v78, v79
  v_mfma_f32_16x16x32_bf16 v[224:227], a[216:219], v[64:67], v[224:227]
  ds_read_b128 a[164:167], v2 offset:49152
  v_mfma_f32_16x16x32_bf16 v[228:231], a[220:223], v[64:67], v[228:231]
  v_exp_f32 v80, v80
  v_mfma_f32_16x16x32_bf16 a[228:231], a[244:247], v[64:67], a[228:231]
  v_exp_f32 v81, v81
  v_mfma_f32_16x16x32_bf16 v[112:115], a[192:195], v[72:75], v[112:115]
  v_exp_f32 v82, v82
  v_mfma_f32_16x16x32_bf16 v[116:119], a[196:199], v[72:75], v[116:119]
  v_exp_f32 v83, v83
  v_mfma_f32_16x16x32_bf16 v[152:155], a[200:203], v[72:75], v[152:155]
  ds_write_b128 v26, a[132:135] offset:24576
  v_mfma_f32_16x16x32_bf16 v[156:159], a[204:207], v[72:75], v[156:159]
  ds_read_b128 a[168:171], v3 offset:49152
  v_cvt_pk_bf16_f32 v80, v80, v81
  v_mfma_f32_16x16x32_bf16 v[192:195], a[208:211], v[72:75], v[192:195]
  v_exp_f32 v84, v84
  v_mfma_f32_16x16x32_bf16 v[196:199], a[212:215], v[72:75], v[196:199]
  v_exp_f32 v85, v85
  v_mfma_f32_16x16x32_bf16 v[232:235], a[216:219], v[72:75], v[232:235]
  ds_read_b128 a[172:175], v4 offset:49152
  v_cvt_pk_bf16_f32 v81, v82, v83
  v_mfma_f32_16x16x32_bf16 v[236:239], a[220:223], v[72:75], v[236:239]
  v_exp_f32 v86, v86
  v_mfma_f32_16x16x32_bf16 a[232:235], a[244:247], v[72:75], a[232:235]
  v_exp_f32 v87, v87
  v_cvt_pk_bf16_f32 v82, v84, v85
  v_cvt_pk_bf16_f32 v83, v86, v87
  s_nop 1
  v_mfma_f32_16x16x32_bf16 v[120:123], a[192:195], v[80:83], v[120:123]
  v_exp_f32 v88, v88
  v_mfma_f32_16x16x32_bf16 v[124:127], a[196:199], v[80:83], v[124:127]
  v_exp_f32 v89, v89
  v_mfma_f32_16x16x32_bf16 v[160:163], a[200:203], v[80:83], v[160:163]
  ds_write_b128 v26, a[136:139] offset:28672
  v_mfma_f32_16x16x32_bf16 v[164:167], a[204:207], v[80:83], v[164:167]
  ds_read_b128 a[176:179], v1 offset:53248
  v_cvt_pk_bf16_f32 v88, v88, v89
  v_mfma_f32_16x16x32_bf16 v[200:203], a[208:211], v[80:83], v[200:203]
  v_exp_f32 v90, v90
  v_mfma_f32_16x16x32_bf16 v[204:207], a[212:215], v[80:83], v[204:207]
  v_exp_f32 v91, v91
  v_mfma_f32_16x16x32_bf16 v[240:243], a[216:219], v[80:83], v[240:243]
  v_exp_f32 v92, v92
  v_mfma_f32_16x16x32_bf16 v[244:247], a[220:223], v[80:83], v[244:247]
  v_exp_f32 v93, v93
  v_mfma_f32_16x16x32_bf16 a[236:239], a[244:247], v[80:83], a[236:239]
  ds_read_b128 a[180:183], v2 offset:53248
  v_cvt_pk_bf16_f32 v89, v90, v91
  v_exp_f32 v94, v94
  v_exp_f32 v95, v95
  v_cvt_pk_bf16_f32 v90, v92, v93
  v_cvt_pk_bf16_f32 v91, v94, v95
  s_nop 1
  v_mfma_f32_16x16x32_bf16 v[128:131], a[192:195], v[88:91], v[128:131]
  ds_read_b128 a[184:187], v3 offset:53248
  v_mfma_f32_16x16x32_bf16 v[132:135], a[196:199], v[88:91], v[132:135]
  ds_read_b128 a[188:191], v4 offset:53248
  v_mfma_f32_16x16x32_bf16 v[168:171], a[200:203], v[88:91], v[168:171]
  v_mfma_f32_16x16x32_bf16 v[172:175], a[204:207], v[88:91], v[172:175]
  ds_write_b128 v26, a[124:127] offset:16384
  v_mfma_f32_16x16x32_bf16 v[208:211], a[208:211], v[88:91], v[208:211]
  s_add_u32 s35, s35, s36
  s_andn2_b32 s35, s35, s70
  v_mfma_f32_16x16x32_bf16 v[212:215], a[212:215], v[88:91], v[212:215]
  v_mfma_f32_16x16x32_bf16 v[248:251], a[216:219], v[88:91], v[248:251]
  v_mfma_f32_16x16x32_bf16 v[252:255], a[220:223], v[88:91], v[252:255]
  s_waitcnt lgkmcnt(0)
  v_mfma_f32_16x16x32_bf16 a[240:243], a[244:247], v[88:91], a[240:243]
  v_mfma_f32_16x16x32_bf16 v[56:59], a[160:163], a[0:3], v[36:39]
  s_waitcnt vmcnt(0)
  s_barrier
  v_mfma_f32_16x16x32_bf16 v[56:59], a[164:167], a[20:23], v[56:59]
  ds_read_b64_tr_b16 a[192:193], v5 offset:49152
  v_mfma_f32_16x16x32_bf16 v[56:59], a[168:171], a[40:43], v[56:59]
  ds_write_b128 v26, a[140:143] offset:32768
  v_mfma_f32_16x16x32_bf16 v[56:59], a[172:175], a[60:63], v[56:59]
  ds_read_b64_tr_b16 a[194:195], v5 offset:53248
  v_mfma_f32_16x16x32_bf16 v[60:63], a[176:179], a[0:3], v[36:39]
  ds_read_b64_tr_b16 a[196:197], v6 offset:49152
  v_mfma_f32_16x16x32_bf16 v[60:63], a[180:183], a[20:23], v[60:63]
  ds_read_b64_tr_b16 a[198:199], v6 offset:53248
  v_mfma_f32_16x16x32_bf16 v[60:63], a[184:187], a[40:43], v[60:63]
  ds_write_b128 v26, a[144:147] offset:36864
  v_mfma_f32_16x16x32_bf16 v[60:63], a[188:191], a[60:63], v[60:63]
  ds_read_b64_tr_b16 a[200:201], v7 offset:49152
  v_mfma_f32_16x16x32_bf16 v[64:67], a[160:163], a[4:7], v[40:43]
  ds_read_b64_tr_b16 a[202:203], v7 offset:53248
  v_mfma_f32_16x16x32_bf16 v[64:67], a[164:167], a[24:27], v[64:67]
  ds_read_b64_tr_b16 a[204:205], v8 offset:49152
  v_mfma_f32_16x16x32_bf16 v[64:67], a[168:171], a[44:47], v[64:67]
  ds_write_b128 v26, a[148:151] offset:40960
  v_mfma_f32_16x16x32_bf16 v[64:67], a[172:175], a[64:67], v[64:67]
  ds_read_b64_tr_b16 a[206:207], v8 offset:53248
  v_mfma_f32_16x16x32_bf16 v[68:71], a[176:179], a[4:7], v[40:43]
  v_exp_f32 v56, v56
  v_mfma_f32_16x16x32_bf16 v[68:71], a[180:183], a[24:27], v[68:71]
  ds_read_b64_tr_b16 a[208:209], v9 offset:49152
  v_mfma_f32_16x16x32_bf16 v[68:71], a[184:187], a[44:47], v[68:71]
  ds_write_b128 v26, a[152:155] offset:45056
  v_mfma_f32_16x16x32_bf16 v[68:71], a[188:191], a[64:67], v[68:71]
  v_exp_f32 v57, v57
  v_mfma_f32_16x16x32_bf16 v[72:75], a[160:163], a[8:11], v[44:47]
  ds_read_b64_tr_b16 a[210:211], v9 offset:53248
  v_cvt_pk_bf16_f32 v56, v56, v57
  v_mfma_f32_16x16x32_bf16 v[72:75], a[164:167], a[28:31], v[72:75]
  v_exp_f32 v58, v58
  v_mfma_f32_16x16x32_bf16 v[72:75], a[168:171], a[48:51], v[72:75]
  v_exp_f32 v59, v59
  v_mfma_f32_16x16x32_bf16 v[72:75], a[172:175], a[68:71], v[72:75]
  ds_read_b64_tr_b16 a[212:213], v10 offset:49152
  v_cvt_pk_bf16_f32 v57, v58, v59
  v_mfma_f32_16x16x32_bf16 v[76:79], a[176:179], a[8:11], v[44:47]
  v_exp_f32 v60, v60
  v_mfma_f32_16x16x32_bf16 v[76:79], a[180:183], a[28:31], v[76:79]
  ds_read_b64_tr_b16 a[214:215], v10 offset:53248
  v_mfma_f32_16x16x32_bf16 v[76:79], a[184:187], a[48:51], v[76:79]
  v_exp_f32 v61, v61
  v_mfma_f32_16x16x32_bf16 v[76:79], a[188:191], a[68:71], v[76:79]
  ds_read_b64_tr_b16 a[216:217], v11 offset:49152
  v_cvt_pk_bf16_f32 v58, v60, v61
  v_mfma_f32_16x16x32_bf16 v[80:83], a[160:163], a[12:15], v[48:51]
  v_exp_f32 v62, v62
  v_mfma_f32_16x16x32_bf16 v[80:83], a[164:167], a[32:35], v[80:83]
  s_add_u32 m0, s31, 32768
  v_exp_f32 v63, v63
  v_mfma_f32_16x16x32_bf16 v[80:83], a[168:171], a[52:55], v[80:83]
  buffer_load_dwordx4 v17, s[12:15], s35 offen lds
  v_mfma_f32_16x16x32_bf16 v[80:83], a[172:175], a[72:75], v[80:83]
  ds_read_b64_tr_b16 a[218:219], v11 offset:53248
  v_cvt_pk_bf16_f32 v59, v62, v63
  v_mfma_f32_16x16x32_bf16 v[84:87], a[176:179], a[12:15], v[48:51]
  v_exp_f32 v64, v64
  v_mfma_f32_16x16x32_bf16 v[84:87], a[180:183], a[32:35], v[84:87]
  ds_read_b64_tr_b16 a[220:221], v12 offset:49152
  v_mfma_f32_16x16x32_bf16 v[84:87], a[184:187], a[52:55], v[84:87]
  v_exp_f32 v65, v65
  v_mfma_f32_16x16x32_bf16 v[84:87], a[188:191], a[72:75], v[84:87]
  ds_read_b64_tr_b16 a[222:223], v12 offset:53248
  v_cvt_pk_bf16_f32 v64, v64, v65
  v_mfma_f32_16x16x32_bf16 v[88:91], a[160:163], a[16:19], v[52:55]
  buffer_load_dwordx4 v18, s[12:15], s35 offen offset:1024 lds
  v_mfma_f32_16x16x32_bf16 v[88:91], a[164:167], a[36:39], v[88:91]
  v_exp_f32 v66, v66
  v_mfma_f32_16x16x32_bf16 v[88:91], a[168:171], a[56:59], v[88:91]
  v_exp_f32 v67, v67
  v_mfma_f32_16x16x32_bf16 v[88:91], a[172:175], a[76:79], v[88:91]
  v_exp_f32 v68, v68
  v_mfma_f32_16x16x32_bf16 v[92:95], a[176:179], a[16:19], v[52:55]
  v_exp_f32 v69, v69
  v_mfma_f32_16x16x32_bf16 v[92:95], a[180:183], a[36:39], v[92:95]
  v_exp_f32 v70, v70
  v_mfma_f32_16x16x32_bf16 v[92:95], a[184:187], a[56:59], v[92:95]
  buffer_load_dwordx4 v19, s[12:15], s35 offen offset:2048 lds
  v_mfma_f32_16x16x32_bf16 v[92:95], a[188:191], a[76:79], v[92:95]
  s_waitcnt lgkmcnt(0)
  v_exp_f32 v71, v71
  v_mfma_f32_16x16x32_bf16 v[96:99], a[192:195], v[56:59], v[96:99]
  v_cvt_pk_bf16_f32 v65, v66, v67
  v_cvt_pk_bf16_f32 v66, v68, v69
  v_mfma_f32_16x16x32_bf16 v[100:103], a[196:199], v[56:59], v[100:103]
  v_cvt_pk_bf16_f32 v67, v70, v71
  v_mfma_f32_16x16x32_bf16 v[136:139], a[200:203], v[56:59], v[136:139]
  v_exp_f32 v72, v72
  v_mfma_f32_16x16x32_bf16 v[140:143], a[204:207], v[56:59], v[140:143]
  v_exp_f32 v73, v73
  v_mfma_f32_16x16x32_bf16 v[176:179], a[208:211], v[56:59], v[176:179]
  buffer_load_dwordx4 v20, s[12:15], s35 offen offset:3072 lds
  v_mfma_f32_16x16x32_bf16 v[180:183], a[212:215], v[56:59], v[180:183]
  v_exp_f32 v74, v74
  v_mfma_f32_16x16x32_bf16 v[216:219], a[216:219], v[56:59], v[216:219]
  v_exp_f32 v75, v75
  v_mfma_f32_16x16x32_bf16 v[220:223], a[220:223], v[56:59], v[220:223]
  v_exp_f32 v76, v76
  v_mfma_f32_16x16x32_bf16 a[224:227], a[244:247], v[56:59], a[224:227]
  v_exp_f32 v77, v77
  v_mfma_f32_16x16x32_bf16 v[104:107], a[192:195], v[64:67], v[104:107]
  v_exp_f32 v78, v78
  v_mfma_f32_16x16x32_bf16 v[108:111], a[196:199], v[64:67], v[108:111]
  v_exp_f32 v79, v79
  v_mfma_f32_16x16x32_bf16 v[144:147], a[200:203], v[64:67], v[144:147]
  v_cvt_pk_bf16_f32 v72, v72, v73
  v_cvt_pk_bf16_f32 v73, v74, v75
  v_mfma_f32_16x16x32_bf16 v[148:151], a[204:207], v[64:67], v[148:151]
  v_cvt_pk_bf16_f32 v74, v76, v77
  v_cvt_pk_bf16_f32 v75, v78, v79
  v_mfma_f32_16x16x32_bf16 v[184:187], a[208:211], v[64:67], v[184:187]
  v_exp_f32 v80, v80
  v_mfma_f32_16x16x32_bf16 v[188:191], a[212:215], v[64:67], v[188:191]
  v_exp_f32 v81, v81
  v_mfma_f32_16x16x32_bf16 v[224:227], a[216:219], v[64:67], v[224:227]
  v_exp_f32 v82, v82
  v_mfma_f32_16x16x32_bf16 v[228:231], a[220:223], v[64:67], v[228:231]
  v_exp_f32 v83, v83
  v_mfma_f32_16x16x32_bf16 a[228:231], a[244:247], v[64:67], a[228:231]
  v_exp_f32 v84, v84
  v_mfma_f32_16x16x32_bf16 v[112:115], a[192:195], v[72:75], v[112:115]
  v_exp_f32 v85, v85
  v_mfma_f32_16x16x32_bf16 v[116:119], a[196:199], v[72:75], v[116:119]
  v_exp_f32 v86, v86
  v_mfma_f32_16x16x32_bf16 v[152:155], a[200:203], v[72:75], v[152:155]
  v_exp_f32 v87, v87
  v_mfma_f32_16x16x32_bf16 v[156:159], a[204:207], v[72:75], v[156:159]
  v_cvt_pk_bf16_f32 v80, v80, v81
  v_cvt_pk_bf16_f32 v81, v82, v83
  v_mfma_f32_16x16x32_bf16 v[192:195], a[208:211], v[72:75], v[192:195]
  v_cvt_pk_bf16_f32 v82, v84, v85
  v_cvt_pk_bf16_f32 v83, v86, v87
  v_mfma_f32_16x16x32_bf16 v[196:199], a[212:215], v[72:75], v[196:199]
  v_exp_f32 v88, v88
  v_mfma_f32_16x16x32_bf16 v[232:235], a[216:219], v[72:75], v[232:235]
  v_exp_f32 v89, v89
  v_mfma_f32_16x16x32_bf16 v[236:239], a[220:223], v[72:75], v[236:239]
  v_exp_f32 v90, v90
  v_mfma_f32_16x16x32_bf16 a[232:235], a[244:247], v[72:75], a[232:235]
  v_exp_f32 v91, v91
  v_mfma_f32_16x16x32_bf16 v[120:123], a[192:195], v[80:83], v[120:123]
  v_exp_f32 v92, v92
  v_mfma_f32_16x16x32_bf16 v[124:127], a[196:199], v[80:83], v[124:127]
  v_exp_f32 v93, v93
  v_mfma_f32_16x16x32_bf16 v[160:163], a[200:203], v[80:83], v[160:163]
  v_exp_f32 v94, v94
  v_mfma_f32_16x16x32_bf16 v[164:167], a[204:207], v[80:83], v[164:167]
  v_exp_f32 v95, v95
  v_mfma_f32_16x16x32_bf16 v[200:203], a[208:211], v[80:83], v[200:203]
  v_cvt_pk_bf16_f32 v88, v88, v89
  v_cvt_pk_bf16_f32 v89, v90, v91
  v_mfma_f32_16x16x32_bf16 v[204:207], a[212:215], v[80:83], v[204:207]
  v_cvt_pk_bf16_f32 v90, v92, v93
  v_cvt_pk_bf16_f32 v91, v94, v95
  v_mfma_f32_16x16x32_bf16 v[240:243], a[216:219], v[80:83], v[240:243]
  v_mfma_f32_16x16x32_bf16 v[244:247], a[220:223], v[80:83], v[244:247]
  v_mfma_f32_16x16x32_bf16 a[236:239], a[244:247], v[80:83], a[236:239]
  v_mfma_f32_16x16x32_bf16 v[128:131], a[192:195], v[88:91], v[128:131]
  v_mfma_f32_16x16x32_bf16 v[132:135], a[196:199], v[88:91], v[132:135]
  v_mfma_f32_16x16x32_bf16 v[168:171], a[200:203], v[88:91], v[168:171]
  v_mfma_f32_16x16x32_bf16 v[172:175], a[204:207], v[88:91], v[172:175]
  ds_write_b128 v26, a[156:159] offset:49152
  v_mfma_f32_16x16x32_bf16 v[208:211], a[208:211], v[88:91], v[208:211]
  s_add_u32 s35, s35, s36
  s_andn2_b32 s35, s35, s70
  v_mfma_f32_16x16x32_bf16 v[212:215], a[212:215], v[88:91], v[212:215]
  v_mfma_f32_16x16x32_bf16 v[248:251], a[216:219], v[88:91], v[248:251]
  v_mfma_f32_16x16x32_bf16 v[252:255], a[220:223], v[88:91], v[252:255]
  s_waitcnt lgkmcnt(0)
  v_mfma_f32_16x16x32_bf16 a[240:243], a[244:247], v[88:91], a[240:243]
L_aend:
  s_nop 7
  v_accvgpr_read_b32 v24, a224
  v_accvgpr_read_b32 v26, a228
  v_accvgpr_read_b32 v28, a232
  v_accvgpr_read_b32 v30, a236
  v_accvgpr_read_b32 v32, a240
  v_add_f32 v27, v24, v26
  v_add_f32 v29, v28, v30
  v_add_f32 v27, v27, v32
  s_mov_b32 s48, 1400897536
  v_add_f32 v27, v27, v29
  s_lshl_b32 s49, s30, 2
  s_add_u32 s49, s49, 163776
  v_cmp_ngt_f32 vcc, s48, v27
  v_mov_b32 v29, s49
  s_nop 0
  v_mov_b32 v25, vcc_lo
  v_or_b32 v25, vcc_hi, v25
  ds_write_b32 v29, v25
  v_rcp_f32 v24, v24
  v_rcp_f32 v26, v26
  v_rcp_f32 v28, v28
  v_rcp_f32 v30, v30
  v_rcp_f32 v32, v32
  v_mov_b32 v29, 163776
  s_waitcnt lgkmcnt(0)
  s_barrier
  ds_read_b128 v[56:59], v29
  s_cmp_eq_u32 s50, 0
  s_cbranch_scc0 L_aepi1
  v_lshrrev_b32 v34, 3, v0
  v_min_u32 v34, 5, v34
  s_and_b32 s48, s30, 1
  s_mul_i32 s48, s48, 0xc000
  s_add_u32 s48, s48, s71
  s_add_u32 s48, s48, 0x8000
  v_lshl_add_u32 v34, v34, 13, s48
  v_and_b32 v34, 0x1ffff, v34
  v_and_b32 v35, 7, v0
  v_lshl_add_u32 v34, v35, 7, v34
  s_mov_b32 s48, 262144
  buffer_load_dword v35, v34, s[8:11], s48 offen
  v_pk_mul_f32 v[96:97], v[96:97], v[24:25] op_sel_hi:[1,0]
  v_pk_mul_f32 v[98:99], v[98:99], v[24:25] op_sel_hi:[1,0]
  v_pk_mul_f32 v[100:101], v[100:101], v[24:25] op_sel_hi:[1,0]
  v_pk_mul_f32 v[102:103], v[102:103], v[24:25] op_sel_hi:[1,0]
  v_cvt_pk_bf16_f32 v96, v96, v97
  v_cvt_pk_bf16_f32 v97, v98, v99
  v_cvt_pk_bf16_f32 v98, v100, v101
  v_cvt_pk_bf16_f32 v99, v102, v103
  v_pk_mul_f32 v[104:105], v[104:105], v[26:27] op_sel_hi:[1,0]
  v_pk_mul_f32 v[106:107], v[106:107], v[26:27] op_sel_hi:[1,0]
  v_pk_mul_f32 v[108:109], v[108:109], v[26:27] op_sel_hi:[1,0]
  v_pk_mul_f32 v[110:111], v[110:111], v[26:27] op_sel_hi:[1,0]
  v_cvt_pk_bf16_f32 v104, v104, v105
  v_cvt_pk_bf16_f32 v105, v106, v107
  v_cvt_pk_bf16_f32 v106, v108, v109
  v_cvt_pk_bf16_f32 v107, v110, v111
  v_pk_mul_f32 v[112:113], v[112:113], v[28:29] op_sel_hi:[1,0]
  v_pk_mul_f32 v[114:115], v[114:115], v[28:29] op_sel_hi:[1,0]
  v_pk_mul_f32 v[116:117], v[116:117], v[28:29] op_sel_hi:[1,0]
  v_pk_mul_f32 v[118:119], v[118:119], v[28:29] op_sel_hi:[1,0]
  v_cvt_pk_bf16_f32 v112, v112, v113
  v_cvt_pk_bf16_f32 v113, v114, v115
  v_cvt_pk_bf16_f32 v114, v116, v117
  v_cvt_pk_bf16_f32 v115, v118, v119
  v_pk_mul_f32 v[120:121], v[120:121], v[30:31] op_sel_hi:[1,0]
  v_pk_mul_f32 v[122:123], v[122:123], v[30:31] op_sel_hi:[1,0]
  v_pk_mul_f32 v[124:125], v[124:125], v[30:31] op_sel_hi:[1,0]
  v_pk_mul_f32 v[126:127], v[126:127], v[30:31] op_sel_hi:[1,0]
  v_cvt_pk_bf16_f32 v120, v120, v121
  v_cvt_pk_bf16_f32 v121, v122, v123
  v_cvt_pk_bf16_f32 v122, v124, v125
  v_cvt_pk_bf16_f32 v123, v126, v127
  s_waitcnt lgkmcnt(0)
  v_or3_b32 v56, v56, v57, v58
  v_or_b32 v56, v56, v59
  s_nop 0
  v_readfirstlane_b32 s48, v56
  s_nop 3
  s_andn2_b32 s48, s48, s3
  s_cbranch_scc1 L_redo
  s_mov_b32 s3, 0
  v_pk_mul_f32 v[128:129], v[128:129], v[32:33] op_sel_hi:[1,0]
  v_pk_mul_f32 v[130:131], v[130:131], v[32:33] op_sel_hi:[1,0]
  v_pk_mul_f32 v[132:133], v[132:133], v[32:33] op_sel_hi:[1,0]
  v_pk_mul_f32 v[134:135], v[134:135], v[32:33] op_sel_hi:[1,0]
  v_cvt_pk_bf16_f32 v128, v128, v129
  v_cvt_pk_bf16_f32 v129, v130, v131
  v_cvt_pk_bf16_f32 v130, v132, v133
  v_cvt_pk_bf16_f32 v131, v134, v135
  v_pk_mul_f32 v[136:137], v[136:137], v[24:25] op_sel_hi:[1,0]
  v_pk_mul_f32 v[138:139], v[138:139], v[24:25] op_sel_hi:[1,0]
  v_pk_mul_f32 v[140:141], v[140:141], v[24:25] op_sel_hi:[1,0]
  v_pk_mul_f32 v[142:143], v[142:143], v[24:25] op_sel_hi:[1,0]
  v_cvt_pk_bf16_f32 v136, v136, v137
  v_cvt_pk_bf16_f32 v137, v138, v139
  v_cvt_pk_bf16_f32 v138, v140, v141
  v_cvt_pk_bf16_f32 v139, v142, v143
  v_pk_mul_f32 v[144:145], v[144:145], v[26:27] op_sel_hi:[1,0]
  v_pk_mul_f32 v[146:147], v[146:147], v[26:27] op_sel_hi:[1,0]
  v_pk_mul_f32 v[148:149], v[148:149], v[26:27] op_sel_hi:[1,0]
  v_pk_mul_f32 v[150:151], v[150:151], v[26:27] op_sel_hi:[1,0]
  v_cvt_pk_bf16_f32 v144, v144, v145
  v_cvt_pk_bf16_f32 v145, v146, v147
  v_cvt_pk_bf16_f32 v146, v148, v149
  v_cvt_pk_bf16_f32 v147, v150, v151
  v_pk_mul_f32 v[152:153], v[152:153], v[28:29] op_sel_hi:[1,0]
  v_pk_mul_f32 v[154:155], v[154:155], v[28:29] op_sel_hi:[1,0]
  v_pk_mul_f32 v[156:157], v[156:157], v[28:29] op_sel_hi:[1,0]
  v_pk_mul_f32 v[158:159], v[158:159], v[28:29] op_sel_hi:[1,0]
  v_cvt_pk_bf16_f32 v152, v152, v153
  v_cvt_pk_bf16_f32 v153, v154, v155
  v_cvt_pk_bf16_f32 v154, v156, v157
  v_cvt_pk_bf16_f32 v155, v158, v159
  v_pk_mul_f32 v[160:161], v[160:161], v[30:31] op_sel_hi:[1,0]
  v_pk_mul_f32 v[162:163], v[162:163], v[30:31] op_sel_hi:[1,0]
  v_pk_mul_f32 v[164:165], v[164:165], v[30:31] op_sel_hi:[1,0]
  v_pk_mul_f32 v[166:167], v[166:167], v[30:31] op_sel_hi:[1,0]
  v_cvt_pk_bf16_f32 v160, v160, v161
  v_cvt_pk_bf16_f32 v161, v162, v163
  v_cvt_pk_bf16_f32 v162, v164, v165
  v_cvt_pk_bf16_f32 v163, v166, v167
  v_pk_mul_f32 v[168:169], v[168:169], v[32:33] op_sel_hi:[1,0]
  v_pk_mul_f32 v[170:171], v[170:171], v[32:33] op_sel_hi:[1,0]
  v_pk_mul_f32 v[172:173], v[172:173], v[32:33] op_sel_hi:[1,0]
  v_pk_mul_f32 v[174:175], v[174:175], v[32:33] op_sel_hi:[1,0]
  v_cvt_pk_bf16_f32 v168, v168, v169
  v_cvt_pk_bf16_f32 v169, v170, v171
  v_cvt_pk_bf16_f32 v170, v172, v173
  v_cvt_pk_bf16_f32 v171, v174, v175
  v_pk_mul_f32 v[176:177], v[176:177], v[24:25] op_sel_hi:[1,0]
  v_pk_mul_f32 v[178:179], v[178:179], v[24:25] op_sel_hi:[1,0]
  v_pk_mul_f32 v[180:181], v[180:181], v[24:25] op_sel_hi:[1,0]
  v_pk_mul_f32 v[182:183], v[182:183], v[24:25] op_sel_hi:[1,0]
  v_cvt_pk_bf16_f32 v176, v176, v177
  v_cvt_pk_bf16_f32 v177, v178, v179
  v_cvt_pk_bf16_f32 v178, v180, v181
  v_cvt_pk_bf16_f32 v179, v182, v183
  v_pk_mul_f32 v[184:185], v[184:185], v[26:27] op_sel_hi:[1,0]
  v_pk_mul_f32 v[186:187], v[186:187], v[26:27] op_sel_hi:[1,0]
  v_pk_mul_f32 v[188:189], v[188:189], v[26:27] op_sel_hi:[1,0]
  v_pk_mul_f32 v[190:191], v[190:191], v[26:27] op_sel_hi:[1,0]
  v_cvt_pk_bf16_f32 v184, v184, v185
  v_cvt_pk_bf16_f32 v185, v186, v187
  v_cvt_pk_bf16_f32 v186, v188, v189
  v_cvt_pk_bf16_f32 v187, v190, v191
  v_pk_mul_f32 v[192:193], v[192:193], v[28:29] op_sel_hi:[1,0]
  v_pk_mul_f32 v[194:195], v[194:195], v[28:29] op_sel_hi:[1,0]
  v_pk_mul_f32 v[196:197], v[196:197], v[28:29] op_sel_hi:[1,0]
  v_pk_mul_f32 v[198:199], v[198:199], v[28:29] op_sel_hi:[1,0]
  v_cvt_pk_bf16_f32 v192, v192, v193
  v_cvt_pk_bf16_f32 v193, v194, v195
  v_cvt_pk_bf16_f32 v194, v196, v197
  v_cvt_pk_bf16_f32 v195, v198, v199
  v_pk_mul_f32 v[200:201], v[200:201], v[30:31] op_sel_hi:[1,0]
  v_pk_mul_f32 v[202:203], v[202:203], v[30:31] op_sel_hi:[1,0]
  v_pk_mul_f32 v[204:205], v[204:205], v[30:31] op_sel_hi:[1,0]
  v_pk_mul_f32 v[206:207], v[206:207], v[30:31] op_sel_hi:[1,0]
  v_cvt_pk_bf16_f32 v200, v200, v201
  v_cvt_pk_bf16_f32 v201, v202, v203
  v_cvt_pk_bf16_f32 v202, v204, v205
  v_cvt_pk_bf16_f32 v203, v206, v207
  v_pk_mul_f32 v[208:209], v[208:209], v[32:33] op_sel_hi:[1,0]
  v_pk_mul_f32 v[210:211], v[210:211], v[32:33] op_sel_hi:[1,0]
  v_pk_mul_f32 v[212:213], v[212:213], v[32:33] op_sel_hi:[1,0]
  v_pk_mul_f32 v[214:215], v[214:215], v[32:33] op_sel_hi:[1,0]
  v_cvt_pk_bf16_f32 v208, v208, v209
  v_cvt_pk_bf16_f32 v209, v210, v211
  v_cvt_pk_bf16_f32 v210, v212, v213
  v_cvt_pk_bf16_f32 v211, v214, v215
  v_pk_mul_f32 v[216:217], v[216:217], v[24:25] op_sel_hi:[1,0]
  v_pk_mul_f32 v[218:219], v[218:219], v[24:25] op_sel_hi:[1,0]
  v_pk_mul_f32 v[220:221], v[220:221], v[24:25] op_sel_hi:[1,0]
  v_pk_mul_f32 v[222:223], v[222:223], v[24:25] op_sel_hi:[1,0]
  v_cvt_pk_bf16_f32 v216, v216, v217
  v_cvt_pk_bf16_f32 v217, v218, v219
  v_cvt_pk_bf16_f32 v218, v220, v221
  v_cvt_pk_bf16_f32 v219, v222, v223
  v_pk_mul_f32 v[224:225], v[224:225], v[26:27] op_sel_hi:[1,0]
  v_pk_mul_f32 v[226:227], v[226:227], v[26:27] op_sel_hi:[1,0]
  v_pk_mul_f32 v[228:229], v[228:229], v[26:27] op_sel_hi:[1,0]
  v_pk_mul_f32 v[230:231], v[230:231], v[26:27] op_sel_hi:[1,0]
  v_cvt_pk_bf16_f32 v224, v224, v225
  v_cvt_pk_bf16_f32 v225, v226, v227
  v_cvt_pk_bf16_f32 v226, v228, v229
  v_cvt_pk_bf16_f32 v227, v230, v231
  v_pk_mul_f32 v[232:233], v[232:233], v[28:29] op_sel_hi:[1,0]
  v_pk_mul_f32 v[234:235], v[234:235], v[28:29] op_sel_hi:[1,0]
  v_pk_mul_f32 v[236:237], v[236:237], v[28:29] op_sel_hi:[1,0]
  v_pk_mul_f32 v[238:239], v[238:239], v[28:29] op_sel_hi:[1,0]
  v_cvt_pk_bf16_f32 v232, v232, v233
  v_cvt_pk_bf16_f32 v233, v234, v235
  v_cvt_pk_bf16_f32 v234, v236, v237
  v_cvt_pk_bf16_f32 v235, v238, v239
  v_pk_mul_f32 v[240:241], v[240:241], v[30:31] op_sel_hi:[1,0]
  v_pk_mul_f32 v[242:243], v[242:243], v[30:31] op_sel_hi:[1,0]
  v_pk_mul_f32 v[244:245], v[244:245], v[30:31] op_sel_hi:[1,0]
  v_pk_mul_f32 v[246:247], v[246:247], v[30:31] op_sel_hi:[1,0]
  v_cvt_pk_bf16_f32 v240, v240, v241
  v_cvt_pk_bf16_f32 v241, v242, v243
  v_cvt_pk_bf16_f32 v242, v244, v245
  v_cvt_pk_bf16_f32 v243, v246, v247
  v_pk_mul_f32 v[248:249], v[248:249], v[32:33] op_sel_hi:[1,0]
  v_pk_mul_f32 v[250:251], v[250:251], v[32:33] op_sel_hi:[1,0]
  v_pk_mul_f32 v[252:253], v[252:253], v[32:33] op_sel_hi:[1,0]
  v_pk_mul_f32 v[254:255], v[254:255], v[32:33] op_sel_hi:[1,0]
  v_cvt_pk_bf16_f32 v248, v248, v249
  v_cvt_pk_bf16_f32 v249, v250, v251
  v_cvt_pk_bf16_f32 v250, v252, v253
  v_cvt_pk_bf16_f32 v251, v254, v255
  v_accvgpr_mov_b32 a0, a80
  v_accvgpr_mov_b32 a1, a81
  v_accvgpr_mov_b32 a2, a82
  v_accvgpr_mov_b32 a3, a83
  v_accvgpr_write_b32 a80, v96
  v_accvgpr_write_b32 a81, v97
  v_accvgpr_write_b32 a82, v98
  v_accvgpr_write_b32 a83, v99
  v_accvgpr_mov_b32 a4, a84
  v_accvgpr_mov_b32 a5, a85
  v_accvgpr_mov_b32 a6, a86
  v_accvgpr_mov_b32 a7, a87
  v_accvgpr_write_b32 a84, v104
  v_accvgpr_write_b32 a85, v105
  v_accvgpr_write_b32 a86, v106
  v_accvgpr_write_b32 a87, v107
  v_accvgpr_mov_b32 a8, a88
  v_accvgpr_mov_b32 a9, a89
  v_accvgpr_mov_b32 a10, a90
  v_accvgpr_mov_b32 a11, a91
  v_accvgpr_write_b32 a88, v112
  v_accvgpr_write_b32 a89, v113
  v_accvgpr_write_b32 a90, v114
  v_accvgpr_write_b32 a91, v115
  v_accvgpr_mov_b32 a12, a92
  v_accvgpr_mov_b32 a13, a93
  v_accvgpr_mov_b32 a14, a94
  v_accvgpr_mov_b32 a15, a95
  v_accvgpr_write_b32 a92, v120
  v_accvgpr_write_b32 a93, v121
  v_accvgpr_write_b32 a94, v122
  v_accvgpr_write_b32 a95, v123
  v_accvgpr_mov_b32 a16, a96
  v_accvgpr_mov_b32 a17, a97
  v_accvgpr_mov_b32 a18, a98
  v_accvgpr_mov_b32 a19, a99
  v_accvgpr_write_b32 a96, v128
  v_accvgpr_write_b32 a97, v129
  v_accvgpr_write_b32 a98, v130
  v_accvgpr_write_b32 a99, v131
  v_accvgpr_mov_b32 a20, a100
  v_accvgpr_mov_b32 a21, a101
  v_accvgpr_mov_b32 a22, a102
  v_accvgpr_mov_b32 a23, a103
  v_accvgpr_write_b32 a100, v136
  v_accvgpr_write_b32 a101, v137
  v_accvgpr_write_b32 a102, v138
  v_accvgpr_write_b32 a103, v139
  v_accvgpr_mov_b32 a24, a104
  v_accvgpr_mov_b32 a25, a105
  v_accvgpr_mov_b32 a26, a106
  v_accvgpr_mov_b32 a27, a107
  v_accvgpr_write_b32 a104, v144
  v_accvgpr_write_b32 a105, v145
  v_accvgpr_write_b32 a106, v146
  v_accvgpr_write_b32 a107, v147
  v_accvgpr_mov_b32 a28, a108
  v_accvgpr_mov_b32 a29, a109
  v_accvgpr_mov_b32 a30, a110
  v_accvgpr_mov_b32 a31, a111
  v_accvgpr_write_b32 a108, v152
  v_accvgpr_write_b32 a109, v153
  v_accvgpr_write_b32 a110, v154
  v_accvgpr_write_b32 a111, v155
  v_accvgpr_mov_b32 a32, a112
  v_accvgpr_mov_b32 a33, a113
  v_accvgpr_mov_b32 a34, a114
  v_accvgpr_mov_b32 a35, a115
  v_accvgpr_write_b32 a112, v160
  v_accvgpr_write_b32 a113, v161
  v_accvgpr_write_b32 a114, v162
  v_accvgpr_write_b32 a115, v163
  v_accvgpr_mov_b32 a36, a116
  v_accvgpr_mov_b32 a37, a117
  v_accvgpr_mov_b32 a38, a118
  v_accvgpr_mov_b32 a39, a119
  v_accvgpr_write_b32 a116, v168
  v_accvgpr_write_b32 a117, v169
  v_accvgpr_write_b32 a118, v170
  v_accvgpr_write_b32 a119, v171
  v_accvgpr_mov_b32 a40, a120
  v_accvgpr_mov_b32 a41, a121
  v_accvgpr_mov_b32 a42, a122
  v_accvgpr_mov_b32 a43, a123
  v_accvgpr_write_b32 a120, v176
  v_accvgpr_write_b32 a121, v177
  v_accvgpr_write_b32 a122, v178
  v_accvgpr_write_b32 a123, v179
  v_accvgpr_mov_b32 a44, a124
  v_accvgpr_mov_b32 a45, a125
  v_accvgpr_mov_b32 a46, a126
  v_accvgpr_mov_b32 a47, a127
  v_accvgpr_write_b32 a124, v184
  v_accvgpr_write_b32 a125, v185
  v_accvgpr_write_b32 a126, v186
  v_accvgpr_write_b32 a127, v187
  v_accvgpr_mov_b32 a48, a128
  v_accvgpr_mov_b32 a49, a129
  v_accvgpr_mov_b32 a50, a130
  v_accvgpr_mov_b32 a51, a131
  v_accvgpr_write_b32 a128, v192
  v_accvgpr_write_b32 a129, v193
  v_accvgpr_write_b32 a130, v194
  v_accvgpr_write_b32 a131, v195
  v_accvgpr_mov_b32 a52, a132
  v_accvgpr_mov_b32 a53, a133
  v_accvgpr_mov_b32 a54, a134
  v_accvgpr_mov_b32 a55, a135
  v_accvgpr_write_b32 a132, v200
  v_accvgpr_write_b32 a133, v201
  v_accvgpr_write_b32 a134, v202
  v_accvgpr_write_b32 a135, v203
  v_accvgpr_mov_b32 a56, a136
  v_accvgpr_mov_b32 a57, a137
  v_accvgpr_mov_b32 a58, a138
  v_accvgpr_mov_b32 a59, a139
  v_accvgpr_write_b32 a136, v208
  v_accvgpr_write_b32 a137, v209
  v_accvgpr_write_b32 a138, v210
  v_accvgpr_write_b32 a139, v211
  v_accvgpr_mov_b32 a60, a140
  v_accvgpr_mov_b32 a61, a141
  v_accvgpr_mov_b32 a62, a142
  v_accvgpr_mov_b32 a63, a143
  v_accvgpr_write_b32 a140, v216
  v_accvgpr_write_b32 a141, v217
  v_accvgpr_write_b32 a142, v218
  v_accvgpr_write_b32 a143, v219
  v_accvgpr_mov_b32 a64, a144
  v_accvgpr_mov_b32 a65, a145
  v_accvgpr_mov_b32 a66, a146
  v_accvgpr_mov_b32 a67, a147
  v_accvgpr_write_b32 a144, v224
  v_accvgpr_write_b32 a145, v225
  v_accvgpr_write_b32 a146, v226
  v_accvgpr_write_b32 a147, v227
  v_accvgpr_mov_b32 a68, a148
  v_accvgpr_mov_b32 a69, a149
  v_accvgpr_mov_b32 a70, a150
  v_accvgpr_mov_b32 a71, a151
  v_accvgpr_write_b32 a148, v232
  v_accvgpr_write_b32 a149, v233
  v_accvgpr_write_b32 a150, v234
  v_accvgpr_write_b32 a151, v235
  v_accvgpr_mov_b32 a72, a152
  v_accvgpr_mov_b32 a73, a153
  v_accvgpr_mov_b32 a74, a154
  v_accvgpr_mov_b32 a75, a155
  v_accvgpr_write_b32 a152, v240
  v_accvgpr_write_b32 a153, v241
  v_accvgpr_write_b32 a154, v242
  v_accvgpr_write_b32 a155, v243
  v_accvgpr_mov_b32 a76, a156
  v_accvgpr_mov_b32 a77, a157
  v_accvgpr_mov_b32 a78, a158
  v_accvgpr_mov_b32 a79, a159
  v_accvgpr_write_b32 a156, v248
  v_accvgpr_write_b32 a157, v249
  v_accvgpr_write_b32 a158, v250
  v_accvgpr_write_b32 a159, v251
  s_mov_b32 s50, 1
  s_branch L_apre
L_aepi1:
  s_add_u32 m0, s31, 49152
  s_nop 0
  buffer_load_dwordx4 v17, s[12:15], s35 offen lds
  buffer_load_dwordx4 v18, s[12:15], s35 offen offset:1024 lds
  buffer_load_dwordx4 v19, s[12:15], s35 offen offset:2048 lds
  buffer_load_dwordx4 v20, s[12:15], s35 offen offset:3072 lds
  v_mov_b32 v46, v24
  v_mov_b32 v48, v26
  v_mov_b32 v50, v28
  v_mov_b32 v52, v30
  v_mov_b32 v54, v32
  v_readfirstlane_b32 s38, v34
  v_lshrrev_b32 v36, 4, v0
  v_bfe_u32 v37, v0, 2, 2
  v_and_b32 v38, 3, v0
  v_lshl_add_u32 v40, v36, 2, v37
  v_bfe_u32 v39, v40, 1, 2
  v_lshlrev_b32 v40, 7, v40
  v_lshl_add_u32 v40, v38, 3, v40
  s_and_b32 s48, s30, 2
  v_xor_b32 v39, s48, v39
  v_lshl_add_u32 v40, v39, 5, v40
  s_lshl_b32 s48, s48, 13
  s_sub_u32 s49, 16384, s48
  v_add_u32 v24, s48, v40
  v_add_u32 v26, s49, v40
  v_xor_b32 v25, 32, v24
  v_xor_b32 v27, 32, v26
  s_waitcnt lgkmcnt(0)
  v_or3_b32 v56, v56, v57, v58
  v_or_b32 v56, v56, v59
  s_nop 0
  v_readfirstlane_b32 s48, v56
  s_nop 3
  s_andn2_b32 s48, s48, s3
  s_cbranch_scc1 L_redo
  s_mov_b32 s3, 0
  s_xor_b32 s48, s30, 2
  s_lshl_b32 s48, s48, 10
  s_add_u32 s48, s48, 65792
  v_lshl_add_u32 v3, v0, 4, s48
  v_add_u32 v4, 0x10000, v3
  s_xor_b32 s48, s30, 0
  s_lshl_b32 s48, s48, 10
  s_add_u32 s48, s48, 65792
  v_lshl_add_u32 v1, v0, 4, s48
  v_add_u32 v2, 0x10000, v1
  s_cmp_eq_u32 s38, 0
  s_cbranch_scc1 L_nspin
L_ngot:
  ds_read_b128 a[160:163], v4 offset:0
  ds_read_b128 a[164:167], v4 offset:4096
  ds_read_b128 a[168:171], v4 offset:8192
  ds_read_b128 a[172:175], v4 offset:12288
  v_pk_mul_f32 v[96:97], v[96:97], v[46:47] op_sel_hi:[1,0]
  v_pk_mul_f32 v[98:99], v[98:99], v[46:47] op_sel_hi:[1,0]
  v_pk_mul_f32 v[100:101], v[100:101], v[46:47] op_sel_hi:[1,0]
  v_pk_mul_f32 v[102:103], v[102:103], v[46:47] op_sel_hi:[1,0]
  v_cvt_pk_bf16_f32 v96, v96, v97
  v_cvt_pk_bf16_f32 v97, v98, v99
  v_cvt_pk_bf16_f32 v98, v100, v101
  v_cvt_pk_bf16_f32 v99, v102, v103
  ds_read_b128 a[176:179], v4 offset:16384
  ds_read_b128 a[180:183], v4 offset:20480
  ds_read_b128 a[184:187], v4 offset:24576
  ds_read_b128 a[188:191], v3 offset:0
  v_pk_mul_f32 v[104:105], v[104:105], v[48:49] op_sel_hi:[1,0]
  v_pk_mul_f32 v[106:107], v[106:107], v[48:49] op_sel_hi:[1,0]
  v_pk_mul_f32 v[108:109], v[108:109], v[48:49] op_sel_hi:[1,0]
  v_pk_mul_f32 v[110:111], v[110:111], v[48:49] op_sel_hi:[1,0]
  v_cvt_pk_bf16_f32 v104, v104, v105
  v_cvt_pk_bf16_f32 v105, v106, v107
  v_cvt_pk_bf16_f32 v106, v108, v109
  v_cvt_pk_bf16_f32 v107, v110, v111
  ds_read_b128 a[192:195], v3 offset:4096
  ds_read_b128 a[196:199], v3 offset:8192
  ds_read_b128 a[200:203], v3 offset:12288
  ds_read_b128 a[204:207], v3 offset:16384
  v_pk_mul_f32 v[112:113], v[112:113], v[50:51] op_sel_hi:[1,0]
  v_pk_mul_f32 v[114:115], v[114:115], v[50:51] op_sel_hi:[1,0]
  v_pk_mul_f32 v[116:117], v[116:117], v[50:51] op_sel_hi:[1,0]
  v_pk_mul_f32 v[118:119], v[118:119], v[50:51] op_sel_hi:[1,0]
  v_cvt_pk_bf16_f32 v112, v112, v113
  v_cvt_pk_bf16_f32 v113, v114, v115
  v_cvt_pk_bf16_f32 v114, v116, v117
  v_cvt_pk_bf16_f32 v115, v118, v119
  ds_read_b128 a[208:211], v3 offset:20480
  ds_read_b128 a[212:215], v3 offset:24576
  ds_read_b128 a[216:219], v3 offset:28672
  ds_read_b128 a[220:223], v3 offset:32768
  v_pk_mul_f32 v[120:121], v[120:121], v[52:53] op_sel_hi:[1,0]
  v_pk_mul_f32 v[122:123], v[122:123], v[52:53] op_sel_hi:[1,0]
  v_pk_mul_f32 v[124:125], v[124:125], v[52:53] op_sel_hi:[1,0]
  v_pk_mul_f32 v[126:127], v[126:127], v[52:53] op_sel_hi:[1,0]
  v_cvt_pk_bf16_f32 v120, v120, v121
  v_cvt_pk_bf16_f32 v121, v122, v123
  v_cvt_pk_bf16_f32 v122, v124, v125
  v_cvt_pk_bf16_f32 v123, v126, v127
  ds_read_b128 a[224:227], v3 offset:36864
  ds_read_b128 a[228:231], v3 offset:40960
  ds_read_b128 a[232:235], v3 offset:45056
  ds_read_b128 a[236:239], v3 offset:49152
  v_pk_mul_f32 v[128:129], v[128:129], v[54:55] op_sel_hi:[1,0]
  v_pk_mul_f32 v[130:131], v[130:131], v[54:55] op_sel_hi:[1,0]
  v_pk_mul_f32 v[132:133], v[132:133], v[54:55] op_sel_hi:[1,0]
  v_pk_mul_f32 v[134:135], v[134:135], v[54:55] op_sel_hi:[1,0]
  v_cvt_pk_bf16_f32 v128, v128, v129
  v_cvt_pk_bf16_f32 v129, v130, v131
  v_cvt_pk_bf16_f32 v130, v132, v133
  v_cvt_pk_bf16_f32 v131, v134, v135
  ds_read_b64_tr_b16 v[56:57], v24 offset:0
  ds_read_b64_tr_b16 v[58:59], v24 offset:2048
  ds_read_b64_tr_b16 v[72:73], v25 offset:0
  ds_read_b64_tr_b16 v[74:75], v25 offset:2048
  v_pk_mul_f32 v[136:137], v[136:137], v[46:47] op_sel_hi:[1,0]
  v_pk_mul_f32 v[138:139], v[138:139], v[46:47] op_sel_hi:[1,0]
  v_pk_mul_f32 v[140:141], v[140:141], v[46:47] op_sel_hi:[1,0]
  v_pk_mul_f32 v[142:143], v[142:143], v[46:47] op_sel_hi:[1,0]
  v_cvt_pk_bf16_f32 v136, v136, v137
  v_cvt_pk_bf16_f32 v137, v138, v139
  v_cvt_pk_bf16_f32 v138, v140, v141
  v_cvt_pk_bf16_f32 v139, v142, v143
  ds_read_b64_tr_b16 v[60:61], v24 offset:4096
  ds_read_b64_tr_b16 v[62:63], v24 offset:6144
  ds_read_b64_tr_b16 v[76:77], v25 offset:4096
  ds_read_b64_tr_b16 v[78:79], v25 offset:6144
  v_pk_mul_f32 v[144:145], v[144:145], v[48:49] op_sel_hi:[1,0]
  v_pk_mul_f32 v[146:147], v[146:147], v[48:49] op_sel_hi:[1,0]
  v_pk_mul_f32 v[148:149], v[148:149], v[48:49] op_sel_hi:[1,0]
  v_pk_mul_f32 v[150:151], v[150:151], v[48:49] op_sel_hi:[1,0]
  v_cvt_pk_bf16_f32 v144, v144, v145
  v_cvt_pk_bf16_f32 v145, v146, v147
  v_cvt_pk_bf16_f32 v146, v148, v149
  v_cvt_pk_bf16_f32 v147, v150, v151
  ds_read_b64_tr_b16 v[64:65], v24 offset:8192
  ds_read_b64_tr_b16 v[66:67], v24 offset:10240
  ds_read_b64_tr_b16 v[80:81], v25 offset:8192
  ds_read_b64_tr_b16 v[82:83], v25 offset:10240
  v_pk_mul_f32 v[152:153], v[152:153], v[50:51] op_sel_hi:[1,0]
  v_pk_mul_f32 v[154:155], v[154:155], v[50:51] op_sel_hi:[1,0]
  v_pk_mul_f32 v[156:157], v[156:157], v[50:51] op_sel_hi:[1,0]
  v_pk_mul_f32 v[158:159], v[158:159], v[50:51] op_sel_hi:[1,0]
  v_cvt_pk_bf16_f32 v152, v152, v153
  v_cvt_pk_bf16_f32 v153, v154, v155
  v_cvt_pk_bf16_f32 v154, v156, v157
  v_cvt_pk_bf16_f32 v155, v158, v159
  ds_read_b64_tr_b16 v[68:69], v24 offset:12288
  ds_read_b64_tr_b16 v[70:71], v24 offset:14336
  ds_read_b64_tr_b16 v[84:85], v25 offset:12288
  ds_read_b64_tr_b16 v[86:87], v25 offset:14336
  v_pk_mul_f32 v[160:161], v[160:161], v[52:53] op_sel_hi:[1,0]
  v_pk_mul_f32 v[162:163], v[162:163], v[52:53] op_sel_hi:[1,0]
  v_pk_mul_f32 v[164:165], v[164:165], v[52:53] op_sel_hi:[1,0]
  v_pk_mul_f32 v[166:167], v[166:167], v[52:53] op_sel_hi:[1,0]
  v_cvt_pk_bf16_f32 v160, v160, v161
  v_cvt_pk_bf16_f32 v161, v162, v163
  v_cvt_pk_bf16_f32 v162, v164, v165
  v_cvt_pk_bf16_f32 v163, v166, v167
  v_pk_mul_f32 v[168:169], v[168:169], v[54:55] op_sel_hi:[1,0]
  v_pk_mul_f32 v[170:171], v[170:171], v[54:55] op_sel_hi:[1,0]
  v_pk_mul_f32 v[172:173], v[172:173], v[54:55] op_sel_hi:[1,0]
  v_pk_mul_f32 v[174:175], v[174:175], v[54:55] op_sel_hi:[1,0]
  v_cvt_pk_bf16_f32 v168, v168, v169
  v_cvt_pk_bf16_f32 v169, v170, v171
  v_cvt_pk_bf16_f32 v170, v172, v173
  v_cvt_pk_bf16_f32 v171, v174, v175
  s_waitcnt lgkmcnt(0)
  s_barrier
  v_mfma_f32_16x16x32_bf16 v[100:103], v[56:59], a[80:83], 0
  ds_read_b64_tr_b16 v[88:89], v27 offset:0
  v_mul_f32 v176, v176, v46
  v_mfma_f32_16x16x32_bf16 v[100:103], v[60:63], a[100:103], v[100:103]
  ds_write_b128 v2, v[96:99] offset:0
  v_mfma_f32_16x16x32_bf16 v[100:103], v[64:67], a[120:123], v[100:103]
  ds_read_b64_tr_b16 v[90:91], v27 offset:2048
  v_mul_f32 v177, v177, v46
  v_mfma_f32_16x16x32_bf16 v[100:103], v[68:71], a[140:143], v[100:103]
  ds_read_b64_tr_b16 v[92:93], v27 offset:4096
  v_mul_f32 v178, v178, v46
  v_mfma_f32_16x16x32_bf16 v[116:119], v[56:59], a[84:87], 0
  ds_read_b64_tr_b16 v[94:95], v27 offset:6144
  v_mul_f32 v179, v179, v46
  v_mfma_f32_16x16x32_bf16 v[116:119], v[60:63], a[104:107], v[116:119]
  ds_write_b128 v2, v[104:107] offset:4096
  v_mfma_f32_16x16x32_bf16 v[116:119], v[64:67], a[124:127], v[116:119]
  ds_read_b64_tr_b16 v[6:7], v27 offset:8192
  v_mul_f32 v180, v180, v46
  v_mfma_f32_16x16x32_bf16 v[116:119], v[68:71], a[144:147], v[116:119]
  ds_read_b64_tr_b16 v[8:9], v27 offset:10240
  v_mul_f32 v181, v181, v46
  v_mfma_f32_16x16x32_bf16 v[132:135], v[56:59], a[88:91], 0
  ds_read_b64_tr_b16 v[10:11], v27 offset:12288
  v_mul_f32 v182, v182, v46
  v_mfma_f32_16x16x32_bf16 v[132:135], v[60:63], a[108:111], v[132:135]
  ds_write_b128 v2, v[112:115] offset:8192
  v_mfma_f32_16x16x32_bf16 v[132:135], v[64:67], a[128:131], v[132:135]
  ds_read_b64_tr_b16 v[12:13], v27 offset:14336
  v_mul_f32 v183, v183, v46
  v_mfma_f32_16x16x32_bf16 v[132:135], v[68:71], a[148:151], v[132:135]
  v_cvt_pk_bf16_f32 v176, v176, v177
  v_cvt_pk_bf16_f32 v177, v178, v179
  v_mfma_f32_16x16x32_bf16 v[148:151], v[56:59], a[92:95], 0
  v_cvt_pk_bf16_f32 v178, v180, v181
  v_cvt_pk_bf16_f32 v179, v182, v183
  v_mfma_f32_16x16x32_bf16 v[148:151], v[60:63], a[112:115], v[148:151]
  ds_write_b128 v2, v[120:123] offset:12288
  v_mfma_f32_16x16x32_bf16 v[148:151], v[64:67], a[132:135], v[148:151]
  v_mul_f32 v184, v184, v48
  v_mul_f32 v185, v185, v48
  v_mfma_f32_16x16x32_bf16 v[148:151], v[68:71], a[152:155], v[148:151]
  v_mul_f32 v186, v186, v48
  v_mul_f32 v187, v187, v48
  v_mfma_f32_16x16x32_bf16 v[164:167], v[56:59], a[96:99], 0
  v_mul_f32 v188, v188, v48
  v_mul_f32 v189, v189, v48
  v_mfma_f32_16x16x32_bf16 v[164:167], v[60:63], a[116:119], v[164:167]
  ds_write_b128 v2, v[128:131] offset:16384
  v_mfma_f32_16x16x32_bf16 v[164:167], v[64:67], a[136:139], v[164:167]
  ds_read_b64_tr_b16 v[56:57], v26 offset:0
  v_mul_f32 v190, v190, v48
  v_mfma_f32_16x16x32_bf16 v[164:167], v[68:71], a[156:159], v[164:167]
  ds_read_b64_tr_b16 v[58:59], v26 offset:2048
  v_mul_f32 v191, v191, v48
  v_mfma_f32_16x16x32_bf16 v[108:111], v[72:75], a[80:83], 0
  ds_read_b64_tr_b16 v[60:61], v26 offset:4096
  v_cvt_pk_bf16_f32 v184, v184, v185
  v_mfma_f32_16x16x32_bf16 v[108:111], v[76:79], a[100:103], v[108:111]
  ds_write_b128 v2, v[136:139] offset:20480
  v_mfma_f32_16x16x32_bf16 v[108:111], v[80:83], a[120:123], v[108:111]
  ds_read_b64_tr_b16 v[62:63], v26 offset:6144
  v_cvt_pk_bf16_f32 v185, v186, v187
  v_mfma_f32_16x16x32_bf16 v[108:111], v[84:87], a[140:143], v[108:111]
  ds_read_b64_tr_b16 v[64:65], v26 offset:8192
  v_cvt_pk_bf16_f32 v186, v188, v189
  v_mfma_f32_16x16x32_bf16 v[124:127], v[72:75], a[84:87], 0
  ds_read_b64_tr_b16 v[66:67], v26 offset:10240
  v_cvt_pk_bf16_f32 v187, v190, v191
  v_mfma_f32_16x16x32_bf16 v[124:127], v[76:79], a[104:107], v[124:127]
  ds_write_b128 v2, v[144:147] offset:24576
  v_mfma_f32_16x16x32_bf16 v[124:127], v[80:83], a[124:127], v[124:127]
  ds_read_b64_tr_b16 v[68:69], v26 offset:12288
  v_mul_f32 v192, v192, v50
  v_mfma_f32_16x16x32_bf16 v[124:127], v[84:87], a[144:147], v[124:127]
  ds_read_b64_tr_b16 v[70:71], v26 offset:14336
  v_mul_f32 v193, v193, v50
  v_mfma_f32_16x16x32_bf16 v[140:143], v[72:75], a[88:91], 0
  v_mul_f32 v194, v194, v50
  v_mul_f32 v195, v195, v50
  v_mfma_f32_16x16x32_bf16 v[140:143], v[76:79], a[108:111], v[140:143]
  ds_write_b128 v1, v[152:155] offset:0
  v_mfma_f32_16x16x32_bf16 v[140:143], v[80:83], a[128:131], v[140:143]
  v_mul_f32 v196, v196, v50
  v_mul_f32 v197, v197, v50
  v_mfma_f32_16x16x32_bf16 v[140:143], v[84:87], a[148:151], v[140:143]
  v_mul_f32 v198, v198, v50
  v_mul_f32 v199, v199, v50
  v_mfma_f32_16x16x32_bf16 v[156:159], v[72:75], a[92:95], 0
  v_cvt_pk_bf16_f32 v192, v192, v193
  v_cvt_pk_bf16_f32 v193, v194, v195
  v_mfma_f32_16x16x32_bf16 v[156:159], v[76:79], a[112:115], v[156:159]
  ds_write_b128 v1, v[160:163] offset:4096
  v_mfma_f32_16x16x32_bf16 v[156:159], v[80:83], a[132:135], v[156:159]
  v_cvt_pk_bf16_f32 v194, v196, v197
  v_cvt_pk_bf16_f32 v195, v198, v199
  v_mfma_f32_16x16x32_bf16 v[156:159], v[84:87], a[152:155], v[156:159]
  v_mul_f32 v200, v200, v52
  v_mul_f32 v201, v201, v52
  v_mfma_f32_16x16x32_bf16 v[172:175], v[72:75], a[96:99], 0
  s_add_u32 s52, s52, 128
  s_and_b32 s52, s52, 0x3ff
  v_mul_f32 v202, v202, v52
  v_mfma_f32_16x16x32_bf16 v[172:175], v[76:79], a[116:119], v[172:175]
  ds_write_b128 v1, v[168:171] offset:8192
  s_mov_b32 s55, s53
  v_mfma_f32_16x16x32_bf16 v[172:175], v[80:83], a[136:139], v[172:175]
  v_mul_f32 v203, v203, v52
  v_mul_f32 v204, v204, v52
  v_mfma_f32_16x16x32_bf16 v[172:175], v[84:87], a[156:159], v[172:175]
  s_waitcnt lgkmcnt(0)
  v_mul_f32 v205, v205, v52
  v_mul_f32 v206, v206, v52
  v_mul_f32 v207, v207, v52
  v_cvt_pk_bf16_f32 v200, v200, v201
  v_cvt_pk_bf16_f32 v201, v202, v203
  v_cvt_pk_bf16_f32 v202, v204, v205
  v_cvt_pk_bf16_f32 v203, v206, v207
  v_mul_f32 v208, v208, v54
  v_mul_f32 v209, v209, v54
  v_mul_f32 v210, v210, v54
  v_mul_f32 v211, v211, v54
  v_mul_f32 v212, v212, v54
  v_mul_f32 v213, v213, v54
  v_mul_f32 v214, v214, v54
  v_mul_f32 v215, v215, v54
  v_cvt_pk_bf16_f32 v208, v208, v209
  v_cvt_pk_bf16_f32 v209, v210, v211
  v_cvt_pk_bf16_f32 v210, v212, v213
  v_cvt_pk_bf16_f32 v211, v214, v215
  v_mul_f32 v216, v216, v46
  v_mul_f32 v217, v217, v46
  v_mul_f32 v218, v218, v46
  v_mul_f32 v219, v219, v46
  v_mul_f32 v220, v220, v46
  v_mul_f32 v221, v221, v46
  v_mul_f32 v222, v222, v46
  v_mul_f32 v223, v223, v46
  v_cvt_pk_bf16_f32 v216, v216, v217
  v_cvt_pk_bf16_f32 v217, v218, v219
  v_cvt_pk_bf16_f32 v218, v220, v221
  v_cvt_pk_bf16_f32 v219, v222, v223
  v_mul_f32 v224, v224, v48
  v_mul_f32 v225, v225, v48
  v_mul_f32 v226, v226, v48
  v_mul_f32 v227, v227, v48
  v_mul_f32 v228, v228, v48
  v_mul_f32 v229, v229, v48
  v_mul_f32 v230, v230, v48
  v_mul_f32 v231, v231, v48
  v_cvt_pk_bf16_f32 v224, v224, v225
  v_cvt_pk_bf16_f32 v225, v226, v227
  v_cvt_pk_bf16_f32 v226, v228, v229
  v_cvt_pk_bf16_f32 v227, v230, v231
  v_mfma_f32_16x16x32_bf16 v[100:103], v[56:59], a[160:163], v[100:103]
  s_waitcnt vmcnt(0)
  s_barrier
  v_mul_f32 v232, v232, v50
  v_mfma_f32_16x16x32_bf16 v[100:103], v[60:63], a[180:183], v[100:103]
  ds_read_b64_tr_b16 v[72:73], v25 offset:32768
  v_mul_f32 v233, v233, v50
  v_mfma_f32_16x16x32_bf16 v[100:103], v[64:67], a[200:203], v[100:103]
  ds_write_b128 v1, v[176:179] offset:12288
  v_mfma_f32_16x16x32_bf16 v[100:103], v[68:71], a[220:223], v[100:103]
  ds_read_b64_tr_b16 v[74:75], v25 offset:34816
  v_mul_f32 v234, v234, v50
  v_mfma_f32_16x16x32_bf16 v[116:119], v[56:59], a[164:167], v[116:119]
  ds_read_b64_tr_b16 v[76:77], v25 offset:36864
  v_mul_f32 v235, v235, v50
  v_mfma_f32_16x16x32_bf16 v[116:119], v[60:63], a[184:187], v[116:119]
  ds_write_b128 v1, v[184:187] offset:16384
  v_mfma_f32_16x16x32_bf16 v[116:119], v[64:67], a[204:207], v[116:119]
  ds_read_b64_tr_b16 v[78:79], v25 offset:38912
  v_mul_f32 v236, v236, v50
  v_mfma_f32_16x16x32_bf16 v[116:119], v[68:71], a[224:227], v[116:119]
  ds_read_b64_tr_b16 v[80:81], v25 offset:40960
  v_mul_f32 v237, v237, v50
  v_mfma_f32_16x16x32_bf16 v[132:135], v[56:59], a[168:171], v[132:135]
  ds_read_b64_tr_b16 v[82:83], v25 offset:43008
  v_mul_f32 v238, v238, v50
  v_mfma_f32_16x16x32_bf16 v[132:135], v[60:63], a[188:191], v[132:135]
  ds_write_b128 v1, v[192:195] offset:20480
  v_mfma_f32_16x16x32_bf16 v[132:135], v[64:67], a[208:211], v[132:135]
  ds_read_b64_tr_b16 v[84:85], v25 offset:45056
  v_mul_f32 v239, v239, v50
  v_mfma_f32_16x16x32_bf16 v[132:135], v[68:71], a[228:231], v[132:135]
  ds_read_b64_tr_b16 v[86:87], v25 offset:47104
  v_cvt_pk_bf16_f32 v232, v232, v233
  v_mfma_f32_16x16x32_bf16 v[148:151], v[56:59], a[172:175], v[148:151]
  ds_write_b128 v1, v[200:203] offset:24576
  v_mfma_f32_16x16x32_bf16 v[148:151], v[60:63], a[192:195], v[148:151]
  v_cvt_pk_bf16_f32 v233, v234, v235
  v_cvt_pk_bf16_f32 v234, v236, v237
  v_mfma_f32_16x16x32_bf16 v[148:151], v[64:67], a[212:215], v[148:151]
  v_cvt_pk_bf16_f32 v235, v238, v239
  v_mul_f32 v240, v240, v52
  v_mfma_f32_16x16x32_bf16 v[148:151], v[68:71], a[232:235], v[148:151]
  v_mul_f32 v241, v241, v52
  v_mul_f32 v242, v242, v52
  v_mfma_f32_16x16x32_bf16 v[164:167], v[56:59], a[176:179], v[164:167]
  ds_write_b128 v1, v[208:211] offset:28672
  v_mfma_f32_16x16x32_bf16 v[164:167], v[60:63], a[196:199], v[164:167]
  ds_read_b64_tr_b16 v[56:57], v24 offset:32768
  v_mul_f32 v243, v243, v52
  v_mfma_f32_16x16x32_bf16 v[164:167], v[64:67], a[216:219], v[164:167]
  ds_read_b64_tr_b16 v[58:59], v24 offset:34816
  v_mul_f32 v244, v244, v52
  v_mfma_f32_16x16x32_bf16 v[164:167], v[68:71], a[236:239], v[164:167]
  ds_read_b64_tr_b16 v[60:61], v24 offset:36864
  v_mul_f32 v245, v245, v52
  v_mfma_f32_16x16x32_bf16 v[108:111], v[88:91], a[160:163], v[108:111]
  ds_write_b128 v1, v[216:219] offset:32768
  v_mfma_f32_16x16x32_bf16 v[108:111], v[92:95], a[180:183], v[108:111]
  ds_read_b64_tr_b16 v[62:63], v24 offset:38912
  v_mul_f32 v246, v246, v52
  v_mfma_f32_16x16x32_bf16 v[108:111], v[6:9], a[200:203], v[108:111]
  ds_read_b64_tr_b16 v[64:65], v24 offset:40960
  v_mul_f32 v247, v247, v52
  v_mfma_f32_16x16x32_bf16 v[108:111], v[10:13], a[220:223], v[108:111]
  ds_write_b128 v1, v[224:227] offset:36864
  v_mfma_f32_16x16x32_bf16 v[124:127], v[88:91], a[164:167], v[124:127]
  ds_read_b64_tr_b16 v[66:67], v24 offset:43008
  v_cvt_pk_bf16_f32 v240, v240, v241
  v_mfma_f32_16x16x32_bf16 v[124:127], v[92:95], a[184:187], v[124:127]
  ds_read_b64_tr_b16 v[68:69], v24 offset:45056
  v_cvt_pk_bf16_f32 v241, v242, v243
  v_mfma_f32_16x16x32_bf16 v[124:127], v[6:9], a[204:207], v[124:127]
  ds_read_b64_tr_b16 v[70:71], v24 offset:47104
  v_cvt_pk_bf16_f32 v242, v244, v245
  v_mfma_f32_16x16x32_bf16 v[124:127], v[10:13], a[224:227], v[124:127]
  ds_write_b128 v1, v[232:235] offset:40960
  v_mfma_f32_16x16x32_bf16 v[140:143], v[88:91], a[168:171], v[140:143]
  v_cvt_pk_bf16_f32 v243, v246, v247
  v_mul_f32 v248, v248, v54
  v_mfma_f32_16x16x32_bf16 v[140:143], v[92:95], a[188:191], v[140:143]
  v_mul_f32 v249, v249, v54
  v_mul_f32 v250, v250, v54
  v_mfma_f32_16x16x32_bf16 v[140:143], v[6:9], a[208:211], v[140:143]
  ds_write_b128 v1, v[240:243] offset:45056
  v_mfma_f32_16x16x32_bf16 v[140:143], v[10:13], a[228:231], v[140:143]
  v_mul_f32 v251, v251, v54
  v_mul_f32 v252, v252, v54
  v_mfma_f32_16x16x32_bf16 v[156:159], v[88:91], a[172:175], v[156:159]
  v_mul_f32 v253, v253, v54
  v_mul_f32 v254, v254, v54
  v_mfma_f32_16x16x32_bf16 v[156:159], v[92:95], a[192:195], v[156:159]
  v_mul_f32 v255, v255, v54
  v_cvt_pk_bf16_f32 v248, v248, v249
  v_mfma_f32_16x16x32_bf16 v[156:159], v[6:9], a[212:215], v[156:159]
  v_cvt_pk_bf16_f32 v249, v250, v251
  v_cvt_pk_bf16_f32 v250, v252, v253
  v_cvt_pk_bf16_f32 v251, v254, v255
  ds_write_b128 v1, v[248:251] offset:49152
  v_mfma_f32_16x16x32_bf16 v[156:159], v[10:13], a[232:235], v[156:159]
  v_mfma_f32_16x16x32_bf16 v[172:175], v[88:91], a[176:179], v[172:175]
  v_mfma_f32_16x16x32_bf16 v[172:175], v[92:95], a[196:199], v[172:175]
  v_mfma_f32_16x16x32_bf16 v[172:175], v[6:9], a[216:219], v[172:175]
  v_mfma_f32_16x16x32_bf16 v[172:175], v[10:13], a[236:239], v[172:175]
  s_waitcnt lgkmcnt(0)
  v_mfma_f32_16x16x32_bf16 v[100:103], v[56:59], v[96:99], v[100:103]
  s_barrier
  v_mfma_f32_16x16x32_bf16 v[100:103], v[60:63], v[136:139], v[100:103]
  s_add_u32 s35, s52, 0
  s_add_u32 m0, s31, 0
  ds_read_b64_tr_b16 v[88:89], v27 offset:32768
  ds_read_b64_tr_b16 v[90:91], v27 offset:34816
  v_mfma_f32_16x16x32_bf16 v[100:103], v[64:67], v[176:179], v[100:103]
  buffer_load_dwordx4 v17, s[12:15], s35 offen lds
  v_mfma_f32_16x16x32_bf16 v[100:103], v[68:71], v[216:219], v[100:103]
  ds_read_b64_tr_b16 v[92:93], v27 offset:36864
  ds_read_b64_tr_b16 v[94:95], v27 offset:38912
  v_mfma_f32_16x16x32_bf16 v[116:119], v[56:59], v[104:107], v[116:119]
  buffer_load_dwordx4 v18, s[12:15], s35 offen offset:1024 lds
  v_mfma_f32_16x16x32_bf16 v[116:119], v[60:63], v[144:147], v[116:119]
  ds_read_b64_tr_b16 v[6:7], v27 offset:40960
  ds_read_b64_tr_b16 v[8:9], v27 offset:43008
  v_mfma_f32_16x16x32_bf16 v[116:119], v[64:67], v[184:187], v[116:119]
  buffer_load_dwordx4 v19, s[12:15], s35 offen offset:2048 lds
  v_mfma_f32_16x16x32_bf16 v[116:119], v[68:71], v[224:227], v[116:119]
  ds_read_b64_tr_b16 v[10:11], v27 offset:45056
  ds_read_b64_tr_b16 v[12:13], v27 offset:47104
  v_mfma_f32_16x16x32_bf16 v[132:135], v[56:59], v[112:115], v[132:135]
  buffer_load_dwordx4 v20, s[12:15], s35 offen offset:3072 lds
  v_mfma_f32_16x16x32_bf16 v[132:135], v[60:63], v[152:155], v[132:135]
  s_add_u32 s35, s52, 131072
  s_add_u32 m0, s31, 16384
  ds_read_b128 a[0:3], v4 offset:0
  v_mfma_f32_16x16x32_bf16 v[132:135], v[64:67], v[192:195], v[132:135]
  buffer_load_dwordx4 v17, s[12:15], s35 offen lds
  v_mfma_f32_16x16x32_bf16 v[132:135], v[68:71], v[232:235], v[132:135]
  ds_read_b128 a[4:7], v4 offset:4096
  v_mfma_f32_16x16x32_bf16 v[148:151], v[56:59], v[120:123], v[148:151]
  buffer_load_dwordx4 v18, s[12:15], s35 offen offset:1024 lds
  v_mfma_f32_16x16x32_bf16 v[148:151], v[60:63], v[160:163], v[148:151]
  ds_read_b128 a[8:11], v4 offset:8192
  v_mfma_f32_16x16x32_bf16 v[148:151], v[64:67], v[200:203], v[148:151]
  buffer_load_dwordx4 v19, s[12:15], s35 offen offset:2048 lds
  v_mfma_f32_16x16x32_bf16 v[148:151], v[68:71], v[240:243], v[148:151]
  ds_read_b128 a[12:15], v4 offset:12288
  v_mfma_f32_16x16x32_bf16 v[164:167], v[56:59], v[128:131], v[164:167]
  buffer_load_dwordx4 v20, s[12:15], s35 offen offset:3072 lds
  v_mfma_f32_16x16x32_bf16 v[164:167], v[60:63], v[168:171], v[164:167]
  ds_read_b128 a[16:19], v4 offset:16384
  v_mfma_f32_16x16x32_bf16 v[164:167], v[64:67], v[208:211], v[164:167]
  ds_read_b64_tr_b16 v[56:57], v26 offset:32768
  ds_read_b64_tr_b16 v[58:59], v26 offset:34816
  v_mfma_f32_16x16x32_bf16 v[164:167], v[68:71], v[248:251], v[164:167]
  ds_read_b64_tr_b16 v[60:61], v26 offset:36864
  ds_read_b64_tr_b16 v[62:63], v26 offset:38912
  v_mfma_f32_16x16x32_bf16 v[108:111], v[72:75], v[96:99], v[108:111]
  ds_read_b64_tr_b16 v[64:65], v26 offset:40960
  ds_read_b64_tr_b16 v[66:67], v26 offset:43008
  v_mfma_f32_16x16x32_bf16 v[108:111], v[76:79], v[136:139], v[108:111]
  ds_read_b64_tr_b16 v[68:69], v26 offset:45056
  ds_read_b64_tr_b16 v[70:71], v26 offset:47104
  v_mfma_f32_16x16x32_bf16 v[108:111], v[80:83], v[176:179], v[108:111]
  ds_read_b128 a[20:23], v4 offset:20480
  v_mfma_f32_16x16x32_bf16 v[108:111], v[84:87], v[216:219], v[108:111]
  ds_read_b128 a[24:27], v4 offset:24576
  v_mfma_f32_16x16x32_bf16 v[124:127], v[72:75], v[104:107], v[124:127]
  ds_read_b128 a[28:31], v3 offset:0
  v_mfma_f32_16x16x32_bf16 v[124:127], v[76:79], v[144:147], v[124:127]
  ds_read_b128 a[32:35], v3 offset:4096
  v_mfma_f32_16x16x32_bf16 v[124:127], v[80:83], v[184:187], v[124:127]
  ds_read_b128 a[36:39], v3 offset:8192
  v_mfma_f32_16x16x32_bf16 v[124:127], v[84:87], v[224:227], v[124:127]
  ds_read_b128 a[40:43], v3 offset:12288
  v_mfma_f32_16x16x32_bf16 v[140:143], v[72:75], v[112:115], v[140:143]
  ds_read_b128 a[44:47], v3 offset:16384
  v_mfma_f32_16x16x32_bf16 v[140:143], v[76:79], v[152:155], v[140:143]
  ds_read_b128 a[48:51], v3 offset:20480
  v_mfma_f32_16x16x32_bf16 v[140:143], v[80:83], v[192:195], v[140:143]
  ds_read_b128 a[52:55], v3 offset:24576
  v_mfma_f32_16x16x32_bf16 v[140:143], v[84:87], v[232:235], v[140:143]
  ds_read_b128 a[56:59], v3 offset:28672
  v_mfma_f32_16x16x32_bf16 v[156:159], v[72:75], v[120:123], v[156:159]
  ds_read_b128 a[60:63], v3 offset:32768
  v_mfma_f32_16x16x32_bf16 v[156:159], v[76:79], v[160:163], v[156:159]
  ds_read_b128 a[64:67], v3 offset:36864
  v_mfma_f32_16x16x32_bf16 v[156:159], v[80:83], v[200:203], v[156:159]
  ds_read_b128 a[68:71], v3 offset:40960
  v_mfma_f32_16x16x32_bf16 v[156:159], v[84:87], v[240:243], v[156:159]
  ds_read_b128 a[72:75], v3 offset:45056
  v_mfma_f32_16x16x32_bf16 v[172:175], v[72:75], v[128:131], v[172:175]
  ds_read_b128 a[76:79], v3 offset:49152
  v_mfma_f32_16x16x32_bf16 v[172:175], v[76:79], v[168:171], v[172:175]
  v_mfma_f32_16x16x32_bf16 v[172:175], v[80:83], v[208:211], v[172:175]
  v_mfma_f32_16x16x32_bf16 v[172:175], v[84:87], v[248:251], v[172:175]
  s_waitcnt lgkmcnt(0)
  v_mfma_f32_16x16x32_bf16 v[100:103], v[56:59], a[0:3], v[100:103]
  s_waitcnt vmcnt(0)
  s_barrier
  s_lshl_b32 s44, s30, 5
  s_lshl_b32 s45, s33, 7
  v_mfma_f32_16x16x32_bf16 v[100:103], v[60:63], a[20:23], v[100:103]
  ds_read_b64_tr_b16 v[72:73], v25 offset:0
  v_mfma_f32_16x16x32_bf16 v[100:103], v[64:67], a[40:43], v[100:103]
  s_add_u32 s35, s52, 262144
  s_add_u32 m0, s31, 32768
  ds_read_b64_tr_b16 v[74:75], v25 offset:2048
  s_add_u32 s45, s45, s44
  s_mov_b32 s57, 0
  v_mfma_f32_16x16x32_bf16 v[100:103], v[68:71], a[60:63], v[100:103]
  buffer_load_dwordx4 v17, s[12:15], s35 offen lds
  s_mov_b32 s58, 16777216
  s_add_u32 s59, s32, 65792
  v_mfma_f32_16x16x32_bf16 v[116:119], v[56:59], a[4:7], v[116:119]
  ds_read_b64_tr_b16 v[76:77], v25 offset:4096
  v_lshl_add_u32 v28, v0, 4, s32
  v_mfma_f32_16x16x32_bf16 v[116:119], v[60:63], a[24:27], v[116:119]
  ds_read_b64_tr_b16 v[78:79], v25 offset:6144
  v_add_u32 v29, 4096, v28
  v_mfma_f32_16x16x32_bf16 v[116:119], v[64:67], a[44:47], v[116:119]
  ds_read_b64_tr_b16 v[80:81], v25 offset:8192
  v_mov_b32 v31, s38
  v_mfma_f32_16x16x32_bf16 v[116:119], v[68:71], a[64:67], v[116:119]
  buffer_load_dwordx4 v18, s[12:15], s35 offen offset:1024 lds
  v_mfma_f32_16x16x32_bf16 v[132:135], v[56:59], a[8:11], v[132:135]
  ds_read_b64_tr_b16 v[82:83], v25 offset:10240
  v_mov_b32 v39, 16777216
  v_mfma_f32_16x16x32_bf16 v[132:135], v[60:63], a[28:31], v[132:135]
  ds_read_b64_tr_b16 v[84:85], v25 offset:12288
  v_mov_b32 v40, s44
  v_mfma_f32_16x16x32_bf16 v[132:135], v[64:67], a[48:51], v[132:135]
  ds_read_b64_tr_b16 v[86:87], v25 offset:14336
  v_cmp_eq_u32 vcc, 0, v0
  v_mfma_f32_16x16x32_bf16 v[132:135], v[68:71], a[68:71], v[132:135]
  buffer_load_dwordx4 v19, s[12:15], s35 offen offset:2048 lds
  v_mfma_f32_16x16x32_bf16 v[148:151], v[56:59], a[12:15], v[148:151]
  v_cndmask_b32 v32, v39, v40, vcc
  v_lshl_add_u32 v40, v0, 2, s45
  v_mfma_f32_16x16x32_bf16 v[148:151], v[60:63], a[32:35], v[148:151]
  v_cmp_gt_u32 vcc, 8, v0
  v_mfma_f32_16x16x32_bf16 v[148:151], v[64:67], a[52:55], v[148:151]
  v_mfma_f32_16x16x32_bf16 v[148:151], v[68:71], a[72:75], v[148:151]
  buffer_load_dwordx4 v20, s[12:15], s35 offen offset:3072 lds
  v_mfma_f32_16x16x32_bf16 v[164:167], v[56:59], a[16:19], v[164:167]
  v_cndmask_b32 v33, v39, v40, vcc
  v_and_b32 v38, 1, v0
  v_mfma_f32_16x16x32_bf16 v[164:167], v[60:63], a[36:39], v[164:167]
  ds_read_b64_tr_b16 v[56:57], v24 offset:0
  v_lshlrev_b32 v38, 4, v38
  v_mfma_f32_16x16x32_bf16 v[164:167], v[64:67], a[56:59], v[164:167]
  s_add_u32 s35, s52, 393216
  s_add_u32 m0, s31, 49152
  ds_read_b64_tr_b16 v[58:59], v24 offset:2048
  v_mfma_f32_16x16x32_bf16 v[164:167], v[68:71], a[76:79], v[164:167]
  buffer_load_dwordx4 v17, s[12:15], s35 offen lds
  v_mfma_f32_16x16x32_bf16 v[108:111], v[88:91], a[0:3], v[108:111]
  ds_read_b64_tr_b16 v[60:61], v24 offset:4096
  v_mov_b32 v39, 0x3f80
  v_mfma_f32_16x16x32_bf16 v[108:111], v[92:95], a[20:23], v[108:111]
  ds_read_b64_tr_b16 v[62:63], v24 offset:6144
  v_lshlrev_b32 v39, v38, v39
  v_mfma_f32_16x16x32_bf16 v[108:111], v[6:9], a[40:43], v[108:111]
  ds_read_b64_tr_b16 v[64:65], v24 offset:8192
  v_cmp_eq_u32 vcc, v37, v36
  v_mfma_f32_16x16x32_bf16 v[108:111], v[10:13], a[60:63], v[108:111]
  buffer_load_dwordx4 v18, s[12:15], s35 offen offset:1024 lds
  v_mfma_f32_16x16x32_bf16 v[124:127], v[88:91], a[4:7], v[124:127]
  ds_read_b64_tr_b16 v[66:67], v24 offset:10240
  v_and_b32 v38, 2, v0
  v_mfma_f32_16x16x32_bf16 v[124:127], v[92:95], a[24:27], v[124:127]
  ds_read_b64_tr_b16 v[68:69], v24 offset:12288
  v_mov_b32 v37, 0
  v_mfma_f32_16x16x32_bf16 v[124:127], v[6:9], a[44:47], v[124:127]
  ds_read_b64_tr_b16 v[70:71], v24 offset:14336
  v_cndmask_b32 v39, v37, v39, vcc
  v_mfma_f32_16x16x32_bf16 v[124:127], v[10:13], a[64:67], v[124:127]
  buffer_load_dwordx4 v19, s[12:15], s35 offen offset:2048 lds
  v_mfma_f32_16x16x32_bf16 v[140:143], v[88:91], a[8:11], v[140:143]
  v_cmp_eq_u32 vcc, 0, v38
  v_accvgpr_write_b32 a240, v37
  v_mfma_f32_16x16x32_bf16 v[140:143], v[92:95], a[28:31], v[140:143]
  v_accvgpr_write_b32 a241, v37
  v_cndmask_b32 v40, v37, v39, vcc
  v_mfma_f32_16x16x32_bf16 v[140:143], v[6:9], a[48:51], v[140:143]
  v_cndmask_b32 v38, v39, v37, vcc
  v_accvgpr_write_b32 a244, v37
  v_mfma_f32_16x16x32_bf16 v[140:143], v[10:13], a[68:71], v[140:143]
  buffer_load_dwordx4 v20, s[12:15], s35 offen offset:3072 lds
  s_mul_i32 s46, s33, 143360
  s_sub_u32 s46, s46, 16797696
  s_mov_b32 s47, 1
  v_mfma_f32_16x16x32_bf16 v[156:159], v[88:91], a[12:15], v[156:159]
  s_mov_b32 s39, 0
  v_accvgpr_write_b32 a245, v37
  v_accvgpr_write_b32 a242, v40
  v_mfma_f32_16x16x32_bf16 v[156:159], v[92:95], a[32:35], v[156:159]
  v_accvgpr_write_b32 a243, v38
  v_mfma_f32_16x16x32_bf16 v[156:159], v[6:9], a[52:55], v[156:159]
  v_mfma_f32_16x16x32_bf16 v[156:159], v[10:13], a[72:75], v[156:159]
  s_mov_b32 s56, s54
  s_add_u32 s54, s54, 132
  s_add_u32 s53, s53, 163840
  v_mfma_f32_16x16x32_bf16 v[172:175], v[88:91], a[16:19], v[172:175]
  s_cmp_ge_u32 s54, 1024
  s_cselect_b32 s48, 1024, 0
  s_cselect_b32 s49, 1146880, 0
  v_mfma_f32_16x16x32_bf16 v[172:175], v[92:95], a[36:39], v[172:175]
  s_sub_u32 s54, s54, s48
  s_sub_u32 s53, s53, s49
  v_mfma_f32_16x16x32_bf16 v[172:175], v[6:9], a[56:59], v[172:175]
  s_waitcnt lgkmcnt(0)
  v_mfma_f32_16x16x32_bf16 v[172:175], v[10:13], a[76:79], v[172:175]
L_oloop:
  v_mfma_f32_16x16x32_bf16 v[180:183], v[56:59], a[80:83], 0
  buffer_load_dword v30, v33, s[20:23], 0 offen sc1
  v_mfma_f32_16x16x32_bf16 v[180:183], v[60:63], a[100:103], v[180:183]
  ds_read_b64_tr_b16 v[88:89], v27 offset:0
  v_mfma_f32_16x16x32_bf16 v[180:183], v[64:67], a[120:123], v[180:183]
  ds_read_b64_tr_b16 v[90:91], v27 offset:2048
  v_mfma_f32_16x16x32_bf16 v[180:183], v[68:71], a[140:143], v[180:183]
  ds_read_b64_tr_b16 v[92:93], v27 offset:4096
  v_cvt_pk_bf16_f32 v36, v100, v101
  v_mfma_f32_16x16x32_bf16 v[196:199], v[56:59], a[84:87], 0
  ds_read_b64_tr_b16 v[94:95], v27 offset:6144
  v_cvt_pk_bf16_f32 v37, v102, v103
  v_mfma_f32_16x16x32_bf16 v[196:199], v[60:63], a[104:107], v[196:199]
  ds_read_b64_tr_b16 v[6:7], v27 offset:8192
  v_cvt_pk_bf16_f32 v38, v108, v109
  v_mfma_f32_16x16x32_bf16 v[196:199], v[64:67], a[124:127], v[196:199]
  ds_read_b64_tr_b16 v[8:9], v27 offset:10240
  v_cvt_pk_bf16_f32 v39, v110, v111
  v_mfma_f32_16x16x32_bf16 v[196:199], v[68:71], a[144:147], v[196:199]
  ds_read_b64_tr_b16 v[10:11], v27 offset:12288
  v_cvt_pk_bf16_f32 v40, v116, v117
  v_mfma_f32_16x16x32_bf16 v[212:215], v[56:59], a[88:91], 0
  ds_read_b64_tr_b16 v[12:13], v27 offset:14336
  v_cvt_pk_bf16_f32 v41, v118, v119
  v_mfma_f32_16x16x32_bf16 v[212:215], v[60:63], a[108:111], v[212:215]
  v_cvt_pk_bf16_f32 v42, v124, v125
  v_cvt_pk_bf16_f32 v43, v126, v127
  v_mfma_f32_16x16x32_bf16 v[212:215], v[64:67], a[128:131], v[212:215]
  v_cvt_pk_bf16_f32 v44, v132, v133
  v_cvt_pk_bf16_f32 v45, v134, v135
  v_mfma_f32_16x16x32_bf16 v[212:215], v[68:71], a[148:151], v[212:215]
  v_cvt_pk_bf16_f32 v46, v140, v141
  v_cvt_pk_bf16_f32 v47, v142, v143
  v_mfma_f32_16x16x32_bf16 v[228:231], v[56:59], a[92:95], 0
  buffer_store_dwordx4 v[36:39], v28, s[16:19], s55 offen sc1
  v_mfma_f32_16x16x32_bf16 v[228:231], v[60:63], a[112:115], v[228:231]
  v_cvt_pk_bf16_f32 v48, v148, v149
  v_cvt_pk_bf16_f32 v49, v150, v151
  v_mfma_f32_16x16x32_bf16 v[228:231], v[64:67], a[132:135], v[228:231]
  v_cvt_pk_bf16_f32 v50, v156, v157
  v_cvt_pk_bf16_f32 v51, v158, v159
  v_mfma_f32_16x16x32_bf16 v[228:231], v[68:71], a[152:155], v[228:231]
  v_cvt_pk_bf16_f32 v52, v164, v165
  v_cvt_pk_bf16_f32 v53, v166, v167
  v_mfma_f32_16x16x32_bf16 v[244:247], v[56:59], a[96:99], 0
  v_cvt_pk_bf16_f32 v54, v172, v173
  v_cvt_pk_bf16_f32 v55, v174, v175
  v_mfma_f32_16x16x32_bf16 v[244:247], v[60:63], a[116:119], v[244:247]
  ds_read_b64_tr_b16 v[56:57], v26 offset:0
  v_mfma_f32_16x16x32_bf16 v[244:247], v[64:67], a[136:139], v[244:247]
  buffer_store_dwordx4 v[40:43], v28, s[16:19], s55 offen offset:1024 sc1
  v_mfma_f32_16x16x32_bf16 v[244:247], v[68:71], a[156:159], v[244:247]
  ds_read_b64_tr_b16 v[58:59], v26 offset:2048
  v_mfma_f32_16x16x32_bf16 v[188:191], v[72:75], a[80:83], 0
  ds_read_b64_tr_b16 v[60:61], v26 offset:4096
  v_mfma_f32_16x16x32_bf16 v[188:191], v[76:79], a[100:103], v[188:191]
  ds_read_b64_tr_b16 v[62:63], v26 offset:6144
  v_mfma_f32_16x16x32_bf16 v[188:191], v[80:83], a[120:123], v[188:191]
  ds_read_b64_tr_b16 v[64:65], v26 offset:8192
  v_mfma_f32_16x16x32_bf16 v[188:191], v[84:87], a[140:143], v[188:191]
  ds_read_b64_tr_b16 v[66:67], v26 offset:10240
  v_mfma_f32_16x16x32_bf16 v[204:207], v[72:75], a[84:87], 0
  buffer_store_dwordx4 v[44:47], v28, s[16:19], s55 offen offset:2048 sc1
  v_mfma_f32_16x16x32_bf16 v[204:207], v[76:79], a[104:107], v[204:207]
  ds_read_b64_tr_b16 v[68:69], v26 offset:12288
  v_mfma_f32_16x16x32_bf16 v[204:207], v[80:83], a[124:127], v[204:207]
  ds_read_b64_tr_b16 v[70:71], v26 offset:14336
  v_mfma_f32_16x16x32_bf16 v[204:207], v[84:87], a[144:147], v[204:207]
  v_mfma_f32_16x16x32_bf16 v[220:223], v[72:75], a[88:91], 0
  v_mfma_f32_16x16x32_bf16 v[220:223], v[76:79], a[108:111], v[220:223]
  v_mfma_f32_16x16x32_bf16 v[220:223], v[80:83], a[128:131], v[220:223]
  buffer_store_dwordx4 v[48:51], v28, s[16:19], s55 offen offset:3072 sc1
  v_mfma_f32_16x16x32_bf16 v[220:223], v[84:87], a[148:151], v[220:223]
  v_mfma_f32_16x16x32_bf16 v[236:239], v[72:75], a[92:95], 0
  v_mfma_f32_16x16x32_bf16 v[236:239], v[76:79], a[112:115], v[236:239]
  v_mfma_f32_16x16x32_bf16 v[236:239], v[80:83], a[132:135], v[236:239]
  v_mfma_f32_16x16x32_bf16 v[236:239], v[84:87], a[152:155], v[236:239]
  v_mfma_f32_16x16x32_bf16 v[252:255], v[72:75], a[96:99], 0
  buffer_store_dwordx4 v[52:55], v29, s[16:19], s55 offen sc1
  s_add_u32 s52, s52, 128
  s_and_b32 s52, s52, 0x3ff
  v_mfma_f32_16x16x32_bf16 v[252:255], v[76:79], a[116:119], v[252:255]
  s_mov_b32 s55, s53
  v_mfma_f32_16x16x32_bf16 v[252:255], v[80:83], a[136:139], v[252:255]
  s_waitcnt lgkmcnt(0)
  v_mfma_f32_16x16x32_bf16 v[252:255], v[84:87], a[156:159], v[252:255]
  v_mfma_f32_16x16x32_bf16 v[180:183], v[56:59], a[160:163], v[180:183]
  s_waitcnt vmcnt(6)
  s_barrier
  v_mfma_f32_16x16x32_bf16 v[180:183], v[60:63], a[180:183], v[180:183]
  ds_read_b64_tr_b16 v[72:73], v25 offset:32768
  v_mfma_f32_16x16x32_bf16 v[180:183], v[64:67], a[200:203], v[180:183]
  s_add_u32 s35, s52, 0
  s_add_u32 m0, s31, 0
  ds_read_b64_tr_b16 v[74:75], v25 offset:34816
  v_mfma_f32_16x16x32_bf16 v[180:183], v[68:71], a[220:223], v[180:183]
  buffer_load_dwordx4 v17, s[12:15], s35 offen lds
  v_mfma_f32_16x16x32_bf16 v[196:199], v[56:59], a[164:167], v[196:199]
  ds_read_b64_tr_b16 v[76:77], v25 offset:36864
  v_mfma_f32_16x16x32_bf16 v[196:199], v[60:63], a[184:187], v[196:199]
  ds_read_b64_tr_b16 v[78:79], v25 offset:38912
  v_mfma_f32_16x16x32_bf16 v[196:199], v[64:67], a[204:207], v[196:199]
  ds_read_b64_tr_b16 v[80:81], v25 offset:40960
  v_mfma_f32_16x16x32_bf16 v[196:199], v[68:71], a[224:227], v[196:199]
  buffer_load_dwordx4 v18, s[12:15], s35 offen offset:1024 lds
  v_mfma_f32_16x16x32_bf16 v[212:215], v[56:59], a[168:171], v[212:215]
  ds_read_b64_tr_b16 v[82:83], v25 offset:43008
  v_mfma_f32_16x16x32_bf16 v[212:215], v[60:63], a[188:191], v[212:215]
  ds_read_b64_tr_b16 v[84:85], v25 offset:45056
  v_mfma_f32_16x16x32_bf16 v[212:215], v[64:67], a[208:211], v[212:215]
  ds_read_b64_tr_b16 v[86:87], v25 offset:47104
  v_mfma_f32_16x16x32_bf16 v[212:215], v[68:71], a[228:231], v[212:215]
  buffer_load_dwordx4 v19, s[12:15], s35 offen offset:2048 lds
  v_mfma_f32_16x16x32_bf16 v[228:231], v[56:59], a[172:175], v[228:231]
  v_mfma_f32_16x16x32_bf16 v[228:231], v[60:63], a[192:195], v[228:231]
  v_mfma_f32_16x16x32_bf16 v[228:231], v[64:67], a[212:215], v[228:231]
  v_mfma_f32_16x16x32_bf16 v[228:231], v[68:71], a[232:235], v[228:231]
  buffer_load_dwordx4 v20, s[12:15], s35 offen offset:3072 lds
  v_mfma_f32_16x16x32_bf16 v[244:247], v[56:59], a[176:179], v[244:247]
  v_mfma_f32_16x16x32_bf16 v[244:247], v[60:63], a[196:199], v[244:247]
  ds_read_b64_tr_b16 v[56:57], v24 offset:32768
  v_mfma_f32_16x16x32_bf16 v[244:247], v[64:67], a[216:219], v[244:247]
  s_add_u32 s35, s52, 131072
  s_add_u32 m0, s31, 16384
  ds_read_b64_tr_b16 v[58:59], v24 offset:34816
  v_mfma_f32_16x16x32_bf16 v[244:247], v[68:71], a[236:239], v[244:247]
  buffer_load_dwordx4 v17, s[12:15], s35 offen lds
  v_mfma_f32_16x16x32_bf16 v[188:191], v[88:91], a[160:163], v[188:191]
  ds_read_b64_tr_b16 v[60:61], v24 offset:36864
  v_mfma_f32_16x16x32_bf16 v[188:191], v[92:95], a[180:183], v[188:191]
  ds_read_b64_tr_b16 v[62:63], v24 offset:38912
  v_mfma_f32_16x16x32_bf16 v[188:191], v[6:9], a[200:203], v[188:191]
  ds_read_b64_tr_b16 v[64:65], v24 offset:40960
  v_mfma_f32_16x16x32_bf16 v[188:191], v[10:13], a[220:223], v[188:191]
  buffer_load_dwordx4 v18, s[12:15], s35 offen offset:1024 lds
  v_mfma_f32_16x16x32_bf16 v[204:207], v[88:91], a[164:167], v[204:207]
  ds_read_b64_tr_b16 v[66:67], v24 offset:43008
  v_mfma_f32_16x16x32_bf16 v[204:207], v[92:95], a[184:187], v[204:207]
  ds_read_b64_tr_b16 v[68:69], v24 offset:45056
  v_mfma_f32_16x16x32_bf16 v[204:207], v[6:9], a[204:207], v[204:207]
  ds_read_b64_tr_b16 v[70:71], v24 offset:47104
  v_mfma_f32_16x16x32_bf16 v[204:207], v[10:13], a[224:227], v[204:207]
  buffer_load_dwordx4 v19, s[12:15], s35 offen offset:2048 lds
  v_mfma_f32_16x16x32_bf16 v[220:223], v[88:91], a[168:171], v[220:223]
  v_mfma_f32_16x16x32_bf16 v[220:223], v[92:95], a[188:191], v[220:223]
  v_mfma_f32_16x16x32_bf16 v[220:223], v[6:9], a[208:211], v[220:223]
  v_mfma_f32_16x16x32_bf16 v[220:223], v[10:13], a[228:231], v[220:223]
  buffer_load_dwordx4 v20, s[12:15], s35 offen offset:3072 lds
  v_mfma_f32_16x16x32_bf16 v[236:239], v[88:91], a[172:175], v[236:239]
  v_mfma_f32_16x16x32_bf16 v[236:239], v[92:95], a[192:195], v[236:239]
  v_mfma_f32_16x16x32_bf16 v[236:239], v[6:9], a[212:215], v[236:239]
  v_mfma_f32_16x16x32_bf16 v[236:239], v[10:13], a[232:235], v[236:239]
  v_mfma_f32_16x16x32_bf16 v[252:255], v[88:91], a[176:179], v[252:255]
  v_mfma_f32_16x16x32_bf16 v[252:255], v[92:95], a[196:199], v[252:255]
  v_mfma_f32_16x16x32_bf16 v[252:255], v[6:9], a[216:219], v[252:255]
  s_waitcnt lgkmcnt(0)
  v_mfma_f32_16x16x32_bf16 v[252:255], v[10:13], a[236:239], v[252:255]
  v_mfma_f32_16x16x32_bf16 v[180:183], v[56:59], v[96:99], v[180:183]
  s_waitcnt vmcnt(13)
  v_cmp_eq_u32 vcc, v30, v31
  v_mfma_f32_16x16x32_bf16 v[180:183], v[60:63], v[136:139], v[180:183]
  v_mfma_f32_16x16x32_bf16 v[180:183], v[64:67], v[176:179], v[180:183]
  s_and_b32 s48, vcc_lo, s57
  s_cmp_eq_u32 s48, s57
  s_cbranch_scc0 L_spinL1
L_gotL1:
  v_mfma_f32_16x16x32_bf16 v[180:183], v[68:71], v[216:219], v[180:183]
  s_mov_b32 m0, s59
  ds_read_b64_tr_b16 v[88:89], v27 offset:32768
  v_mfma_f32_16x16x32_bf16 v[196:199], v[56:59], v[104:107], v[196:199]
  buffer_load_dwordx4 v28, s[16:19], s58 offen sc1 lds
  v_mfma_f32_16x16x32_bf16 v[196:199], v[60:63], v[144:147], v[196:199]
  ds_read_b64_tr_b16 v[90:91], v27 offset:34816
  v_mfma_f32_16x16x32_bf16 v[196:199], v[64:67], v[184:187], v[196:199]
  ds_read_b64_tr_b16 v[92:93], v27 offset:36864
  v_mfma_f32_16x16x32_bf16 v[196:199], v[68:71], v[224:227], v[196:199]
  ds_read_b64_tr_b16 v[94:95], v27 offset:38912
  v_mfma_f32_16x16x32_bf16 v[212:215], v[56:59], v[112:115], v[212:215]
  buffer_load_dwordx4 v28, s[16:19], s58 offen offset:1024 sc1 lds
  v_mfma_f32_16x16x32_bf16 v[212:215], v[60:63], v[152:155], v[212:215]
  ds_read_b64_tr_b16 v[6:7], v27 offset:40960
  v_mfma_f32_16x16x32_bf16 v[212:215], v[64:67], v[192:195], v[212:215]
  ds_read_b64_tr_b16 v[8:9], v27 offset:43008
  v_mfma_f32_16x16x32_bf16 v[212:215], v[68:71], v[232:235], v[212:215]
  ds_read_b64_tr_b16 v[10:11], v27 offset:45056
  v_mfma_f32_16x16x32_bf16 v[228:231], v[56:59], v[120:123], v[228:231]
  buffer_load_dwordx4 v28, s[16:19], s58 offen offset:2048 sc1 lds
  v_mfma_f32_16x16x32_bf16 v[228:231], v[60:63], v[160:163], v[228:231]
  ds_read_b64_tr_b16 v[12:13], v27 offset:47104
  v_mfma_f32_16x16x32_bf16 v[228:231], v[64:67], v[200:203], v[228:231]
  v_mfma_f32_16x16x32_bf16 v[228:231], v[68:71], v[240:243], v[228:231]
  v_mfma_f32_16x16x32_bf16 v[244:247], v[56:59], v[128:131], v[244:247]
  buffer_load_dwordx4 v28, s[16:19], s58 offen offset:3072 sc1 lds
  v_mfma_f32_16x16x32_bf16 v[244:247], v[60:63], v[168:171], v[244:247]
  ds_read_b64_tr_b16 v[56:57], v26 offset:32768
  v_mfma_f32_16x16x32_bf16 v[244:247], v[64:67], v[208:211], v[244:247]
  ds_read_b64_tr_b16 v[58:59], v26 offset:34816
  v_mfma_f32_16x16x32_bf16 v[244:247], v[68:71], v[248:251], v[244:247]
  s_add_u32 m0, s59, 4096
  ds_read_b64_tr_b16 v[60:61], v26 offset:36864
  v_mfma_f32_16x16x32_bf16 v[188:191], v[72:75], v[96:99], v[188:191]
  buffer_load_dwordx4 v29, s[16:19], s58 offen sc1 lds
  v_mfma_f32_16x16x32_bf16 v[188:191], v[76:79], v[136:139], v[188:191]
  ds_read_b64_tr_b16 v[62:63], v26 offset:38912
  v_mfma_f32_16x16x32_bf16 v[188:191], v[80:83], v[176:179], v[188:191]
  ds_read_b64_tr_b16 v[64:65], v26 offset:40960
  v_mfma_f32_16x16x32_bf16 v[188:191], v[84:87], v[216:219], v[188:191]
  ds_read_b64_tr_b16 v[66:67], v26 offset:43008
  v_mfma_f32_16x16x32_bf16 v[204:207], v[72:75], v[104:107], v[204:207]
  ds_read_b64_tr_b16 v[68:69], v26 offset:45056
  v_mfma_f32_16x16x32_bf16 v[204:207], v[76:79], v[144:147], v[204:207]
  ds_read_b64_tr_b16 v[70:71], v26 offset:47104
  v_mfma_f32_16x16x32_bf16 v[204:207], v[80:83], v[184:187], v[204:207]
  v_mfma_f32_16x16x32_bf16 v[204:207], v[84:87], v[224:227], v[204:207]
  v_mfma_f32_16x16x32_bf16 v[220:223], v[72:75], v[112:115], v[220:223]
  v_mfma_f32_16x16x32_bf16 v[220:223], v[76:79], v[152:155], v[220:223]
  v_mfma_f32_16x16x32_bf16 v[220:223], v[80:83], v[192:195], v[220:223]
  v_mfma_f32_16x16x32_bf16 v[220:223], v[84:87], v[232:235], v[220:223]
  v_mfma_f32_16x16x32_bf16 v[236:239], v[72:75], v[120:123], v[236:239]
  s_lshl_b32 s57, s57, 1
  s_cmp_eq_u32 s47, 0
  s_cselect_b32 s57, 1, s57
  v_mfma_f32_16x16x32_bf16 v[236:239], v[76:79], v[160:163], v[236:239]
  s_cselect_b32 s48, s46, 20480
  s_cselect_b32 s49, 0, 20480
  s_add_u32 s58, s58, s48
  v_mfma_f32_16x16x32_bf16 v[236:239], v[80:83], v[200:203], v[236:239]
  s_cmp_lt_i32 s47, 1
  s_cselect_b32 s49, s49, 0
  s_add_u32 s59, s59, s49
  v_mfma_f32_16x16x32_bf16 v[236:239], v[84:87], v[240:243], v[236:239]
  s_sub_u32 s47, s47, 1
  v_mfma_f32_16x16x32_bf16 v[252:255], v[72:75], v[128:131], v[252:255]
  v_mfma_f32_16x16x32_bf16 v[252:255], v[76:79], v[168:171], v[252:255]
  v_mfma_f32_16x16x32_bf16 v[252:255], v[80:83], v[208:211], v[252:255]
  s_waitcnt lgkmcnt(0)
  v_mfma_f32_16x16x32_bf16 v[252:255], v[84:87], v[248:251], v[252:255]
  v_mfma_f32_16x16x32_bf16 v[180:183], v[56:59], a[0:3], v[180:183]
  s_waitcnt vmcnt(5)
  s_barrier
  v_mfma_f32_16x16x32_bf16 v[180:183], v[60:63], a[20:23], v[180:183]
  buffer_store_dword v31, v32, s[20:23], s56 offen sc1
  v_mfma_f32_16x16x32_bf16 v[180:183], v[64:67], a[40:43], v[180:183]
  s_add_u32 s35, s52, 262144
  s_add_u32 m0, s31, 32768
  ds_read_b64_tr_b16 v[72:73], v25 offset:0
  v_mfma_f32_16x16x32_bf16 v[180:183], v[68:71], a[60:63], v[180:183]
  buffer_load_dwordx4 v17, s[12:15], s35 offen lds
  v_mfma_f32_16x16x32_bf16 v[196:199], v[56:59], a[4:7], v[196:199]
  ds_read_b64_tr_b16 v[74:75], v25 offset:2048
  v_mfma_f32_16x16x32_bf16 v[196:199], v[60:63], a[24:27], v[196:199]
  ds_read_b64_tr_b16 v[76:77], v25 offset:4096
  v_mfma_f32_16x16x32_bf16 v[196:199], v[64:67], a[44:47], v[196:199]
  ds_read_b64_tr_b16 v[78:79], v25 offset:6144
  v_mfma_f32_16x16x32_bf16 v[196:199], v[68:71], a[64:67], v[196:199]
  buffer_load_dwordx4 v18, s[12:15], s35 offen offset:1024 lds
  v_mfma_f32_16x16x32_bf16 v[212:215], v[56:59], a[8:11], v[212:215]
  ds_read_b64_tr_b16 v[80:81], v25 offset:8192
  v_mfma_f32_16x16x32_bf16 v[212:215], v[60:63], a[28:31], v[212:215]
  ds_read_b64_tr_b16 v[82:83], v25 offset:10240
  v_mfma_f32_16x16x32_bf16 v[212:215], v[64:67], a[48:51], v[212:215]
  ds_read_b64_tr_b16 v[84:85], v25 offset:12288
  v_mfma_f32_16x16x32_bf16 v[212:215], v[68:71], a[68:71], v[212:215]
  buffer_load_dwordx4 v19, s[12:15], s35 offen offset:2048 lds
  v_mfma_f32_16x16x32_bf16 v[228:231], v[56:59], a[12:15], v[228:231]
  ds_read_b64_tr_b16 v[86:87], v25 offset:14336
  v_mfma_f32_16x16x32_bf16 v[228:231], v[60:63], a[32:35], v[228:231]
  v_mfma_f32_16x16x32_bf16 v[228:231], v[64:67], a[52:55], v[228:231]
  v_mfma_f32_16x16x32_bf16 v[228:231], v[68:71], a[72:75], v[228:231]
  buffer_load_dwordx4 v20, s[12:15], s35 offen offset:3072 lds
  v_mfma_f32_16x16x32_bf16 v[244:247], v[56:59], a[16:19], v[244:247]
  v_mfma_f32_16x16x32_bf16 v[244:247], v[60:63], a[36:39], v[244:247]
  ds_read_b64_tr_b16 v[56:57], v24 offset:0
  v_mfma_f32_16x16x32_bf16 v[244:247], v[64:67], a[56:59], v[244:247]
  s_add_u32 s35, s52, 393216
  s_add_u32 m0, s31, 49152
  ds_read_b64_tr_b16 v[58:59], v24 offset:2048
  v_mfma_f32_16x16x32_bf16 v[244:247], v[68:71], a[76:79], v[244:247]
  buffer_load_dwordx4 v17, s[12:15], s35 offen lds
  v_mfma_f32_16x16x32_bf16 v[188:191], v[88:91], a[0:3], v[188:191]
  ds_read_b64_tr_b16 v[60:61], v24 offset:4096
  v_mfma_f32_16x16x32_bf16 v[188:191], v[92:95], a[20:23], v[188:191]
  ds_read_b64_tr_b16 v[62:63], v24 offset:6144
  v_mfma_f32_16x16x32_bf16 v[188:191], v[6:9], a[40:43], v[188:191]
  ds_read_b64_tr_b16 v[64:65], v24 offset:8192
  v_mfma_f32_16x16x32_bf16 v[188:191], v[10:13], a[60:63], v[188:191]
  buffer_load_dwordx4 v18, s[12:15], s35 offen offset:1024 lds
  v_mfma_f32_16x16x32_bf16 v[204:207], v[88:91], a[4:7], v[204:207]
  ds_read_b64_tr_b16 v[66:67], v24 offset:10240
  v_mfma_f32_16x16x32_bf16 v[204:207], v[92:95], a[24:27], v[204:207]
  ds_read_b64_tr_b16 v[68:69], v24 offset:12288
  v_mfma_f32_16x16x32_bf16 v[204:207], v[6:9], a[44:47], v[204:207]
  ds_read_b64_tr_b16 v[70:71], v24 offset:14336
  v_mfma_f32_16x16x32_bf16 v[204:207], v[10:13], a[64:67], v[204:207]
  buffer_load_dwordx4 v19, s[12:15], s35 offen offset:2048 lds
  v_mfma_f32_16x16x32_bf16 v[220:223], v[88:91], a[8:11], v[220:223]
  v_mfma_f32_16x16x32_bf16 v[220:223], v[92:95], a[28:31], v[220:223]
  v_mfma_f32_16x16x32_bf16 v[220:223], v[6:9], a[48:51], v[220:223]
  v_mfma_f32_16x16x32_bf16 v[220:223], v[10:13], a[68:71], v[220:223]
  buffer_load_dwordx4 v20, s[12:15], s35 offen offset:3072 lds
  v_mfma_f32_16x16x32_bf16 v[236:239], v[88:91], a[12:15], v[236:239]
  v_mfma_f32_16x16x32_bf16 v[236:239], v[92:95], a[32:35], v[236:239]
  v_mfma_f32_16x16x32_bf16 v[236:239], v[6:9], a[52:55], v[236:239]
  v_mfma_f32_16x16x32_bf16 v[236:239], v[10:13], a[72:75], v[236:239]
  s_mov_b32 s56, s54
  s_add_u32 s54, s54, 132
  s_add_u32 s53, s53, 163840
  v_mfma_f32_16x16x32_bf16 v[252:255], v[88:91], a[16:19], v[252:255]
  s_cmp_ge_u32 s54, 1024
  s_cselect_b32 s48, 1024, 0
  s_cselect_b32 s49, 1146880, 0
  v_mfma_f32_16x16x32_bf16 v[252:255], v[92:95], a[36:39], v[252:255]
  s_sub_u32 s54, s54, s48
  s_sub_u32 s53, s53, s49
  v_mfma_f32_16x16x32_bf16 v[252:255], v[6:9], a[56:59], v[252:255]
  s_waitcnt lgkmcnt(0)
  v_mfma_f32_16x16x32_bf16 v[252:255], v[10:13], a[76:79], v[252:255]
  v_mfma_f32_16x16x32_bf16 v[100:103], v[56:59], a[80:83], 0
  buffer_load_dword v30, v33, s[20:23], 0 offen sc1
  v_mfma_f32_16x16x32_bf16 v[100:103], v[60:63], a[100:103], v[100:103]
  ds_read_b64_tr_b16 v[88:89], v27 offset:0
  v_mfma_f32_16x16x32_bf16 v[100:103], v[64:67], a[120:123], v[100:103]
  ds_read_b64_tr_b16 v[90:91], v27 offset:2048
  v_mfma_f32_16x16x32_bf16 v[100:103], v[68:71], a[140:143], v[100:103]
  ds_read_b64_tr_b16 v[92:93], v27 offset:4096
  v_cvt_pk_bf16_f32 v36, v180, v181
  v_mfma_f32_16x16x32_bf16 v[116:119], v[56:59], a[84:87], 0
  ds_read_b64_tr_b16 v[94:95], v27 offset:6144
  v_cvt_pk_bf16_f32 v37, v182, v183
  v_mfma_f32_16x16x32_bf16 v[116:119], v[60:63], a[104:107], v[116:119]
  ds_read_b64_tr_b16 v[6:7], v27 offset:8192
  v_cvt_pk_bf16_f32 v38, v188, v189
  v_mfma_f32_16x16x32_bf16 v[116:119], v[64:67], a[124:127], v[116:119]
  ds_read_b64_tr_b16 v[8:9], v27 offset:10240
  v_cvt_pk_bf16_f32 v39, v190, v191
  v_mfma_f32_16x16x32_bf16 v[116:119], v[68:71], a[144:147], v[116:119]
  ds_read_b64_tr_b16 v[10:11], v27 offset:12288
  v_cvt_pk_bf16_f32 v40, v196, v197
  v_mfma_f32_16x16x32_bf16 v[132:135], v[56:59], a[88:91], 0
  ds_read_b64_tr_b16 v[12:13], v27 offset:14336
  v_cvt_pk_bf16_f32 v41, v198, v199
  v_mfma_f32_16x16x32_bf16 v[132:135], v[60:63], a[108:111], v[132:135]
  v_cvt_pk_bf16_f32 v42, v204, v205
  v_cvt_pk_bf16_f32 v43, v206, v207
  v_mfma_f32_16x16x32_bf16 v[132:135], v[64:67], a[128:131], v[132:135]
  v_cvt_pk_bf16_f32 v44, v212, v213
  v_cvt_pk_bf16_f32 v45, v214, v215
  v_mfma_f32_16x16x32_bf16 v[132:135], v[68:71], a[148:151], v[132:135]
  v_cvt_pk_bf16_f32 v46, v220, v221
  v_cvt_pk_bf16_f32 v47, v222, v223
  v_mfma_f32_16x16x32_bf16 v[148:151], v[56:59], a[92:95], 0
  buffer_store_dwordx4 v[36:39], v28, s[16:19], s55 offen sc1
  v_mfma_f32_16x16x32_bf16 v[148:151], v[60:63], a[112:115], v[148:151]
  v_cvt_pk_bf16_f32 v48, v228, v229
  v_cvt_pk_bf16_f32 v49, v230, v231
  v_mfma_f32_16x16x32_bf16 v[148:151], v[64:67], a[132:135], v[148:151]
  v_cvt_pk_bf16_f32 v50, v236, v237
  v_cvt_pk_bf16_f32 v51, v238, v239
  v_mfma_f32_16x16x32_bf16 v[148:151], v[68:71], a[152:155], v[148:151]
  v_cvt_pk_bf16_f32 v52, v244, v245
  v_cvt_pk_bf16_f32 v53, v246, v247
  v_mfma_f32_16x16x32_bf16 v[164:167], v[56:59], a[96:99], 0
  v_cvt_pk_bf16_f32 v54, v252, v253
  v_cvt_pk_bf16_f32 v55, v254, v255
  v_mfma_f32_16x16x32_bf16 v[164:167], v[60:63], a[116:119], v[164:167]
  ds_read_b64_tr_b16 v[56:57], v26 offset:0
  v_mfma_f32_16x16x32_bf16 v[164:167], v[64:67], a[136:139], v[164:167]
  buffer_store_dwordx4 v[40:43], v28, s[16:19], s55 offen offset:1024 sc1
  v_mfma_f32_16x16x32_bf16 v[164:167], v[68:71], a[156:159], v[164:167]
  ds_read_b64_tr_b16 v[58:59], v26 offset:2048
  v_mfma_f32_16x16x32_bf16 v[108:111], v[72:75], a[80:83], 0
  ds_read_b64_tr_b16 v[60:61], v26 offset:4096
  v_mfma_f32_16x16x32_bf16 v[108:111], v[76:79], a[100:103], v[108:111]
  ds_read_b64_tr_b16 v[62:63], v26 offset:6144
  v_mfma_f32_16x16x32_bf16 v[108:111], v[80:83], a[120:123], v[108:111]
  ds_read_b64_tr_b16 v[64:65], v26 offset:8192
  v_mfma_f32_16x16x32_bf16 v[108:111], v[84:87], a[140:143], v[108:111]
  ds_read_b64_tr_b16 v[66:67], v26 offset:10240
  v_mfma_f32_16x16x32_bf16 v[124:127], v[72:75], a[84:87], 0
  buffer_store_dwordx4 v[44:47], v28, s[16:19], s55 offen offset:2048 sc1
  v_mfma_f32_16x16x32_bf16 v[124:127], v[76:79], a[104:107], v[124:127]
  ds_read_b64_tr_b16 v[68:69], v26 offset:12288
  v_mfma_f32_16x16x32_bf16 v[124:127], v[80:83], a[124:127], v[124:127]
  ds_read_b64_tr_b16 v[70:71], v26 offset:14336
  v_mfma_f32_16x16x32_bf16 v[124:127], v[84:87], a[144:147], v[124:127]
  v_mfma_f32_16x16x32_bf16 v[140:143], v[72:75], a[88:91], 0
  v_mfma_f32_16x16x32_bf16 v[140:143], v[76:79], a[108:111], v[140:143]
  v_mfma_f32_16x16x32_bf16 v[140:143], v[80:83], a[128:131], v[140:143]
  buffer_store_dwordx4 v[48:51], v28, s[16:19], s55 offen offset:3072 sc1
  v_mfma_f32_16x16x32_bf16 v[140:143], v[84:87], a[148:151], v[140:143]
  v_mfma_f32_16x16x32_bf16 v[156:159], v[72:75], a[92:95], 0
  v_mfma_f32_16x16x32_bf16 v[156:159], v[76:79], a[112:115], v[156:159]
  v_mfma_f32_16x16x32_bf16 v[156:159], v[80:83], a[132:135], v[156:159]
  v_mfma_f32_16x16x32_bf16 v[156:159], v[84:87], a[152:155], v[156:159]
  v_mfma_f32_16x16x32_bf16 v[172:175], v[72:75], a[96:99], 0
  buffer_store_dwordx4 v[52:55], v29, s[16:19], s55 offen sc1
  s_add_u32 s52, s52, 128
  s_and_b32 s52, s52, 0x3ff
  v_mfma_f32_16x16x32_bf16 v[172:175], v[76:79], a[116:119], v[172:175]
  s_mov_b32 s55, s53
  v_mfma_f32_16x16x32_bf16 v[172:175], v[80:83], a[136:139], v[172:175]
  s_waitcnt lgkmcnt(0)
  v_mfma_f32_16x16x32_bf16 v[172:175], v[84:87], a[156:159], v[172:175]
  v_mfma_f32_16x16x32_bf16 v[100:103], v[56:59], a[160:163], v[100:103]
  s_waitcnt vmcnt(6)
  s_barrier
  v_mfma_f32_16x16x32_bf16 v[100:103], v[60:63], a[180:183], v[100:103]
  ds_read_b64_tr_b16 v[72:73], v25 offset:32768
  v_mfma_f32_16x16x32_bf16 v[100:103], v[64:67], a[200:203], v[100:103]
  s_add_u32 s35, s52, 0
  s_add_u32 m0, s31, 0
  ds_read_b64_tr_b16 v[74:75], v25 offset:34816
  v_mfma_f32_16x16x32_bf16 v[100:103], v[68:71], a[220:223], v[100:103]
  buffer_load_dwordx4 v17, s[12:15], s35 offen lds
  v_mfma_f32_16x16x32_bf16 v[116:119], v[56:59], a[164:167], v[116:119]
  ds_read_b64_tr_b16 v[76:77], v25 offset:36864
  v_mfma_f32_16x16x32_bf16 v[116:119], v[60:63], a[184:187], v[116:119]
  ds_read_b64_tr_b16 v[78:79], v25 offset:38912
  v_mfma_f32_16x16x32_bf16 v[116:119], v[64:67], a[204:207], v[116:119]
  ds_read_b64_tr_b16 v[80:81], v25 offset:40960
  v_mfma_f32_16x16x32_bf16 v[116:119], v[68:71], a[224:227], v[116:119]
  buffer_load_dwordx4 v18, s[12:15], s35 offen offset:1024 lds
  v_mfma_f32_16x16x32_bf16 v[132:135], v[56:59], a[168:171], v[132:135]
  ds_read_b64_tr_b16 v[82:83], v25 offset:43008
  v_mfma_f32_16x16x32_bf16 v[132:135], v[60:63], a[188:191], v[132:135]
  ds_read_b64_tr_b16 v[84:85], v25 offset:45056
  v_mfma_f32_16x16x32_bf16 v[132:135], v[64:67], a[208:211], v[132:135]
  ds_read_b64_tr_b16 v[86:87], v25 offset:47104
  v_mfma_f32_16x16x32_bf16 v[132:135], v[68:71], a[228:231], v[132:135]
  buffer_load_dwordx4 v19, s[12:15], s35 offen offset:2048 lds
  v_mfma_f32_16x16x32_bf16 v[148:151], v[56:59], a[172:175], v[148:151]
  v_mfma_f32_16x16x32_bf16 v[148:151], v[60:63], a[192:195], v[148:151]
  v_mfma_f32_16x16x32_bf16 v[148:151], v[64:67], a[212:215], v[148:151]
  v_mfma_f32_16x16x32_bf16 v[148:151], v[68:71], a[232:235], v[148:151]
  buffer_load_dwordx4 v20, s[12:15], s35 offen offset:3072 lds
  v_mfma_f32_16x16x32_bf16 v[164:167], v[56:59], a[176:179], v[164:167]
  v_mfma_f32_16x16x32_bf16 v[164:167], v[60:63], a[196:199], v[164:167]
  ds_read_b64_tr_b16 v[56:57], v24 offset:32768
  v_mfma_f32_16x16x32_bf16 v[164:167], v[64:67], a[216:219], v[164:167]
  s_add_u32 s35, s52, 131072
  s_add_u32 m0, s31, 16384
  ds_read_b64_tr_b16 v[58:59], v24 offset:34816
  v_mfma_f32_16x16x32_bf16 v[164:167], v[68:71], a[236:239], v[164:167]
  buffer_load_dwordx4 v17, s[12:15], s35 offen lds
  v_mfma_f32_16x16x32_bf16 v[108:111], v[88:91], a[160:163], v[108:111]
  ds_read_b64_tr_b16 v[60:61], v24 offset:36864
  v_mfma_f32_16x16x32_bf16 v[108:111], v[92:95], a[180:183], v[108:111]
  ds_read_b64_tr_b16 v[62:63], v24 offset:38912
  v_mfma_f32_16x16x32_bf16 v[108:111], v[6:9], a[200:203], v[108:111]
  ds_read_b64_tr_b16 v[64:65], v24 offset:40960
  v_mfma_f32_16x16x32_bf16 v[108:111], v[10:13], a[220:223], v[108:111]
  buffer_load_dwordx4 v18, s[12:15], s35 offen offset:1024 lds
  v_mfma_f32_16x16x32_bf16 v[124:127], v[88:91], a[164:167], v[124:127]
  ds_read_b64_tr_b16 v[66:67], v24 offset:43008
  v_mfma_f32_16x16x32_bf16 v[124:127], v[92:95], a[184:187], v[124:127]
  ds_read_b64_tr_b16 v[68:69], v24 offset:45056
  v_mfma_f32_16x16x32_bf16 v[124:127], v[6:9], a[204:207], v[124:127]
  ds_read_b64_tr_b16 v[70:71], v24 offset:47104
  v_mfma_f32_16x16x32_bf16 v[124:127], v[10:13], a[224:227], v[124:127]
  buffer_load_dwordx4 v19, s[12:15], s35 offen offset:2048 lds
  v_mfma_f32_16x16x32_bf16 v[140:143], v[88:91], a[168:171], v[140:143]
  v_mfma_f32_16x16x32_bf16 v[140:143], v[92:95], a[188:191], v[140:143]
  v_mfma_f32_16x16x32_bf16 v[140:143], v[6:9], a[208:211], v[140:143]
  v_mfma_f32_16x16x32_bf16 v[140:143], v[10:13], a[228:231], v[140:143]
  buffer_load_dwordx4 v20, s[12:15], s35 offen offset:3072 lds
  v_mfma_f32_16x16x32_bf16 v[156:159], v[88:91], a[172:175], v[156:159]
  v_mfma_f32_16x16x32_bf16 v[156:159], v[92:95], a[192:195], v[156:159]
  v_mfma_f32_16x16x32_bf16 v[156:159], v[6:9], a[212:215], v[156:159]
  v_mfma_f32_16x16x32_bf16 v[156:159], v[10:13], a[232:235], v[156:159]
  v_mfma_f32_16x16x32_bf16 v[172:175], v[88:91], a[176:179], v[172:175]
  v_mfma_f32_16x16x32_bf16 v[172:175], v[92:95], a[196:199], v[172:175]
  v_mfma_f32_16x16x32_bf16 v[172:175], v[6:9], a[216:219], v[172:175]
  s_waitcnt lgkmcnt(0)
  v_mfma_f32_16x16x32_bf16 v[172:175], v[10:13], a[236:239], v[172:175]
  v_mfma_f32_16x16x32_bf16 v[100:103], v[56:59], v[96:99], v[100:103]
  s_waitcnt vmcnt(13)
  v_cmp_eq_u32 vcc, v30, v31
  v_mfma_f32_16x16x32_bf16 v[100:103], v[60:63], v[136:139], v[100:103]
  v_mfma_f32_16x16x32_bf16 v[100:103], v[64:67], v[176:179], v[100:103]
  s_and_b32 s48, vcc_lo, s57
  s_cmp_eq_u32 s48, s57
  s_cbranch_scc0 L_spinL0
L_gotL0:
  v_mfma_f32_16x16x32_bf16 v[100:103], v[68:71], v[216:219], v[100:103]
  s_mov_b32 m0, s59
  ds_read_b64_tr_b16 v[88:89], v27 offset:32768
  v_mfma_f32_16x16x32_bf16 v[116:119], v[56:59], v[104:107], v[116:119]
  buffer_load_dwordx4 v28, s[16:19], s58 offen sc1 lds
  v_mfma_f32_16x16x32_bf16 v[116:119], v[60:63], v[144:147], v[116:119]
  ds_read_b64_tr_b16 v[90:91], v27 offset:34816
  v_mfma_f32_16x16x32_bf16 v[116:119], v[64:67], v[184:187], v[116:119]
  ds_read_b64_tr_b16 v[92:93], v27 offset:36864
  v_mfma_f32_16x16x32_bf16 v[116:119], v[68:71], v[224:227], v[116:119]
  ds_read_b64_tr_b16 v[94:95], v27 offset:38912
  v_mfma_f32_16x16x32_bf16 v[132:135], v[56:59], v[112:115], v[132:135]
  buffer_load_dwordx4 v28, s[16:19], s58 offen offset:1024 sc1 lds
  v_mfma_f32_16x16x32_bf16 v[132:135], v[60:63], v[152:155], v[132:135]
  ds_read_b64_tr_b16 v[6:7], v27 offset:40960
  v_mfma_f32_16x16x32_bf16 v[132:135], v[64:67], v[192:195], v[132:135]
  ds_read_b64_tr_b16 v[8:9], v27 offset:43008
  v_mfma_f32_16x16x32_bf16 v[132:135], v[68:71], v[232:235], v[132:135]
  ds_read_b64_tr_b16 v[10:11], v27 offset:45056
  v_mfma_f32_16x16x32_bf16 v[148:151], v[56:59], v[120:123], v[148:151]
  buffer_load_dwordx4 v28, s[16:19], s58 offen offset:2048 sc1 lds
  v_mfma_f32_16x16x32_bf16 v[148:151], v[60:63], v[160:163], v[148:151]
  ds_read_b64_tr_b16 v[12:13], v27 offset:47104
  v_mfma_f32_16x16x32_bf16 v[148:151], v[64:67], v[200:203], v[148:151]
  v_mfma_f32_16x16x32_bf16 v[148:151], v[68:71], v[240:243], v[148:151]
  v_mfma_f32_16x16x32_bf16 v[164:167], v[56:59], v[128:131], v[164:167]
  buffer_load_dwordx4 v28, s[16:19], s58 offen offset:3072 sc1 lds
  v_mfma_f32_16x16x32_bf16 v[164:167], v[60:63], v[168:171], v[164:167]
  ds_read_b64_tr_b16 v[56:57], v26 offset:32768
  v_mfma_f32_16x16x32_bf16 v[164:167], v[64:67], v[208:211], v[164:167]
  ds_read_b64_tr_b16 v[58:59], v26 offset:34816
  v_mfma_f32_16x16x32_bf16 v[164:167], v[68:71], v[248:251], v[164:167]
  s_add_u32 m0, s59, 4096
  ds_read_b64_tr_b16 v[60:61], v26 offset:36864
  v_mfma_f32_16x16x32_bf16 v[108:111], v[72:75], v[96:99], v[108:111]
  buffer_load_dwordx4 v29, s[16:19], s58 offen sc1 lds
  v_mfma_f32_16x16x32_bf16 v[108:111], v[76:79], v[136:139], v[108:111]
  ds_read_b64_tr_b16 v[62:63], v26 offset:38912
  v_mfma_f32_16x16x32_bf16 v[108:111], v[80:83], v[176:179], v[108:111]
  ds_read_b64_tr_b16 v[64:65], v26 offset:40960
  v_mfma_f32_16x16x32_bf16 v[108:111], v[84:87], v[216:219], v[108:111]
  ds_read_b64_tr_b16 v[66:67], v26 offset:43008
  v_mfma_f32_16x16x32_bf16 v[124:127], v[72:75], v[104:107], v[124:127]
  ds_read_b64_tr_b16 v[68:69], v26 offset:45056
  v_mfma_f32_16x16x32_bf16 v[124:127], v[76:79], v[144:147], v[124:127]
  ds_read_b64_tr_b16 v[70:71], v26 offset:47104
  v_mfma_f32_16x16x32_bf16 v[124:127], v[80:83], v[184:187], v[124:127]
  v_mfma_f32_16x16x32_bf16 v[124:127], v[84:87], v[224:227], v[124:127]
  v_mfma_f32_16x16x32_bf16 v[140:143], v[72:75], v[112:115], v[140:143]
  v_mfma_f32_16x16x32_bf16 v[140:143], v[76:79], v[152:155], v[140:143]
  v_mfma_f32_16x16x32_bf16 v[140:143], v[80:83], v[192:195], v[140:143]
  v_mfma_f32_16x16x32_bf16 v[140:143], v[84:87], v[232:235], v[140:143]
  v_mfma_f32_16x16x32_bf16 v[156:159], v[72:75], v[120:123], v[156:159]
  s_lshl_b32 s57, s57, 1
  s_cmp_eq_u32 s47, 0
  s_cselect_b32 s57, 1, s57
  v_mfma_f32_16x16x32_bf16 v[156:159], v[76:79], v[160:163], v[156:159]
  s_cselect_b32 s48, s46, 20480
  s_cselect_b32 s49, 0, 20480
  s_add_u32 s58, s58, s48
  v_mfma_f32_16x16x32_bf16 v[156:159], v[80:83], v[200:203], v[156:159]
  s_cmp_lt_i32 s47, 1
  s_cselect_b32 s49, s49, 0
  s_add_u32 s59, s59, s49
  v_mfma_f32_16x16x32_bf16 v[156:159], v[84:87], v[240:243], v[156:159]
  s_sub_u32 s47, s47, 1
  v_mfma_f32_16x16x32_bf16 v[172:175], v[72:75], v[128:131], v[172:175]
  v_mfma_f32_16x16x32_bf16 v[172:175], v[76:79], v[168:171], v[172:175]
  v_mfma_f32_16x16x32_bf16 v[172:175], v[80:83], v[208:211], v[172:175]
  s_waitcnt lgkmcnt(0)
  v_mfma_f32_16x16x32_bf16 v[172:175], v[84:87], v[248:251], v[172:175]
  v_mfma_f32_16x16x32_bf16 v[100:103], v[56:59], a[0:3], v[100:103]
  s_waitcnt vmcnt(5)
  s_barrier
  v_mfma_f32_16x16x32_bf16 v[100:103], v[60:63], a[20:23], v[100:103]
  buffer_store_dword v31, v32, s[20:23], s56 offen sc1
  v_mfma_f32_16x16x32_bf16 v[100:103], v[64:67], a[40:43], v[100:103]
  s_add_u32 s35, s52, 262144
  s_add_u32 m0, s31, 32768
  ds_read_b64_tr_b16 v[72:73], v25 offset:0
  v_mfma_f32_16x16x32_bf16 v[100:103], v[68:71], a[60:63], v[100:103]
  buffer_load_dwordx4 v17, s[12:15], s35 offen lds
  v_mfma_f32_16x16x32_bf16 v[116:119], v[56:59], a[4:7], v[116:119]
  ds_read_b64_tr_b16 v[74:75], v25 offset:2048
  v_mfma_f32_16x16x32_bf16 v[116:119], v[60:63], a[24:27], v[116:119]
  ds_read_b64_tr_b16 v[76:77], v25 offset:4096
  v_mfma_f32_16x16x32_bf16 v[116:119], v[64:67], a[44:47], v[116:119]
  ds_read_b64_tr_b16 v[78:79], v25 offset:6144
  v_mfma_f32_16x16x32_bf16 v[116:119], v[68:71], a[64:67], v[116:119]
  buffer_load_dwordx4 v18, s[12:15], s35 offen offset:1024 lds
  v_mfma_f32_16x16x32_bf16 v[132:135], v[56:59], a[8:11], v[132:135]
  ds_read_b64_tr_b16 v[80:81], v25 offset:8192
  v_mfma_f32_16x16x32_bf16 v[132:135], v[60:63], a[28:31], v[132:135]
  ds_read_b64_tr_b16 v[82:83], v25 offset:10240
  v_mfma_f32_16x16x32_bf16 v[132:135], v[64:67], a[48:51], v[132:135]
  ds_read_b64_tr_b16 v[84:85], v25 offset:12288
  v_mfma_f32_16x16x32_bf16 v[132:135], v[68:71], a[68:71], v[132:135]
  buffer_load_dwordx4 v19, s[12:15], s35 offen offset:2048 lds
  v_mfma_f32_16x16x32_bf16 v[148:151], v[56:59], a[12:15], v[148:151]
  ds_read_b64_tr_b16 v[86:87], v25 offset:14336
  v_mfma_f32_16x16x32_bf16 v[148:151], v[60:63], a[32:35], v[148:151]
  v_mfma_f32_16x16x32_bf16 v[148:151], v[64:67], a[52:55], v[148:151]
  v_mfma_f32_16x16x32_bf16 v[148:151], v[68:71], a[72:75], v[148:151]
  buffer_load_dwordx4 v20, s[12:15], s35 offen offset:3072 lds
  v_mfma_f32_16x16x32_bf16 v[164:167], v[56:59], a[16:19], v[164:167]
  v_mfma_f32_16x16x32_bf16 v[164:167], v[60:63], a[36:39], v[164:167]
  ds_read_b64_tr_b16 v[56:57], v24 offset:0
  v_mfma_f32_16x16x32_bf16 v[164:167], v[64:67], a[56:59], v[164:167]
  s_add_u32 s35, s52, 393216
  s_add_u32 m0, s31, 49152
  ds_read_b64_tr_b16 v[58:59], v24 offset:2048
  v_mfma_f32_16x16x32_bf16 v[164:167], v[68:71], a[76:79], v[164:167]
  buffer_load_dwordx4 v17, s[12:15], s35 offen lds
  v_mfma_f32_16x16x32_bf16 v[108:111], v[88:91], a[0:3], v[108:111]
  ds_read_b64_tr_b16 v[60:61], v24 offset:4096
  v_mfma_f32_16x16x32_bf16 v[108:111], v[92:95], a[20:23], v[108:111]
  ds_read_b64_tr_b16 v[62:63], v24 offset:6144
  v_mfma_f32_16x16x32_bf16 v[108:111], v[6:9], a[40:43], v[108:111]
  ds_read_b64_tr_b16 v[64:65], v24 offset:8192
  v_mfma_f32_16x16x32_bf16 v[108:111], v[10:13], a[60:63], v[108:111]
  buffer_load_dwordx4 v18, s[12:15], s35 offen offset:1024 lds
  v_mfma_f32_16x16x32_bf16 v[124:127], v[88:91], a[4:7], v[124:127]
  ds_read_b64_tr_b16 v[66:67], v24 offset:10240
  v_mfma_f32_16x16x32_bf16 v[124:127], v[92:95], a[24:27], v[124:127]
  ds_read_b64_tr_b16 v[68:69], v24 offset:12288
  v_mfma_f32_16x16x32_bf16 v[124:127], v[6:9], a[44:47], v[124:127]
  ds_read_b64_tr_b16 v[70:71], v24 offset:14336
  v_mfma_f32_16x16x32_bf16 v[124:127], v[10:13], a[64:67], v[124:127]
  buffer_load_dwordx4 v19, s[12:15], s35 offen offset:2048 lds
  v_mfma_f32_16x16x32_bf16 v[140:143], v[88:91], a[8:11], v[140:143]
  v_mfma_f32_16x16x32_bf16 v[140:143], v[92:95], a[28:31], v[140:143]
  v_mfma_f32_16x16x32_bf16 v[140:143], v[6:9], a[48:51], v[140:143]
  v_mfma_f32_16x16x32_bf16 v[140:143], v[10:13], a[68:71], v[140:143]
  buffer_load_dwordx4 v20, s[12:15], s35 offen offset:3072 lds
  v_mfma_f32_16x16x32_bf16 v[156:159], v[88:91], a[12:15], v[156:159]
  v_mfma_f32_16x16x32_bf16 v[156:159], v[92:95], a[32:35], v[156:159]
  v_mfma_f32_16x16x32_bf16 v[156:159], v[6:9], a[52:55], v[156:159]
  s_add_u32 s39, s39, 1
  v_mfma_f32_16x16x32_bf16 v[156:159], v[10:13], a[72:75], v[156:159]
  s_mov_b32 s56, s54
  s_add_u32 s54, s54, 132
  s_add_u32 s53, s53, 163840
  v_mfma_f32_16x16x32_bf16 v[172:175], v[88:91], a[16:19], v[172:175]
  s_cmp_ge_u32 s54, 1024
  s_cselect_b32 s48, 1024, 0
  s_cselect_b32 s49, 1146880, 0
  v_mfma_f32_16x16x32_bf16 v[172:175], v[92:95], a[36:39], v[172:175]
  s_sub_u32 s54, s54, s48
  s_sub_u32 s53, s53, s49
  v_mfma_f32_16x16x32_bf16 v[172:175], v[6:9], a[56:59], v[172:175]
  s_waitcnt lgkmcnt(0)
  s_cmp_lt_u32 s39, 3
  v_mfma_f32_16x16x32_bf16 v[172:175], v[10:13], a[76:79], v[172:175]
  s_cbranch_scc1 L_oloop
  v_mfma_f32_16x16x32_bf16 v[180:183], v[56:59], a[80:83], 0
  buffer_load_dword v30, v33, s[20:23], 0 offen sc1
  v_mfma_f32_16x16x32_bf16 v[180:183], v[60:63], a[100:103], v[180:183]
  ds_read_b64_tr_b16 v[88:89], v27 offset:0
  v_mfma_f32_16x16x32_bf16 v[180:183], v[64:67], a[120:123], v[180:183]
  ds_read_b64_tr_b16 v[90:91], v27 offset:2048
  v_mfma_f32_16x16x32_bf16 v[180:183], v[68:71], a[140:143], v[180:183]
  ds_read_b64_tr_b16 v[92:93], v27 offset:4096
  v_cvt_pk_bf16_f32 v36, v100, v101
  v_mfma_f32_16x16x32_bf16 v[196:199], v[56:59], a[84:87], 0
  ds_read_b64_tr_b16 v[94:95], v27 offset:6144
  v_cvt_pk_bf16_f32 v37, v102, v103
  v_mfma_f32_16x16x32_bf16 v[196:199], v[60:63], a[104:107], v[196:199]
  ds_read_b64_tr_b16 v[6:7], v27 offset:8192
  v_cvt_pk_bf16_f32 v38, v108, v109
  v_mfma_f32_16x16x32_bf16 v[196:199], v[64:67], a[124:127], v[196:199]
  ds_read_b64_tr_b16 v[8:9], v27 offset:10240
  v_cvt_pk_bf16_f32 v39, v110, v111
  v_mfma_f32_16x16x32_bf16 v[196:199], v[68:71], a[144:147], v[196:199]
  ds_read_b64_tr_b16 v[10:11], v27 offset:12288
  v_cvt_pk_bf16_f32 v40, v116, v117
  v_mfma_f32_16x16x32_bf16 v[212:215], v[56:59], a[88:91], 0
  ds_read_b64_tr_b16 v[12:13], v27 offset:14336
  v_cvt_pk_bf16_f32 v41, v118, v119
  v_mfma_f32_16x16x32_bf16 v[212:215], v[60:63], a[108:111], v[212:215]
  v_cvt_pk_bf16_f32 v42, v124, v125
  v_cvt_pk_bf16_f32 v43, v126, v127
  v_mfma_f32_16x16x32_bf16 v[212:215], v[64:67], a[128:131], v[212:215]
  v_cvt_pk_bf16_f32 v44, v132, v133
  v_cvt_pk_bf16_f32 v45, v134, v135
  v_mfma_f32_16x16x32_bf16 v[212:215], v[68:71], a[148:151], v[212:215]
  buffer_store_dwordx4 v[36:39], v28, s[16:19], s55 offen sc1
  v_mfma_f32_16x16x32_bf16 v[228:231], v[56:59], a[92:95], 0
  v_cvt_pk_bf16_f32 v46, v140, v141
  v_cvt_pk_bf16_f32 v47, v142, v143
  v_mfma_f32_16x16x32_bf16 v[228:231], v[60:63], a[112:115], v[228:231]
  v_cvt_pk_bf16_f32 v48, v148, v149
  v_cvt_pk_bf16_f32 v49, v150, v151
  v_mfma_f32_16x16x32_bf16 v[228:231], v[64:67], a[132:135], v[228:231]
  buffer_store_dwordx4 v[40:43], v28, s[16:19], s55 offen offset:1024 sc1
  v_mfma_f32_16x16x32_bf16 v[228:231], v[68:71], a[152:155], v[228:231]
  v_cvt_pk_bf16_f32 v50, v156, v157
  v_cvt_pk_bf16_f32 v51, v158, v159
  v_mfma_f32_16x16x32_bf16 v[244:247], v[56:59], a[96:99], 0
  v_cvt_pk_bf16_f32 v52, v164, v165
  v_cvt_pk_bf16_f32 v53, v166, v167
  v_mfma_f32_16x16x32_bf16 v[244:247], v[60:63], a[116:119], v[244:247]
  buffer_store_dwordx4 v[44:47], v28, s[16:19], s55 offen offset:2048 sc1
  v_mfma_f32_16x16x32_bf16 v[244:247], v[64:67], a[136:139], v[244:247]
  ds_read_b64_tr_b16 v[56:57], v26 offset:0
  v_cvt_pk_bf16_f32 v54, v172, v173
  v_mfma_f32_16x16x32_bf16 v[244:247], v[68:71], a[156:159], v[244:247]
  ds_read_b64_tr_b16 v[58:59], v26 offset:2048
  v_cvt_pk_bf16_f32 v55, v174, v175
  v_mfma_f32_16x16x32_bf16 v[188:191], v[72:75], a[80:83], 0
  buffer_store_dwordx4 v[48:51], v28, s[16:19], s55 offen offset:3072 sc1
  v_mfma_f32_16x16x32_bf16 v[188:191], v[76:79], a[100:103], v[188:191]
  ds_read_b64_tr_b16 v[60:61], v26 offset:4096
  v_mfma_f32_16x16x32_bf16 v[188:191], v[80:83], a[120:123], v[188:191]
  ds_read_b64_tr_b16 v[62:63], v26 offset:6144
  v_mfma_f32_16x16x32_bf16 v[188:191], v[84:87], a[140:143], v[188:191]
  buffer_store_dwordx4 v[52:55], v29, s[16:19], s55 offen sc1
  v_mfma_f32_16x16x32_bf16 v[204:207], v[72:75], a[84:87], 0
  ds_read_b64_tr_b16 v[64:65], v26 offset:8192
  v_mfma_f32_16x16x32_bf16 v[204:207], v[76:79], a[104:107], v[204:207]
  ds_read_b64_tr_b16 v[66:67], v26 offset:10240
  v_mfma_f32_16x16x32_bf16 v[204:207], v[80:83], a[124:127], v[204:207]
  ds_read_b64_tr_b16 v[68:69], v26 offset:12288
  v_mfma_f32_16x16x32_bf16 v[204:207], v[84:87], a[144:147], v[204:207]
  ds_read_b64_tr_b16 v[70:71], v26 offset:14336
  v_mfma_f32_16x16x32_bf16 v[220:223], v[72:75], a[88:91], 0
  v_mfma_f32_16x16x32_bf16 v[220:223], v[76:79], a[108:111], v[220:223]
  v_mfma_f32_16x16x32_bf16 v[220:223], v[80:83], a[128:131], v[220:223]
  v_mfma_f32_16x16x32_bf16 v[220:223], v[84:87], a[148:151], v[220:223]
  v_mfma_f32_16x16x32_bf16 v[236:239], v[72:75], a[92:95], 0
  v_mfma_f32_16x16x32_bf16 v[236:239], v[76:79], a[112:115], v[236:239]
  v_mfma_f32_16x16x32_bf16 v[236:239], v[80:83], a[132:135], v[236:239]
  v_mfma_f32_16x16x32_bf16 v[236:239], v[84:87], a[152:155], v[236:239]
  v_mfma_f32_16x16x32_bf16 v[252:255], v[72:75], a[96:99], 0
  v_mfma_f32_16x16x32_bf16 v[252:255], v[76:79], a[116:119], v[252:255]
  v_add_u32 v34, 65792, v28
  v_add_u32 v35, 127232, v28
  v_mfma_f32_16x16x32_bf16 v[252:255], v[80:83], a[136:139], v[252:255]
  s_waitcnt lgkmcnt(0)
  v_mfma_f32_16x16x32_bf16 v[252:255], v[84:87], a[156:159], v[252:255]
  v_mfma_f32_16x16x32_bf16 v[180:183], v[56:59], a[160:163], v[180:183]
  s_waitcnt vmcnt(6)
  s_barrier
  v_mfma_f32_16x16x32_bf16 v[180:183], v[60:63], a[180:183], v[180:183]
  ds_read_b64_tr_b16 v[72:73], v25 offset:32768
  v_mfma_f32_16x16x32_bf16 v[180:183], v[64:67], a[200:203], v[180:183]
  ds_read_b64_tr_b16 v[74:75], v25 offset:34816
  v_mfma_f32_16x16x32_bf16 v[180:183], v[68:71], a[220:223], v[180:183]
  ds_read_b64_tr_b16 v[76:77], v25 offset:36864
  v_mfma_f32_16x16x32_bf16 v[196:199], v[56:59], a[164:167], v[196:199]
  ds_read_b64_tr_b16 v[78:79], v25 offset:38912
  v_mfma_f32_16x16x32_bf16 v[196:199], v[60:63], a[184:187], v[196:199]
  ds_read_b64_tr_b16 v[80:81], v25 offset:40960
  v_mfma_f32_16x16x32_bf16 v[196:199], v[64:67], a[204:207], v[196:199]
  ds_read_b64_tr_b16 v[82:83], v25 offset:43008
  v_mfma_f32_16x16x32_bf16 v[196:199], v[68:71], a[224:227], v[196:199]
  ds_read_b64_tr_b16 v[84:85], v25 offset:45056
  v_mfma_f32_16x16x32_bf16 v[212:215], v[56:59], a[168:171], v[212:215]
  ds_read_b64_tr_b16 v[86:87], v25 offset:47104
  v_mfma_f32_16x16x32_bf16 v[212:215], v[60:63], a[188:191], v[212:215]
  ds_read_b128 a[80:83], v34 offset:0
  v_mfma_f32_16x16x32_bf16 v[212:215], v[64:67], a[208:211], v[212:215]
  ds_read_b128 a[84:87], v34 offset:1024
  v_mfma_f32_16x16x32_bf16 v[212:215], v[68:71], a[228:231], v[212:215]
  ds_read_b128 a[88:91], v34 offset:2048
  v_mfma_f32_16x16x32_bf16 v[228:231], v[56:59], a[172:175], v[228:231]
  ds_read_b128 a[92:95], v34 offset:3072
  v_mfma_f32_16x16x32_bf16 v[228:231], v[60:63], a[192:195], v[228:231]
  ds_read_b128 a[96:99], v34 offset:4096
  v_mfma_f32_16x16x32_bf16 v[228:231], v[64:67], a[212:215], v[228:231]
  ds_read_b128 a[100:103], v34 offset:20480
  v_mfma_f32_16x16x32_bf16 v[228:231], v[68:71], a[232:235], v[228:231]
  ds_read_b128 a[104:107], v34 offset:21504
  v_mfma_f32_16x16x32_bf16 v[244:247], v[56:59], a[176:179], v[244:247]
  ds_read_b128 a[108:111], v34 offset:22528
  v_mfma_f32_16x16x32_bf16 v[244:247], v[60:63], a[196:199], v[244:247]
  ds_read_b64_tr_b16 v[56:57], v24 offset:32768
  v_mfma_f32_16x16x32_bf16 v[244:247], v[64:67], a[216:219], v[244:247]
  ds_read_b64_tr_b16 v[58:59], v24 offset:34816
  v_mfma_f32_16x16x32_bf16 v[244:247], v[68:71], a[236:239], v[244:247]
  ds_read_b64_tr_b16 v[60:61], v24 offset:36864
  v_mfma_f32_16x16x32_bf16 v[188:191], v[88:91], a[160:163], v[188:191]
  ds_read_b64_tr_b16 v[62:63], v24 offset:38912
  v_mfma_f32_16x16x32_bf16 v[188:191], v[92:95], a[180:183], v[188:191]
  ds_read_b64_tr_b16 v[64:65], v24 offset:40960
  v_mfma_f32_16x16x32_bf16 v[188:191], v[6:9], a[200:203], v[188:191]
  ds_read_b64_tr_b16 v[66:67], v24 offset:43008
  v_mfma_f32_16x16x32_bf16 v[188:191], v[10:13], a[220:223], v[188:191]
  ds_read_b64_tr_b16 v[68:69], v24 offset:45056
  v_mfma_f32_16x16x32_bf16 v[204:207], v[88:91], a[164:167], v[204:207]
  ds_read_b64_tr_b16 v[70:71], v24 offset:47104
  v_mfma_f32_16x16x32_bf16 v[204:207], v[92:95], a[184:187], v[204:207]
  s_waitcnt vmcnt(0)
  v_mfma_f32_16x16x32_bf16 v[204:207], v[6:9], a[204:207], v[204:207]
  buffer_store_dword v31, v32, s[20:23], s56 offen sc1
  v_mfma_f32_16x16x32_bf16 v[204:207], v[10:13], a[224:227], v[204:207]
  ds_read_b128 a[112:115], v34 offset:23552
  v_mfma_f32_16x16x32_bf16 v[220:223], v[88:91], a[168:171], v[220:223]
  ds_read_b128 a[116:119], v34 offset:24576
  v_mfma_f32_16x16x32_bf16 v[220:223], v[92:95], a[188:191], v[220:223]
  ds_read_b128 a[120:123], v34 offset:40960
  v_mfma_f32_16x16x32_bf16 v[220:223], v[6:9], a[208:211], v[220:223]
  ds_read_b128 a[124:127], v34 offset:41984
  v_mfma_f32_16x16x32_bf16 v[220:223], v[10:13], a[228:231], v[220:223]
  ds_read_b128 a[128:131], v34 offset:43008
  v_mfma_f32_16x16x32_bf16 v[236:239], v[88:91], a[172:175], v[236:239]
  ds_read_b128 a[132:135], v34 offset:44032
  v_mfma_f32_16x16x32_bf16 v[236:239], v[92:95], a[192:195], v[236:239]
  ds_read_b128 a[136:139], v34 offset:45056
  v_mfma_f32_16x16x32_bf16 v[236:239], v[6:9], a[212:215], v[236:239]
  ds_read_b128 a[140:143], v35 offset:0
  v_mfma_f32_16x16x32_bf16 v[236:239], v[10:13], a[232:235], v[236:239]
  ds_read_b128 a[144:147], v35 offset:1024
  v_mfma_f32_16x16x32_bf16 v[252:255], v[88:91], a[176:179], v[252:255]
  ds_read_b128 a[148:151], v35 offset:2048
  v_mfma_f32_16x16x32_bf16 v[252:255], v[92:95], a[196:199], v[252:255]
  ds_read_b128 a[152:155], v35 offset:3072
  v_mfma_f32_16x16x32_bf16 v[252:255], v[6:9], a[216:219], v[252:255]
  ds_read_b128 a[156:159], v35 offset:4096
  v_mfma_f32_16x16x32_bf16 v[252:255], v[10:13], a[236:239], v[252:255]
  s_waitcnt lgkmcnt(0)
  v_mfma_f32_16x16x32_bf16 v[180:183], v[56:59], v[96:99], v[180:183]
  s_waitcnt vmcnt(6)
  v_cmp_eq_u32 vcc, v30, v31
  v_mfma_f32_16x16x32_bf16 v[180:183], v[60:63], v[136:139], v[180:183]
  v_mfma_f32_16x16x32_bf16 v[180:183], v[64:67], v[176:179], v[180:183]
  s_and_b32 s48, vcc_lo, 0x10
  s_cmp_eq_u32 s48, 0x10
  s_cbranch_scc0 L_spinA
L_gotA:
  v_mfma_f32_16x16x32_bf16 v[180:183], v[68:71], v[216:219], v[180:183]
  s_add_u32 s42, s58, 0
  ds_read_b64_tr_b16 v[88:89], v27 offset:32768
  v_mfma_f32_16x16x32_bf16 v[196:199], v[56:59], v[104:107], v[196:199]
  buffer_load_dwordx4 a[160:163], v28, s[16:19], s42 offen sc1
  v_mfma_f32_16x16x32_bf16 v[196:199], v[60:63], v[144:147], v[196:199]
  ds_read_b64_tr_b16 v[90:91], v27 offset:34816
  v_mfma_f32_16x16x32_bf16 v[196:199], v[64:67], v[184:187], v[196:199]
  ds_read_b64_tr_b16 v[92:93], v27 offset:36864
  v_mfma_f32_16x16x32_bf16 v[196:199], v[68:71], v[224:227], v[196:199]
  ds_read_b64_tr_b16 v[94:95], v27 offset:38912
  v_mfma_f32_16x16x32_bf16 v[212:215], v[56:59], v[112:115], v[212:215]
  buffer_load_dwordx4 a[164:167], v28, s[16:19], s42 offen offset:1024 sc1
  v_mfma_f32_16x16x32_bf16 v[212:215], v[60:63], v[152:155], v[212:215]
  ds_read_b64_tr_b16 v[6:7], v27 offset:40960
  v_mfma_f32_16x16x32_bf16 v[212:215], v[64:67], v[192:195], v[212:215]
  ds_read_b64_tr_b16 v[8:9], v27 offset:43008
  v_mfma_f32_16x16x32_bf16 v[212:215], v[68:71], v[232:235], v[212:215]
  ds_read_b64_tr_b16 v[10:11], v27 offset:45056
  v_mfma_f32_16x16x32_bf16 v[228:231], v[56:59], v[120:123], v[228:231]
  buffer_load_dwordx4 a[168:171], v28, s[16:19], s42 offen offset:2048 sc1
  v_mfma_f32_16x16x32_bf16 v[228:231], v[60:63], v[160:163], v[228:231]
  ds_read_b64_tr_b16 v[12:13], v27 offset:47104
  v_mfma_f32_16x16x32_bf16 v[228:231], v[64:67], v[200:203], v[228:231]
  v_mfma_f32_16x16x32_bf16 v[228:231], v[68:71], v[240:243], v[228:231]
  v_mfma_f32_16x16x32_bf16 v[244:247], v[56:59], v[128:131], v[244:247]
  buffer_load_dwordx4 a[172:175], v28, s[16:19], s42 offen offset:3072 sc1
  v_mfma_f32_16x16x32_bf16 v[244:247], v[60:63], v[168:171], v[244:247]
  ds_read_b64_tr_b16 v[56:57], v26 offset:32768
  v_mfma_f32_16x16x32_bf16 v[244:247], v[64:67], v[208:211], v[244:247]
  ds_read_b64_tr_b16 v[58:59], v26 offset:34816
  v_mfma_f32_16x16x32_bf16 v[244:247], v[68:71], v[248:251], v[244:247]
  ds_read_b64_tr_b16 v[60:61], v26 offset:36864
  v_mfma_f32_16x16x32_bf16 v[188:191], v[72:75], v[96:99], v[188:191]
  buffer_load_dwordx4 a[176:179], v29, s[16:19], s42 offen sc1
  v_mfma_f32_16x16x32_bf16 v[188:191], v[76:79], v[136:139], v[188:191]
  ds_read_b64_tr_b16 v[62:63], v26 offset:38912
  v_mfma_f32_16x16x32_bf16 v[188:191], v[80:83], v[176:179], v[188:191]
  ds_read_b64_tr_b16 v[64:65], v26 offset:40960
  v_mfma_f32_16x16x32_bf16 v[188:191], v[84:87], v[216:219], v[188:191]
  ds_read_b64_tr_b16 v[66:67], v26 offset:43008
  v_mfma_f32_16x16x32_bf16 v[204:207], v[72:75], v[104:107], v[204:207]
  ds_read_b64_tr_b16 v[68:69], v26 offset:45056
  v_mfma_f32_16x16x32_bf16 v[204:207], v[76:79], v[144:147], v[204:207]
  ds_read_b64_tr_b16 v[70:71], v26 offset:47104
  v_mfma_f32_16x16x32_bf16 v[204:207], v[80:83], v[184:187], v[204:207]
  v_mfma_f32_16x16x32_bf16 v[204:207], v[84:87], v[224:227], v[204:207]
  v_mfma_f32_16x16x32_bf16 v[220:223], v[72:75], v[112:115], v[220:223]
  v_mfma_f32_16x16x32_bf16 v[220:223], v[76:79], v[152:155], v[220:223]
  v_mfma_f32_16x16x32_bf16 v[220:223], v[80:83], v[192:195], v[220:223]
  buffer_load_dword v30, v33, s[20:23], 0 offen sc1
  v_mfma_f32_16x16x32_bf16 v[220:223], v[84:87], v[232:235], v[220:223]
  v_mfma_f32_16x16x32_bf16 v[236:239], v[72:75], v[120:123], v[236:239]
  v_mfma_f32_16x16x32_bf16 v[236:239], v[76:79], v[160:163], v[236:239]
  v_mfma_f32_16x16x32_bf16 v[236:239], v[80:83], v[200:203], v[236:239]
  v_mfma_f32_16x16x32_bf16 v[236:239], v[84:87], v[240:243], v[236:239]
  v_mfma_f32_16x16x32_bf16 v[252:255], v[72:75], v[128:131], v[252:255]
  v_mfma_f32_16x16x32_bf16 v[252:255], v[76:79], v[168:171], v[252:255]
  v_mfma_f32_16x16x32_bf16 v[252:255], v[80:83], v[208:211], v[252:255]
  s_waitcnt lgkmcnt(0)
  v_mfma_f32_16x16x32_bf16 v[252:255], v[84:87], v[248:251], v[252:255]
  v_mfma_f32_16x16x32_bf16 v[180:183], v[56:59], a[0:3], v[180:183]
  v_mfma_f32_16x16x32_bf16 v[180:183], v[60:63], a[20:23], v[180:183]
  v_mfma_f32_16x16x32_bf16 v[180:183], v[64:67], a[40:43], v[180:183]
  v_mfma_f32_16x16x32_bf16 v[180:183], v[68:71], a[60:63], v[180:183]
  v_mfma_f32_16x16x32_bf16 v[196:199], v[56:59], a[4:7], v[196:199]
  v_mfma_f32_16x16x32_bf16 v[196:199], v[60:63], a[24:27], v[196:199]
  v_mfma_f32_16x16x32_bf16 v[196:199], v[64:67], a[44:47], v[196:199]
  v_mfma_f32_16x16x32_bf16 v[196:199], v[68:71], a[64:67], v[196:199]
  v_mfma_f32_16x16x32_bf16 v[212:215], v[56:59], a[8:11], v[212:215]
  v_mfma_f32_16x16x32_bf16 v[212:215], v[60:63], a[28:31], v[212:215]
  v_mfma_f32_16x16x32_bf16 v[212:215], v[64:67], a[48:51], v[212:215]
  v_mfma_f32_16x16x32_bf16 v[212:215], v[68:71], a[68:71], v[212:215]
  v_mfma_f32_16x16x32_bf16 v[228:231], v[56:59], a[12:15], v[228:231]
  v_mfma_f32_16x16x32_bf16 v[228:231], v[60:63], a[32:35], v[228:231]
  v_mfma_f32_16x16x32_bf16 v[228:231], v[64:67], a[52:55], v[228:231]
  s_waitcnt vmcnt(0)
  v_cmp_eq_u32 vcc, v30, v31
  v_mfma_f32_16x16x32_bf16 v[228:231], v[68:71], a[72:75], v[228:231]
  v_mfma_f32_16x16x32_bf16 v[244:247], v[56:59], a[16:19], v[244:247]
  s_and_b32 s48, vcc_lo, 0x60
  s_cmp_eq_u32 s48, 0x60
  s_cbranch_scc0 L_spinF
L_gotF:
  v_mfma_f32_16x16x32_bf16 v[244:247], v[60:63], a[36:39], v[244:247]
  s_add_u32 s43, s58, 20480
  v_mfma_f32_16x16x32_bf16 v[244:247], v[64:67], a[56:59], v[244:247]
  buffer_load_dwordx4 a[180:183], v28, s[16:19], s43 offen sc1
  v_mfma_f32_16x16x32_bf16 v[244:247], v[68:71], a[76:79], v[244:247]
  v_mfma_f32_16x16x32_bf16 v[188:191], v[88:91], a[0:3], v[188:191]
  buffer_load_dwordx4 a[184:187], v28, s[16:19], s43 offen offset:1024 sc1
  v_mfma_f32_16x16x32_bf16 v[188:191], v[92:95], a[20:23], v[188:191]
  v_mfma_f32_16x16x32_bf16 v[188:191], v[6:9], a[40:43], v[188:191]
  buffer_load_dwordx4 a[188:191], v28, s[16:19], s43 offen offset:2048 sc1
  v_mfma_f32_16x16x32_bf16 v[188:191], v[10:13], a[60:63], v[188:191]
  v_mfma_f32_16x16x32_bf16 v[204:207], v[88:91], a[4:7], v[204:207]
  buffer_load_dwordx4 a[192:195], v28, s[16:19], s43 offen offset:3072 sc1
  v_mfma_f32_16x16x32_bf16 v[204:207], v[92:95], a[24:27], v[204:207]
  v_mfma_f32_16x16x32_bf16 v[204:207], v[6:9], a[44:47], v[204:207]
  buffer_load_dwordx4 a[196:199], v29, s[16:19], s43 offen sc1
  v_mfma_f32_16x16x32_bf16 v[204:207], v[10:13], a[64:67], v[204:207]
  s_add_u32 s42, s58, 40960
  v_mfma_f32_16x16x32_bf16 v[220:223], v[88:91], a[8:11], v[220:223]
  buffer_load_dwordx4 a[200:203], v28, s[16:19], s42 offen sc1
  v_mfma_f32_16x16x32_bf16 v[220:223], v[92:95], a[28:31], v[220:223]
  v_mfma_f32_16x16x32_bf16 v[220:223], v[6:9], a[48:51], v[220:223]
  buffer_load_dwordx4 a[204:207], v28, s[16:19], s42 offen offset:1024 sc1
  v_mfma_f32_16x16x32_bf16 v[220:223], v[10:13], a[68:71], v[220:223]
  v_mfma_f32_16x16x32_bf16 v[236:239], v[88:91], a[12:15], v[236:239]
  buffer_load_dwordx4 a[208:211], v28, s[16:19], s42 offen offset:2048 sc1
  v_mfma_f32_16x16x32_bf16 v[236:239], v[92:95], a[32:35], v[236:239]
  v_mfma_f32_16x16x32_bf16 v[236:239], v[6:9], a[52:55], v[236:239]
  buffer_load_dwordx4 a[212:215], v28, s[16:19], s42 offen offset:3072 sc1
  v_mfma_f32_16x16x32_bf16 v[236:239], v[10:13], a[72:75], v[236:239]
  v_mfma_f32_16x16x32_bf16 v[252:255], v[88:91], a[16:19], v[252:255]
  buffer_load_dwordx4 a[216:219], v29, s[16:19], s42 offen sc1
  v_mfma_f32_16x16x32_bf16 v[252:255], v[92:95], a[36:39], v[252:255]
  v_mfma_f32_16x16x32_bf16 v[252:255], v[6:9], a[56:59], v[252:255]
  v_mfma_f32_16x16x32_bf16 v[252:255], v[10:13], a[76:79], v[252:255]
  s_load_dwordx2 s[44:45], s[0:1], 80
  v_mfma_f32_16x16x32_bf16 v[180:183], a[242:245], a[80:83], v[180:183]
  s_lshr_b32 s46, s2, 4
  v_mfma_f32_16x16x32_bf16 v[180:183], a[242:245], a[100:103], v[180:183]
  s_mul_i32 s46, s46, 160
  v_mfma_f32_16x16x32_bf16 v[180:183], a[242:245], a[120:123], v[180:183]
  s_and_b32 s47, s30, 1
  v_mfma_f32_16x16x32_bf16 v[180:183], a[242:245], a[140:143], v[180:183]
  s_mul_i32 s47, s47, 80
  v_mfma_f32_16x16x32_bf16 v[188:191], a[240:243], a[80:83], v[188:191]
  s_add_u32 s46, s46, s47
  v_mfma_f32_16x16x32_bf16 v[188:191], a[240:243], a[100:103], v[188:191]
  s_lshl_b32 s46, s46, 11
  v_mfma_f32_16x16x32_bf16 v[188:191], a[240:243], a[120:123], v[188:191]
  s_bfe_u32 s47, s2, 0x10002
  v_mfma_f32_16x16x32_bf16 v[188:191], a[240:243], a[140:143], v[188:191]
  s_lshl_b32 s47, s47, 10
  v_mfma_f32_16x16x32_bf16 v[196:199], a[242:245], a[84:87], v[196:199]
  s_add_u32 s46, s46, s47
  v_mfma_f32_16x16x32_bf16 v[196:199], a[242:245], a[104:107], v[196:199]
  s_lshl_b32 s47, s33, 7
  v_mfma_f32_16x16x32_bf16 v[196:199], a[242:245], a[124:127], v[196:199]
  s_add_u32 s46, s46, s47
  v_mfma_f32_16x16x32_bf16 v[196:199], a[242:245], a[144:147], v[196:199]
  s_lshr_b32 s47, s30, 1
  v_mfma_f32_16x16x32_bf16 v[204:207], a[240:243], a[84:87], v[204:207]
  s_lshl_b32 s47, s47, 6
  v_mfma_f32_16x16x32_bf16 v[204:207], a[240:243], a[104:107], v[204:207]
  s_add_u32 s35, s46, s47
  v_mfma_f32_16x16x32_bf16 v[204:207], a[240:243], a[124:127], v[204:207]
  v_and_b32 v34, 15, v0
  v_mfma_f32_16x16x32_bf16 v[204:207], a[240:243], a[144:147], v[204:207]
  v_lshlrev_b32 v34, 11, v34
  v_mfma_f32_16x16x32_bf16 v[212:215], a[242:245], a[88:91], v[212:215]
  v_lshrrev_b32 v35, 5, v0
  v_mfma_f32_16x16x32_bf16 v[212:215], a[242:245], a[108:111], v[212:215]
  v_lshl_add_u32 v34, v35, 4, v34
  v_mfma_f32_16x16x32_bf16 v[212:215], a[242:245], a[128:131], v[212:215]
  v_bfe_u32 v35, v0, 4, 1
  v_mfma_f32_16x16x32_bf16 v[212:215], a[242:245], a[148:151], v[212:215]
  v_lshl_add_u32 v34, v35, 5, v34
  v_mfma_f32_16x16x32_bf16 v[220:223], a[240:243], a[88:91], v[220:223]
  s_mov_b32 s46, 5242880
  v_mfma_f32_16x16x32_bf16 v[220:223], a[240:243], a[108:111], v[220:223]
  s_mov_b32 s47, 0x20000
  v_mfma_f32_16x16x32_bf16 v[220:223], a[240:243], a[128:131], v[220:223]
  v_mfma_f32_16x16x32_bf16 v[220:223], a[240:243], a[148:151], v[220:223]
  v_mfma_f32_16x16x32_bf16 v[228:231], a[242:245], a[92:95], v[228:231]
  v_mfma_f32_16x16x32_bf16 v[228:231], a[242:245], a[112:115], v[228:231]
  v_mfma_f32_16x16x32_bf16 v[228:231], a[242:245], a[132:135], v[228:231]
  v_mfma_f32_16x16x32_bf16 v[228:231], a[242:245], a[152:155], v[228:231]
  v_mfma_f32_16x16x32_bf16 v[236:239], a[240:243], a[92:95], v[236:239]
  v_mfma_f32_16x16x32_bf16 v[236:239], a[240:243], a[112:115], v[236:239]
  v_mfma_f32_16x16x32_bf16 v[236:239], a[240:243], a[132:135], v[236:239]
  v_mfma_f32_16x16x32_bf16 v[236:239], a[240:243], a[152:155], v[236:239]
  v_mfma_f32_16x16x32_bf16 v[244:247], a[242:245], a[96:99], v[244:247]
  v_mfma_f32_16x16x32_bf16 v[244:247], a[242:245], a[116:119], v[244:247]
  v_mfma_f32_16x16x32_bf16 v[244:247], a[242:245], a[136:139], v[244:247]
  v_mfma_f32_16x16x32_bf16 v[244:247], a[242:245], a[156:159], v[244:247]
  v_mfma_f32_16x16x32_bf16 v[252:255], a[240:243], a[96:99], v[252:255]
  v_mfma_f32_16x16x32_bf16 v[252:255], a[240:243], a[116:119], v[252:255]
  v_mfma_f32_16x16x32_bf16 v[252:255], a[240:243], a[136:139], v[252:255]
  v_mfma_f32_16x16x32_bf16 v[252:255], a[240:243], a[156:159], v[252:255]
  s_waitcnt vmcnt(11)
  v_mfma_f32_16x16x32_bf16 v[180:183], a[242:245], a[160:163], v[180:183]
  v_mfma_f32_16x16x32_bf16 v[188:191], a[240:243], a[160:163], v[188:191]
  v_mfma_f32_16x16x32_bf16 v[196:199], a[242:245], a[164:167], v[196:199]
  v_mfma_f32_16x16x32_bf16 v[204:207], a[240:243], a[164:167], v[204:207]
  v_mfma_f32_16x16x32_bf16 v[212:215], a[242:245], a[168:171], v[212:215]
  v_mfma_f32_16x16x32_bf16 v[220:223], a[240:243], a[168:171], v[220:223]
  v_mfma_f32_16x16x32_bf16 v[228:231], a[242:245], a[172:175], v[228:231]
  v_mfma_f32_16x16x32_bf16 v[236:239], a[240:243], a[172:175], v[236:239]
  v_mfma_f32_16x16x32_bf16 v[244:247], a[242:245], a[176:179], v[244:247]
  v_mfma_f32_16x16x32_bf16 v[252:255], a[240:243], a[176:179], v[252:255]
  s_waitcnt vmcnt(0) lgkmcnt(0)
  v_mfma_f32_16x16x32_bf16 v[180:183], a[242:245], a[180:183], v[180:183]
  v_mfma_f32_16x16x32_bf16 v[180:183], a[242:245], a[200:203], v[180:183]
  v_mfma_f32_16x16x32_bf16 v[188:191], a[240:243], a[180:183], v[188:191]
  v_mfma_f32_16x16x32_bf16 v[188:191], a[240:243], a[200:203], v[188:191]
  v_mfma_f32_16x16x32_bf16 v[196:199], a[242:245], a[184:187], v[196:199]
  v_mfma_f32_16x16x32_bf16 v[196:199], a[242:245], a[204:207], v[196:199]
  v_mfma_f32_16x16x32_bf16 v[204:207], a[240:243], a[184:187], v[204:207]
  v_mfma_f32_16x16x32_bf16 v[204:207], a[240:243], a[204:207], v[204:207]
  v_mfma_f32_16x16x32_bf16 v[212:215], a[242:245], a[188:191], v[212:215]
  v_mfma_f32_16x16x32_bf16 v[212:215], a[242:245], a[208:211], v[212:215]
  v_cvt_pk_bf16_f32 v36, v180, v181
  v_cvt_pk_bf16_f32 v37, v182, v183
  v_mfma_f32_16x16x32_bf16 v[220:223], a[240:243], a[188:191], v[220:223]
  v_cvt_pk_bf16_f32 v38, v188, v189
  v_cvt_pk_bf16_f32 v39, v190, v191
  v_mfma_f32_16x16x32_bf16 v[220:223], a[240:243], a[208:211], v[220:223]
  v_permlane16_swap_b32 v36, v38
  v_permlane16_swap_b32 v37, v39
  v_mfma_f32_16x16x32_bf16 v[228:231], a[242:245], a[192:195], v[228:231]
  buffer_store_dwordx4 v[36:39], v34, s[44:47], s35 offen
  v_mfma_f32_16x16x32_bf16 v[228:231], a[242:245], a[212:215], v[228:231]
  s_add_u32 s35, s35, 32768
  v_cvt_pk_bf16_f32 v40, v196, v197
  v_cvt_pk_bf16_f32 v41, v198, v199
  v_mfma_f32_16x16x32_bf16 v[236:239], a[240:243], a[192:195], v[236:239]
  v_cvt_pk_bf16_f32 v42, v204, v205
  v_cvt_pk_bf16_f32 v43, v206, v207
  v_mfma_f32_16x16x32_bf16 v[236:239], a[240:243], a[212:215], v[236:239]
  v_permlane16_swap_b32 v40, v42
  v_permlane16_swap_b32 v41, v43
  v_mfma_f32_16x16x32_bf16 v[244:247], a[242:245], a[196:199], v[244:247]
  buffer_store_dwordx4 v[40:43], v34, s[44:47], s35 offen
  v_mfma_f32_16x16x32_bf16 v[244:247], a[242:245], a[216:219], v[244:247]
  s_add_u32 s35, s35, 32768
  v_cvt_pk_bf16_f32 v44, v212, v213
  v_cvt_pk_bf16_f32 v45, v214, v215
  v_mfma_f32_16x16x32_bf16 v[252:255], a[240:243], a[196:199], v[252:255]
  v_cvt_pk_bf16_f32 v46, v220, v221
  v_cvt_pk_bf16_f32 v47, v222, v223
  v_mfma_f32_16x16x32_bf16 v[252:255], a[240:243], a[216:219], v[252:255]
  v_permlane16_swap_b32 v44, v46
  v_permlane16_swap_b32 v45, v47
  buffer_store_dwordx4 v[44:47], v34, s[44:47], s35 offen
  s_add_u32 s35, s35, 32768
  v_cvt_pk_bf16_f32 v48, v228, v229
  v_cvt_pk_bf16_f32 v49, v230, v231
  v_cvt_pk_bf16_f32 v50, v236, v237
  v_cvt_pk_bf16_f32 v51, v238, v239
  s_nop 0
  v_permlane16_swap_b32 v48, v50
  v_permlane16_swap_b32 v49, v51
  buffer_store_dwordx4 v[48:51], v34, s[44:47], s35 offen
  s_add_u32 s35, s35, 32768
  v_cvt_pk_bf16_f32 v52, v244, v245
  v_cvt_pk_bf16_f32 v53, v246, v247
  v_cvt_pk_bf16_f32 v54, v252, v253
  v_cvt_pk_bf16_f32 v55, v254, v255
  s_nop 0
  v_permlane16_swap_b32 v52, v54
  v_permlane16_swap_b32 v53, v55
  buffer_store_dwordx4 v[52:55], v34, s[44:47], s35 offen
  s_add_u32 s35, s35, 32768
L_end:
  s_endpgm
L_spinL1:
  s_mov_b32 s49, 0
L_spinL1_l:
  buffer_load_dword v30, v33, s[20:23], 0 offen sc1
  s_waitcnt vmcnt(0)
  v_cmp_eq_u32 vcc, v30, v31
  s_nop 3
  s_and_b32 s48, vcc_lo, s57
  s_cmp_eq_u32 s48, s57
  s_cbranch_scc1 L_gotL1
  s_add_u32 s49, s49, 1
  s_cmp_lt_u32 s49, 0x40000
  s_cbranch_scc1 L_spinL1_l
  s_branch L_gotL1
L_spinL0:
  s_mov_b32 s49, 0
L_spinL0_l:
  buffer_load_dword v30, v33, s[20:23], 0 offen sc1
  s_waitcnt vmcnt(0)
  v_cmp_eq_u32 vcc, v30, v31
  s_nop 3
  s_and_b32 s48, vcc_lo, s57
  s_cmp_eq_u32 s48, s57
  s_cbranch_scc1 L_gotL0
  s_add_u32 s49, s49, 1
  s_cmp_lt_u32 s49, 0x40000
  s_cbranch_scc1 L_spinL0_l
  s_branch L_gotL0
L_spinA:
  s_mov_b32 s49, 0
L_spinA_l:
  buffer_load_dword v30, v33, s[20:23], 0 offen sc1
  s_waitcnt vmcnt(0)
  v_cmp_eq_u32 vcc, v30, v31
  s_nop 3
  s_and_b32 s48, vcc_lo, 0x10
  s_cmp_eq_u32 s48, 0x10
  s_cbranch_scc1 L_gotA
  s_add_u32 s49, s49, 1
  s_cmp_lt_u32 s49, 0x40000
  s_cbranch_scc1 L_spinA_l
  s_branch L_gotA
L_spinF:
  s_mov_b32 s49, 0
L_spinF_l:
  buffer_load_dword v30, v33, s[20:23], 0 offen sc1
  s_waitcnt vmcnt(0)
  v_cmp_eq_u32 vcc, v30, v31
  s_nop 3
  s_and_b32 s48, vcc_lo, 0x60
  s_cmp_eq_u32 s48, 0x60
  s_cbranch_scc1 L_gotF
  s_add_u32 s49, s49, 1
  s_cmp_lt_u32 s49, 0x40000
  s_cbranch_scc1 L_spinF_l
  s_branch L_gotF
L_nspin:
  s_mov_b32 s49, 0
L_nspin_l:
  v_mov_b32 v33, 0
  global_load_dword v33, v33, s[28:29] sc1
  s_waitcnt vmcnt(0)
  v_readfirstlane_b32 s38, v33
  s_nop 3
  s_cmp_eq_u32 s38, 0
  s_cbranch_scc0 L_ngot
  s_add_u32 s49, s49, 1
  s_cmp_lt_u32 s49, 0x40000
  s_cbranch_scc1 L_nspin_l
  s_branch L_ngot
L_otail:
L_redo:
  s_waitcnt vmcnt(0) lgkmcnt(0)
  s_barrier
  s_lshl_b32 s34, s50, 18
  s_mov_b32 s39, 0
  v_mov_b32 v24, 0xff800000
  v_mov_b32 v25, 0xff800000
  v_mov_b32 v26, 0xff800000
  v_mov_b32 v27, 0xff800000
  v_mov_b32 v28, 0xff800000
L_redo_l:
  s_add_u32 m0, s31, 65792
  s_nop 0
  buffer_load_dwordx4 v13, s[8:11], s34 offen nt lds
  buffer_load_dwordx4 v14, s[8:11], s34 offen offset:1024 nt lds
  buffer_load_dwordx4 v15, s[8:11], s34 offen offset:2048 nt lds
  buffer_load_dwordx4 v16, s[8:11], s34 offen offset:3072 nt lds
  s_waitcnt vmcnt(0)
  s_barrier
  ds_read_b128 a[160:163], v1 offset:0
  ds_read_b128 a[164:167], v2 offset:0
  ds_read_b128 a[168:171], v3 offset:0
  ds_read_b128 a[172:175], v4 offset:0
  ds_read_b128 a[176:179], v1 offset:4096
  ds_read_b128 a[180:183], v2 offset:4096
  ds_read_b128 a[184:187], v3 offset:4096
  ds_read_b128 a[188:191], v4 offset:4096
  s_waitcnt lgkmcnt(0)
  v_mfma_f32_16x16x32_bf16 v[56:59], a[160:163], a[0:3], 0
  v_mfma_f32_16x16x32_bf16 v[56:59], a[164:167], a[20:23], v[56:59]
  v_mfma_f32_16x16x32_bf16 v[56:59], a[168:171], a[40:43], v[56:59]
  v_mfma_f32_16x16x32_bf16 v[56:59], a[172:175], a[60:63], v[56:59]
  v_mfma_f32_16x16x32_bf16 v[60:63], a[176:179], a[0:3], 0
  v_mfma_f32_16x16x32_bf16 v[60:63], a[180:183], a[20:23], v[60:63]
  v_mfma_f32_16x16x32_bf16 v[60:63], a[184:187], a[40:43], v[60:63]
  v_mfma_f32_16x16x32_bf16 v[60:63], a[188:191], a[60:63], v[60:63]
  v_mfma_f32_16x16x32_bf16 v[64:67], a[160:163], a[4:7], 0
  v_mfma_f32_16x16x32_bf16 v[64:67], a[164:167], a[24:27], v[64:67]
  v_mfma_f32_16x16x32_bf16 v[64:67], a[168:171], a[44:47], v[64:67]
  v_mfma_f32_16x16x32_bf16 v[64:67], a[172:175], a[64:67], v[64:67]
  v_mfma_f32_16x16x32_bf16 v[68:71], a[176:179], a[4:7], 0
  v_mfma_f32_16x16x32_bf16 v[68:71], a[180:183], a[24:27], v[68:71]
  v_mfma_f32_16x16x32_bf16 v[68:71], a[184:187], a[44:47], v[68:71]
  v_mfma_f32_16x16x32_bf16 v[68:71], a[188:191], a[64:67], v[68:71]
  v_mfma_f32_16x16x32_bf16 v[72:75], a[160:163], a[8:11], 0
  v_mfma_f32_16x16x32_bf16 v[72:75], a[164:167], a[28:31], v[72:75]
  v_mfma_f32_16x16x32_bf16 v[72:75], a[168:171], a[48:51], v[72:75]
  v_mfma_f32_16x16x32_bf16 v[72:75], a[172:175], a[68:71], v[72:75]
  v_mfma_f32_16x16x32_bf16 v[76:79], a[176:179], a[8:11], 0
  v_mfma_f32_16x16x32_bf16 v[76:79], a[180:183], a[28:31], v[76:79]
  v_mfma_f32_16x16x32_bf16 v[76:79], a[184:187], a[48:51], v[76:79]
  v_mfma_f32_16x16x32_bf16 v[76:79], a[188:191], a[68:71], v[76:79]
  v_mfma_f32_16x16x32_bf16 v[80:83], a[160:163], a[12:15], 0
  v_mfma_f32_16x16x32_bf16 v[80:83], a[164:167], a[32:35], v[80:83]
  v_mfma_f32_16x16x32_bf16 v[80:83], a[168:171], a[52:55], v[80:83]
  v_mfma_f32_16x16x32_bf16 v[80:83], a[172:175], a[72:75], v[80:83]
  v_mfma_f32_16x16x32_bf16 v[84:87], a[176:179], a[12:15], 0
  v_mfma_f32_16x16x32_bf16 v[84:87], a[180:183], a[32:35], v[84:87]
  v_mfma_f32_16x16x32_bf16 v[84:87], a[184:187], a[52:55], v[84:87]
  v_mfma_f32_16x16x32_bf16 v[84:87], a[188:191], a[72:75], v[84:87]
  v_mfma_f32_16x16x32_bf16 v[88:91], a[160:163], a[16:19], 0
  v_mfma_f32_16x16x32_bf16 v[88:91], a[164:167], a[36:39], v[88:91]
  v_mfma_f32_16x16x32_bf16 v[88:91], a[168:171], a[56:59], v[88:91]
  v_mfma_f32_16x16x32_bf16 v[88:91], a[172:175], a[76:79], v[88:91]
  v_mfma_f32_16x16x32_bf16 v[92:95], a[176:179], a[16:19], 0
  v_mfma_f32_16x16x32_bf16 v[92:95], a[180:183], a[36:39], v[92:95]
  v_mfma_f32_16x16x32_bf16 v[92:95], a[184:187], a[56:59], v[92:95]
  v_mfma_f32_16x16x32_bf16 v[92:95], a[188:191], a[76:79], v[92:95]
  s_nop 7
  v_max3_f32 v24, v24, v56, v57
  v_max3_f32 v24, v24, v58, v59
  v_max3_f32 v24, v24, v60, v61
  v_max3_f32 v24, v24, v62, v63
  v_max3_f32 v25, v25, v64, v65
  v_max3_f32 v25, v25, v66, v67
  v_max3_f32 v25, v25, v68, v69
  v_max3_f32 v25, v25, v70, v71
  v_max3_f32 v26, v26, v72, v73
  v_max3_f32 v26, v26, v74, v75
  v_max3_f32 v26, v26, v76, v77
  v_max3_f32 v26, v26, v78, v79
  v_max3_f32 v27, v27, v80, v81
  v_max3_f32 v27, v27, v82, v83
  v_max3_f32 v27, v27, v84, v85
  v_max3_f32 v27, v27, v86, v87
  v_max3_f32 v28, v28, v88, v89
  v_max3_f32 v28, v28, v90, v91
  v_max3_f32 v28, v28, v92, v93
  v_max3_f32 v28, v28, v94, v95
  s_barrier
  s_add_u32 s34, s34, 8192
  s_add_u32 s39, s39, 1
  s_cmp_lt_u32 s39, 16
  s_cbranch_scc1 L_redo_l
  v_mov_b32 v29, v24
  s_nop 1
  v_permlane32_swap_b32 v29, v24
  v_max_f32 v24, v24, v29
  v_mov_b32 v29, v24
  s_nop 1
  v_permlane16_swap_b32 v29, v24
  v_max_f32 v24, v24, v29
  v_sub_f32 v36, 0, v24
  v_sub_f32 v37, 0, v24
  v_sub_f32 v38, 0, v24
  v_sub_f32 v39, 0, v24
  v_mov_b32 v29, v25
  s_nop 1
  v_permlane32_swap_b32 v29, v25
  v_max_f32 v25, v25, v29
  v_mov_b32 v29, v25
  s_nop 1
  v_permlane16_swap_b32 v29, v25
  v_max_f32 v25, v25, v29
  v_sub_f32 v40, 0, v25
  v_sub_f32 v41, 0, v25
  v_sub_f32 v42, 0, v25
  v_sub_f32 v43, 0, v25
  v_mov_b32 v29, v26
  s_nop 1
  v_permlane32_swap_b32 v29, v26
  v_max_f32 v26, v26, v29
  v_mov_b32 v29, v26
  s_nop 1
  v_permlane16_swap_b32 v29, v26
  v_max_f32 v26, v26, v29
  v_sub_f32 v44, 0, v26
  v_sub_f32 v45, 0, v26
  v_sub_f32 v46, 0, v26
  v_sub_f32 v47, 0, v26
  v_mov_b32 v29, v27
  s_nop 1
  v_permlane32_swap_b32 v29, v27
  v_max_f32 v27, v27, v29
  v_mov_b32 v29, v27
  s_nop 1
  v_permlane16_swap_b32 v29, v27
  v_max_f32 v27, v27, v29
  v_sub_f32 v48, 0, v27
  v_sub_f32 v49, 0, v27
  v_sub_f32 v50, 0, v27
  v_sub_f32 v51, 0, v27
  v_mov_b32 v29, v28
  s_nop 1
  v_permlane32_swap_b32 v29, v28
  v_max_f32 v28, v28, v29
  v_mov_b32 v29, v28
  s_nop 1
  v_permlane16_swap_b32 v29, v28
  v_max_f32 v28, v28, v29
  v_sub_f32 v52, 0, v28
  v_sub_f32 v53, 0, v28
  v_sub_f32 v54, 0, v28
  v_sub_f32 v55, 0, v28
  v_mov_b32 v96, 0
  v_mov_b32 v97, 0
  v_mov_b32 v98, 0
  v_mov_b32 v99, 0
  v_mov_b32 v100, 0
  v_mov_b32 v101, 0
  v_mov_b32 v102, 0
  v_mov_b32 v103, 0
  v_mov_b32 v104, 0
  v_mov_b32 v105, 0
  v_mov_b32 v106, 0
  v_mov_b32 v107, 0
  v_mov_b32 v108, 0
  v_mov_b32 v109, 0
  v_mov_b32 v110, 0
  v_mov_b32 v111, 0
  v_mov_b32 v112, 0
  v_mov_b32 v113, 0
  v_mov_b32 v114, 0
  v_mov_b32 v115, 0
  v_mov_b32 v116, 0
  v_mov_b32 v117, 0
  v_mov_b32 v118, 0
  v_mov_b32 v119, 0
  v_mov_b32 v120, 0
  v_mov_b32 v121, 0
  v_mov_b32 v122, 0
  v_mov_b32 v123, 0
  v_mov_b32 v124, 0
  v_mov_b32 v125, 0
  v_mov_b32 v126, 0
  v_mov_b32 v127, 0
  v_mov_b32 v128, 0
  v_mov_b32 v129, 0
  v_mov_b32 v130, 0
  v_mov_b32 v131, 0
  v_mov_b32 v132, 0
  v_mov_b32 v133, 0
  v_mov_b32 v134, 0
  v_mov_b32 v135, 0
  v_mov_b32 v136, 0
  v_mov_b32 v137, 0
  v_mov_b32 v138, 0
  v_mov_b32 v139, 0
  v_mov_b32 v140, 0
  v_mov_b32 v141, 0
  v_mov_b32 v142, 0
  v_mov_b32 v143, 0
  v_mov_b32 v144, 0
  v_mov_b32 v145, 0
  v_mov_b32 v146, 0
  v_mov_b32 v147, 0
  v_mov_b32 v148, 0
  v_mov_b32 v149, 0
  v_mov_b32 v150, 0
  v_mov_b32 v151, 0
  v_mov_b32 v152, 0
  v_mov_b32 v153, 0
  v_mov_b32 v154, 0
  v_mov_b32 v155, 0
  v_mov_b32 v156, 0
  v_mov_b32 v157, 0
  v_mov_b32 v158, 0
  v_mov_b32 v159, 0
  v_mov_b32 v160, 0
  v_mov_b32 v161, 0
  v_mov_b32 v162, 0
  v_mov_b32 v163, 0
  v_mov_b32 v164, 0
  v_mov_b32 v165, 0
  v_mov_b32 v166, 0
  v_mov_b32 v167, 0
  v_mov_b32 v168, 0
  v_mov_b32 v169, 0
  v_mov_b32 v170, 0
  v_mov_b32 v171, 0
  v_mov_b32 v172, 0
  v_mov_b32 v173, 0
  v_mov_b32 v174, 0
  v_mov_b32 v175, 0
  v_mov_b32 v176, 0
  v_mov_b32 v177, 0
  v_mov_b32 v178, 0
  v_mov_b32 v179, 0
  v_mov_b32 v180, 0
  v_mov_b32 v181, 0
  v_mov_b32 v182, 0
  v_mov_b32 v183, 0
  v_mov_b32 v184, 0
  v_mov_b32 v185, 0
  v_mov_b32 v186, 0
  v_mov_b32 v187, 0
  v_mov_b32 v188, 0
  v_mov_b32 v189, 0
  v_mov_b32 v190, 0
  v_mov_b32 v191, 0
  v_mov_b32 v192, 0
  v_mov_b32 v193, 0
  v_mov_b32 v194, 0
  v_mov_b32 v195, 0
  v_mov_b32 v196, 0
  v_mov_b32 v197, 0
  v_mov_b32 v198, 0
  v_mov_b32 v199, 0
  v_mov_b32 v200, 0
  v_mov_b32 v201, 0
  v_mov_b32 v202, 0
  v_mov_b32 v203, 0
  v_mov_b32 v204, 0
  v_mov_b32 v205, 0
  v_mov_b32 v206, 0
  v_mov_b32 v207, 0
  v_mov_b32 v208, 0
  v_mov_b32 v209, 0
  v_mov_b32 v210, 0
  v_mov_b32 v211, 0
  v_mov_b32 v212, 0
  v_mov_b32 v213, 0
  v_mov_b32 v214, 0
  v_mov_b32 v215, 0
  v_mov_b32 v216, 0
  v_mov_b32 v217, 0
  v_mov_b32 v218, 0
  v_mov_b32 v219, 0
  v_mov_b32 v220, 0
  v_mov_b32 v221, 0
  v_mov_b32 v222, 0
  v_mov_b32 v223, 0
  v_mov_b32 v224, 0
  v_mov_b32 v225, 0
  v_mov_b32 v226, 0
  v_mov_b32 v227, 0
  v_mov_b32 v228, 0
  v_mov_b32 v229, 0
  v_mov_b32 v230, 0
  v_mov_b32 v231, 0
  v_mov_b32 v232, 0
  v_mov_b32 v233, 0
  v_mov_b32 v234, 0
  v_mov_b32 v235, 0
  v_mov_b32 v236, 0
  v_mov_b32 v237, 0
  v_mov_b32 v238, 0
  v_mov_b32 v239, 0
  v_mov_b32 v240, 0
  v_mov_b32 v241, 0
  v_mov_b32 v242, 0
  v_mov_b32 v243, 0
  v_mov_b32 v244, 0
  v_mov_b32 v245, 0
  v_mov_b32 v246, 0
  v_mov_b32 v247, 0
  v_mov_b32 v248, 0
  v_mov_b32 v249, 0
  v_mov_b32 v250, 0
  v_mov_b32 v251, 0
  v_mov_b32 v252, 0
  v_mov_b32 v253, 0
  v_mov_b32 v254, 0
  v_mov_b32 v255, 0
  v_accvgpr_write_b32 a224, 0
  v_accvgpr_write_b32 a225, 0
  v_accvgpr_write_b32 a226, 0
  v_accvgpr_write_b32 a227, 0
  v_accvgpr_write_b32 a228, 0
  v_accvgpr_write_b32 a229, 0
  v_accvgpr_write_b32 a230, 0
  v_accvgpr_write_b32 a231, 0
  v_accvgpr_write_b32 a232, 0
  v_accvgpr_write_b32 a233, 0
  v_accvgpr_write_b32 a234, 0
  v_accvgpr_write_b32 a235, 0
  v_accvgpr_write_b32 a236, 0
  v_accvgpr_write_b32 a237, 0
  v_accvgpr_write_b32 a238, 0
  v_accvgpr_write_b32 a239, 0
  v_accvgpr_write_b32 a240, 0
  v_accvgpr_write_b32 a241, 0
  v_accvgpr_write_b32 a242, 0
  v_accvgpr_write_b32 a243, 0
  s_mov_b32 s12, s24
  s_mov_b32 s13, s25
  s_mov_b32 s14, 393216
  s_lshl_b32 s35, s50, 18
  s_add_u32 s35, s35, s71
  s_mov_b32 s70, 0x20000
  s_mov_b32 s36, 8192
  v_mov_b32 v17, v21
  v_xor_b32 v18, 0x80, v21
  v_mov_b32 v19, v21
  v_xor_b32 v20, 0x80, v21
  s_mov_b32 s34, s35
  s_add_u32 m0, s31, 65792
  s_nop 0
  buffer_load_dwordx4 v13, s[8:11], s34 offen nt lds
  buffer_load_dwordx4 v14, s[8:11], s34 offen offset:1024 nt lds
  buffer_load_dwordx4 v15, s[8:11], s34 offen offset:2048 nt lds
  buffer_load_dwordx4 v16, s[8:11], s34 offen offset:3072 nt lds
  s_add_u32 s34, s34, 8192
  s_bitset0_b32 s34, 17
  s_add_u32 m0, s31, 82176
  s_nop 0
  buffer_load_dwordx4 v13, s[8:11], s34 offen nt lds
  buffer_load_dwordx4 v14, s[8:11], s34 offen offset:1024 nt lds
  buffer_load_dwordx4 v15, s[8:11], s34 offen offset:2048 nt lds
  buffer_load_dwordx4 v16, s[8:11], s34 offen offset:3072 nt lds
  s_add_u32 s34, s34, 8192
  s_bitset0_b32 s34, 17
  s_add_u32 m0, s31, 98560
  s_nop 0
  buffer_load_dwordx4 v13, s[8:11], s34 offen nt lds
  buffer_load_dwordx4 v14, s[8:11], s34 offen offset:1024 nt lds
  buffer_load_dwordx4 v15, s[8:11], s34 offen offset:2048 nt lds
  buffer_load_dwordx4 v16, s[8:11], s34 offen offset:3072 nt lds
  s_add_u32 s34, s34, 8192
  s_bitset0_b32 s34, 17
  s_add_u32 m0, s31, 114944
  s_nop 0
  buffer_load_dwordx4 v13, s[8:11], s34 offen nt lds
  buffer_load_dwordx4 v14, s[8:11], s34 offen offset:1024 nt lds
  buffer_load_dwordx4 v15, s[8:11], s34 offen offset:2048 nt lds
  buffer_load_dwordx4 v16, s[8:11], s34 offen offset:3072 nt lds
  s_add_u32 s34, s34, 8192
  s_bitset0_b32 s34, 17
  s_add_u32 m0, s31, 0
  s_nop 0
  buffer_load_dwordx4 v17, s[12:15], s35 offen nt lds
  buffer_load_dwordx4 v18, s[12:15], s35 offen offset:1024 nt lds
  buffer_load_dwordx4 v19, s[12:15], s35 offen offset:2048 nt lds
  buffer_load_dwordx4 v20, s[12:15], s35 offen offset:3072 nt lds
  s_add_u32 s35, s35, s36
  s_andn2_b32 s35, s35, s70
  s_add_u32 m0, s31, 16384
  s_nop 0
  buffer_load_dwordx4 v17, s[12:15], s35 offen nt lds
  buffer_load_dwordx4 v18, s[12:15], s35 offen offset:1024 nt lds
  buffer_load_dwordx4 v19, s[12:15], s35 offen offset:2048 nt lds
  buffer_load_dwordx4 v20, s[12:15], s35 offen offset:3072 nt lds
  s_add_u32 s35, s35, s36
  s_andn2_b32 s35, s35, s70
  s_add_u32 m0, s31, 32768
  s_nop 0
  buffer_load_dwordx4 v17, s[12:15], s35 offen nt lds
  buffer_load_dwordx4 v18, s[12:15], s35 offen offset:1024 nt lds
  buffer_load_dwordx4 v19, s[12:15], s35 offen offset:2048 nt lds
  buffer_load_dwordx4 v20, s[12:15], s35 offen offset:3072 nt lds
  s_add_u32 s35, s35, s36
  s_andn2_b32 s35, s35, s70
  s_waitcnt vmcnt(0)
  s_barrier
  ds_read_b128 a[160:163], v1 offset:0
  ds_read_b128 a[164:167], v2 offset:0
  ds_read_b128 a[168:171], v3 offset:0
  ds_read_b128 a[172:175], v4 offset:0
  ds_read_b128 a[176:179], v1 offset:4096
  ds_read_b128 a[180:183], v2 offset:4096
  ds_read_b128 a[184:187], v3 offset:4096
  ds_read_b128 a[188:191], v4 offset:4096
  s_xor_b32 s48, s30, 0
  s_lshl_b32 s48, s48, 10
  s_add_u32 s48, s48, 65792
  v_lshl_add_u32 v26, v0, 4, s48
  v_add_u32 v27, 0x10000, v26
  s_waitcnt lgkmcnt(0)
  s_mov_b64 vcc, 0
  s_mov_b32 s3, -1
  s_mov_b32 s39, -1
  s_mov_b32 s37, 8192
  s_branch L_a3
.section .rodata,"a"
.p2align 6
.amdhsa_kernel concat_heads__mha_block_cached__gqa_block_cached__near_ridge_kernel
  .amdhsa_next_free_vgpr 512
  .amdhsa_next_free_sgpr 102
  .amdhsa_accum_offset 256
  .amdhsa_group_segment_fixed_size 0
  .amdhsa_kernarg_size 104
  .amdhsa_user_sgpr_count 2
  .amdhsa_user_sgpr_kernarg_segment_ptr 1
  .amdhsa_system_sgpr_workgroup_id_x 1
.end_amdhsa_kernel
```
